```python
import torch

def _softmax(x, axis=-1):
    return torch.softmax(x, dim=axis)
def _gelu(x):
    return torch.nn.functional.gelu(x, approximate="tanh")
def _silu(x):
    return torch.nn.functional.silu(x)
def _sigmoid(x):
    return torch.sigmoid(x)
def _layernorm(x, axis=-1, eps=1e-5):
    m = x.mean(dim=axis, keepdim=True)
    v = x.var(dim=axis, keepdim=True, unbiased=False)
    return (x - m) / torch.sqrt(v + eps)
def _scatter_add(tgt, idx, src, axis=0):
    return tgt.clone().index_add_(axis, idx, src)
def _segment_sum(src, seg, n):
    out = torch.zeros((n,) + src.shape[1:], dtype=src.dtype)
    return out.index_add_(0, seg, src)
def _pad(x, pw):
    flat = tuple(v for pair in reversed(pw) for v in pair)
    return torch.nn.functional.pad(x, flat)

kernel_name = 'concat_heads__ssm_conv_h3__sliding_block__prompt'

def setup_inputs():

    _w = (lambda a: (lambda t: t.to(torch.bfloat16) if t.is_floating_point() else t)(torch.as_tensor(a)))
    def _A_setup():
        B, S, D = 1, 2048, 1024
        ks = 4
        return {
            "q": _w((lambda *s: torch.randn(*s, dtype=torch.bfloat16) * 0.05)(B, S, D)),
            "k": _w((lambda *s: torch.randn(*s, dtype=torch.bfloat16) * 1.6)(B, S, D)),
            "v": _w((lambda *s: torch.randn(*s, dtype=torch.bfloat16) * 0.8)(B, S, D)),
            "shift_k": _w((lambda *s: torch.randn(*s, dtype=torch.bfloat16) * 1.6)(D, ks) * 0.5),
            "ssm_k": _w((lambda *s: torch.randn(*s, dtype=torch.bfloat16) * 1.6)(D, S) * (1.0 / S ** 0.5)),
            "ssm_D": _w((lambda *s: torch.randn(*s, dtype=torch.bfloat16) * 0.8)(D)),
        }
    _A_in = _A_setup()

    def _B_setup():
        B, S, D = 1, 2048, 1024
        return {
            "x": _w((lambda *s: torch.randn(*s, dtype=torch.bfloat16) * 0.2)(B, S, D)),
            "wqkv": _w((lambda *s: torch.randn(*s, dtype=torch.bfloat16) * 0.2)(D, 3 * D)),
            "wo": _w((lambda *s: torch.randn(*s, dtype=torch.bfloat16) * 0.05)(D, D)),
        }
    _B_in = _B_setup()

    return {
        "A_q": _A_in["q"],
        "A_k": _A_in["k"],
        "A_v": _A_in["v"],
        "A_shift_k": _A_in["shift_k"],
        "A_ssm_k": _A_in["ssm_k"],
        "A_ssm_D": _A_in["ssm_D"],
        "B_x": _B_in["x"],
        "B_wqkv": _B_in["wqkv"],
        "B_wo": _B_in["wo"],
    }

def reference(A_q, A_k, A_v, A_shift_k, A_ssm_k, A_ssm_D, B_x, B_wqkv, B_wo):
    def _A_ref(q, k, v, shift_k, ssm_k, ssm_D):
        B, S, D = q.shape
        ks = shift_k.shape[-1]
        k_pad = _pad(k, ((0, 0), (ks - 1, 0), (0, 0)))
        k_shift = torch.zeros_like(k)
        for t in range(ks):
            k_shift = k_shift + k_pad[:, t:t + S, :] * shift_k[:, ks - 1 - t][None, None, :]
        kv = k_shift * v
        L = 2 * S
        kv_pad = _pad(kv, ((0, 0), (0, S), (0, 0)))
        kf_pad = _pad(ssm_k, ((0, 0), (0, S)))
        kv_f = (lambda x, axes=(-2,-1): torch.fft.rfft2(x.float(), dim=axes))(kv_pad[:, None, :, :], axes=(1, 2))
        kf_f = (lambda x, axes=(-2,-1): torch.fft.rfft2(x.float(), dim=axes))(kf_pad[:, None, :], axes=(1, 2))
        kf_f = (lambda x, *d: x.permute(*d))(kf_f, 1, 2, 0)
        y_f = kv_f * kf_f[None, :, :, :]
        y = (lambda x, s, axes=(-2,-1): torch.fft.irfft2(x, s=s, dim=axes).to(torch.bfloat16))(y_f, (1, L), axes=(1, 2))[:, 0, :S, :]
        y = y + kv * ssm_D[None, None, :]
        return q * y

    def _B_ref(x, wqkv, wo):
        B, S, D = x.shape
        H = 32; Dh = D // H; W = 256
        qkv = (lambda x, *d: x.permute(*d))((x @ wqkv).reshape(B, S, 3, H, Dh), 2, 0, 3, 1, 4)
        q, k, v = qkv[0], qkv[1], qkv[2]
        scores = torch.einsum("bhqd,bhkd->bhqk", q, k) * (Dh ** -0.5)
        idx = torch.arange(S)
        mask = (idx[:, None] - idx[None, :] >= 0) & (idx[:, None] - idx[None, :] < W)
        scores = torch.where(mask[None, None], scores, -1e9)
        p = _softmax(scores, axis=-1)
        o = torch.einsum("bhqk,bhkd->bhqd", p, v)
        return (lambda x, *d: x.permute(*d))(o, 0, 2, 1, 3).reshape(B, S, D) @ wo

    a = _A_ref(A_q, A_k, A_v, A_shift_k, A_ssm_k, A_ssm_D)
    b = _B_ref(B_x, B_wqkv, B_wo)
    return torch.concatenate([a, b], axis=-1)
```

```asm
; @launch grid=(256,1,1) block=(512,1,1) lds=163840
.amdgcn_target "amdgcn-amd-amdhsa--gfx950"
.text
.globl concat_heads__ssm_conv_h3__sliding_block__prompt_kernel
.p2align 8
.type concat_heads__ssm_conv_h3__sliding_block__prompt_kernel,@function
concat_heads__ssm_conv_h3__sliding_block__prompt_kernel:
    s_cmp_ge_u32 s2, 256
    s_cbranch_scc1 L_end
    s_load_dwordx2 s[4:5], s[0:1], 48
    s_load_dwordx2 s[8:9], s[0:1], 56
    s_and_b32 s80, s2, 6
    s_lshr_b32 s80, 0xa0, s80
    s_and_b32 s80, s80, 6
    s_xor_b32 s2, s2, s80
    v_lshrrev_b32 v1, 6, v0
    v_and_b32 v0, 63, v0
    s_and_b32 s3, s2, 7
    v_readfirstlane_b32 s32, v1
    s_lshr_b32 s35, s2, 3
    s_and_b32 s33, s3, 1
    s_lshl_b32 s33, s33, 3
    s_and_b32 s80, s35, 7
    s_add_u32 s33, s33, s80
    s_lshr_b32 s34, s3, 1
    s_lshl_b32 s34, s34, 2
    s_lshr_b32 s80, s35, 3
    s_add_u32 s34, s34, s80
    v_lshlrev_b32 v1, 4, v0
    v_mov_b32 v252, 0
    s_mov_b32 s6, 0x400000
    s_mov_b32 s7, 0x20000
    s_mov_b32 s10, 0x600000
    s_mov_b32 s11, 0x20000
    s_and_b32 s44, s32, 3
    s_mov_b32 s59, 0
    s_cmp_lt_u32 s32, 4
    s_cbranch_scc1 L_M
    s_setprio 3
    v_lshrrev_b32 v12, 3, v0
    v_and_b32 v13, 7, v0
    s_lshl_b32 s45, s33, 7
    s_lshl_b32 s46, s44, 5
    s_add_u32 s45, s45, s46
    v_lshrrev_b32 v14, 4, v0
    v_xor_b32 v14, v14, v13
    v_add_u32 v15, s45, v12
    v_lshlrev_b32 v15, 11, v15
    v_lshl_add_u32 v2, v14, 4, v15
    v_xor_b32 v3, 64, v2
    v_add_u32 v3, 15360, v3
    v_add_u32 v4, 30720, v2
    v_add_u32 v5, 30720, v3
    s_lshl_b32 s45, s44, 12
    s_lshr_b32 s56, s35, 3
    s_mul_i32 s56, s56, 2
    s_add_u32 s56, s56, s35
    s_lshr_b32 s49, s3, 1
    s_mul_i32 s49, s49, 1
    s_add_u32 s56, s56, s49
    s_waitcnt lgkmcnt(0)
    s_add_u32 m0, s45, 122880
    s_add_u32 s42, s56, 0
    s_and_b32 s42, s42, 3
    s_lshl_b32 s42, s42, 7
    buffer_load_dwordx4 v2, s[4:7], s42 offen offset:0  lds
    buffer_load_dwordx4 v3, s[4:7], s42 offen offset:1024  lds
    buffer_load_dwordx4 v4, s[4:7], s42 offen offset:2048  lds
    buffer_load_dwordx4 v5, s[4:7], s42 offen offset:3072  lds
    s_load_dwordx2 s[12:13], s[0:1], 88
    s_load_dwordx2 s[16:17], s[0:1], 8
    s_load_dwordx2 s[20:21], s[0:1], 16
    s_load_dwordx2 s[24:25], s[0:1], 24
    s_load_dwordx2 s[28:29], s[0:1], 32
    s_load_dwordx2 s[60:61], s[0:1], 64
    s_load_dwordx2 s[64:65], s[0:1], 0
    s_load_dwordx2 s[68:69], s[0:1], 72
    s_load_dwordx2 s[72:73], s[0:1], 80
    s_load_dwordx2 s[36:37], s[0:1], 40
    s_mul_i32 s48, s44, 98304
    s_lshl_b32 s46, s34, 7
    s_add_u32 s48, s48, s46
    v_mul_u32_u24 v15, 2731, v0
    v_lshrrev_b32 v15, 16, v15
    v_mul_u32_u24 v16, 24, v15
    v_sub_u32 v16, v0, v16
    v_bfe_u32 v18, v15, 1, 1
    v_lshlrev_b32 v18, 2, v18
    v_xor_b32 v16, v16, v18
    v_lshrrev_b32 v18, 3, v16
    v_and_b32 v16, 7, v16
    v_mul_u32_u24 v15, 6144, v15
    v_lshl_add_u32 v15, v18, 11, v15
    v_lshl_add_u32 v15, v16, 4, v15
    s_add_u32 s49, s48, 0
    v_add_u32 v6, s49, v15
    s_add_u32 s49, s48, 46080
    v_add_u32 v9, s49, v15
    v_xor_b32 v9, 32, v9
    v_add_u32 v14, 64, v0
    v_mul_u32_u24 v15, 2731, v14
    v_lshrrev_b32 v15, 16, v15
    v_mul_u32_u24 v16, 24, v15
    v_sub_u32 v16, v14, v16
    v_bfe_u32 v18, v15, 1, 1
    v_lshlrev_b32 v18, 2, v18
    v_xor_b32 v16, v16, v18
    v_lshrrev_b32 v18, 3, v16
    v_and_b32 v16, 7, v16
    v_mul_u32_u24 v15, 6144, v15
    v_lshl_add_u32 v15, v18, 11, v15
    v_lshl_add_u32 v15, v16, 4, v15
    s_add_u32 s49, s48, -1024
    v_add_u32 v7, s49, v15
    s_add_u32 s49, s48, 49152
    v_add_u32 v10, s49, v15
    v_xor_b32 v10, 32, v10
    v_add_u32 v14, 128, v0
    v_mul_u32_u24 v15, 2731, v14
    v_lshrrev_b32 v15, 16, v15
    v_mul_u32_u24 v16, 24, v15
    v_sub_u32 v16, v14, v16
    v_bfe_u32 v18, v15, 1, 1
    v_lshlrev_b32 v18, 2, v18
    v_xor_b32 v16, v16, v18
    v_lshrrev_b32 v18, 3, v16
    v_and_b32 v16, 7, v16
    v_mul_u32_u24 v15, 6144, v15
    v_lshl_add_u32 v15, v18, 11, v15
    v_lshl_add_u32 v15, v16, 4, v15
    s_add_u32 s49, s48, -2048
    v_add_u32 v8, s49, v15
    s_add_u32 s49, s48, 48128
    v_add_u32 v11, s49, v15
    v_xor_b32 v11, 32, v11
    s_mul_i32 s43, s44, 6144
    s_add_u32 s43, s43, 16384
    s_add_u32 m0, s43, 122880
    s_add_u32 s42, s56, 0
    s_and_b32 s42, s42, 3
    s_mul_i32 s42, s42, 393216
    buffer_load_dwordx4 v6, s[8:11], s42 offen offset:0  lds
    buffer_load_dwordx4 v7, s[8:11], s42 offen offset:1024  lds
    buffer_load_dwordx4 v8, s[8:11], s42 offen offset:2048  lds
    buffer_load_dwordx4 v9, s[8:11], s42 offen offset:3072  lds
    s_add_u32 m0, s43, 126976
    s_nop 0
    buffer_load_dwordx4 v10, s[8:11], s42 offen offset:0  lds
    buffer_load_dwordx4 v11, s[8:11], s42 offen offset:1024  lds
    s_add_u32 m0, s45, 81920
    s_add_u32 s42, s56, 1
    s_and_b32 s42, s42, 3
    s_lshl_b32 s42, s42, 7
    buffer_load_dwordx4 v2, s[4:7], s42 offen offset:0  lds
    buffer_load_dwordx4 v3, s[4:7], s42 offen offset:1024  lds
    buffer_load_dwordx4 v4, s[4:7], s42 offen offset:2048  lds
    buffer_load_dwordx4 v5, s[4:7], s42 offen offset:3072  lds
    s_waitcnt lgkmcnt(0)
    s_lshl_b32 s84, s3, 5
    s_add_u32 s84, s84, s35
    s_lshl_b32 s80, s84, 3
    s_load_dwordx2 s[76:77], s[36:37], s80
    s_lshl_b32 s89, s2, 7
    s_lshl_b32 s81, s32, 3
    s_add_u32 s89, s89, s81
    s_mov_b32 s14, 0x1a00000
    s_mov_b32 s15, 0x20000
    s_mov_b32 s18, 0x400000
    s_mov_b32 s19, 0x20000
    s_mov_b32 s22, 0x400000
    s_mov_b32 s23, 0x20000
    s_mov_b32 s26, 0x2000
    s_mov_b32 s27, 0x20000
    s_mov_b32 s30, 0x400000
    s_mov_b32 s31, 0x20000
    s_mov_b32 s62, 0x200000
    s_mov_b32 s63, 0x20000
    s_mov_b32 s66, 0x400000
    s_mov_b32 s67, 0x20000
    s_mov_b32 s70, 0x800000
    s_mov_b32 s71, 0x20000
    s_mov_b32 s74, 0x100
    s_mov_b32 s75, 0x20000
    v_mov_b32 v251, 158208
    v_mov_b32 v240, 0x80000000
    s_and_b32 s58, s35, 3
    v_lshrrev_b32 v24, 3, v0
    v_and_b32 v25, 7, v0
    s_lshl_b32 s80, s35, 6
    s_lshl_b32 s81, s3, 2
    s_add_u32 s81, s81, s44
    s_lshl_b32 s81, s81, 5
    v_lshlrev_b32 v24, 3, v24
    v_add_u32 v24, s80, v24
    v_lshlrev_b32 v25, 2, v25
    v_add_u32 v25, s81, v25
    v_lshlrev_b32 v174, 11, v24
    v_lshl_add_u32 v174, v25, 1, v174
    s_mov_b32 s50, 4096
    s_mov_b32 s51, 8192
    s_mov_b32 s52, 12288
    v_subrev_u32 v175, 6144, v174
    v_mov_b32 v26, 0x80000000
    v_cmp_gt_u32 vcc, 3, v24
    v_lshlrev_b32 v177, 12, v25
    v_sub_u32 v24, 2040, v24
    v_cndmask_b32 v175, v175, v26, vcc
    v_lshlrev_b32 v176, 3, v25
    v_lshl_add_u32 v177, v24, 1, v177
    s_lshl_b32 s80, s84, 2
    s_add_u32 s80, s80, s44
    s_lshl_b32 s80, s80, 11
    v_lshlrev_b32 v179, 5, v0
    v_add_u32 v179, s80, v179
    s_lshl_b32 s87, s84, 2
    s_add_u32 s87, s87, s44
    s_lshl_b32 s87, s87, 12
    s_add_u32 m0, s43, 81920
    s_add_u32 s42, s56, 1
    s_and_b32 s42, s42, 3
    s_mul_i32 s42, s42, 393216
    buffer_load_dwordx4 v6, s[8:11], s42 offen offset:0  lds
    buffer_load_dwordx4 v7, s[8:11], s42 offen offset:1024  lds
    buffer_load_dwordx4 v8, s[8:11], s42 offen offset:2048  lds
    buffer_load_dwordx4 v9, s[8:11], s42 offen offset:3072  lds
    s_add_u32 m0, s43, 86016
    s_nop 0
    buffer_load_dwordx4 v10, s[8:11], s42 offen offset:0  lds
    buffer_load_dwordx4 v11, s[8:11], s42 offen offset:1024  lds
    s_waitcnt vmcnt(10)
    s_barrier
    s_add_u32 m0, s45, 0
    s_add_u32 s42, s56, 2
    s_and_b32 s42, s42, 3
    s_lshl_b32 s42, s42, 7
    buffer_load_dwordx4 v2, s[4:7], s42 offen offset:0  lds
    buffer_load_dwordx4 v3, s[4:7], s42 offen offset:1024  lds
    buffer_load_dwordx4 v4, s[4:7], s42 offen offset:2048  lds
    buffer_load_dwordx4 v5, s[4:7], s42 offen offset:3072  lds
    buffer_load_dwordx4 v[162:165], v176, s[24:27], 0 offen
    buffer_load_dwordx4 v[166:169], v176, s[24:27], 0 offen offset:16
    buffer_load_dwordx2 v[124:125], v175, s[16:19], 0 offen offset:0
    buffer_load_dwordx2 v[126:127], v175, s[16:19], 0 offen offset:2048
    buffer_load_dwordx2 v[128:129], v175, s[16:19], s50 offen offset:0
    buffer_load_dwordx2 v[130:131], v174, s[16:19], 0 offen offset:0
    buffer_load_dwordx2 v[132:133], v174, s[16:19], 0 offen offset:2048
    s_add_u32 m0, s43, 0
    s_add_u32 s42, s56, 2
    s_and_b32 s42, s42, 3
    s_mul_i32 s42, s42, 393216
    buffer_load_dwordx4 v6, s[8:11], s42 offen offset:0  lds
    buffer_load_dwordx4 v7, s[8:11], s42 offen offset:1024  lds
    buffer_load_dwordx4 v8, s[8:11], s42 offen offset:2048  lds
    buffer_load_dwordx4 v9, s[8:11], s42 offen offset:3072  lds
    s_add_u32 m0, s43, 4096
    s_nop 0
    buffer_load_dwordx4 v10, s[8:11], s42 offen offset:0  lds
    buffer_load_dwordx4 v11, s[8:11], s42 offen offset:1024  lds
    s_buffer_load_dword s57, s[28:31], s87
    s_mul_i32 s88, s44, 8320
    s_add_u32 s88, s88, 124928
    s_mul_i32 s86, s44, 4608
    s_add_u32 s86, s86, 98176
    s_lshl_b32 s80, s35, 2
    s_add_u32 s80, s80, s44
    s_lshl_b32 s80, s80, 6
    v_add_u32 v20, s80, v0
    v_lshrrev_b32 v241, 3, v20
    v_lshlrev_b32 v241, 11, v241
    v_and_b32 v20, 7, v20
    v_lshl_add_u32 v241, v20, 7, v241
    s_lshr_b32 s80, s3, 2
    s_lshl_b32 s80, s80, 10
    v_add_u32 v241, s80, v241
    s_lshl_b32 s80, s35, 6
    s_lshl_b32 s81, s44, 4
    s_add_u32 s80, s80, s81
    v_lshrrev_b32 v20, 1, v0
    v_add_u32 v20, s80, v20
    v_lshlrev_b32 v20, 11, v20
    v_and_b32 v21, 1, v0
    v_lshl_add_u32 v20, v21, 7, v20
    s_lshl_b32 s80, s3, 8
    v_add_u32 v20, s80, v20
    v_lshlrev_b32 v21, 7, v0
    v_cmp_gt_u32 vcc, 32, v0
    s_nop 1
    v_cndmask_b32 v242, v240, v20, vcc
    v_cndmask_b32 v243, v240, v21, vcc
    v_lshrrev_b32 v20, 4, v0
    v_and_b32 v21, 15, v0
    s_lshl_b32 s80, s35, 6
    s_and_b32 s81, s44, 1
    s_lshl_b32 s81, s81, 5
    s_add_u32 s80, s80, s81
    s_lshl_b32 s81, s3, 2
    s_waitcnt vmcnt(17)
    s_barrier
    s_add_u32 m0, s45, 40960
    s_add_u32 s42, s56, 3
    s_and_b32 s42, s42, 3
    s_lshl_b32 s42, s42, 7
    buffer_load_dwordx4 v2, s[4:7], s42 offen offset:0  lds
    buffer_load_dwordx4 v3, s[4:7], s42 offen offset:1024  lds
    buffer_load_dwordx4 v4, s[4:7], s42 offen offset:2048  lds
    buffer_load_dwordx4 v5, s[4:7], s42 offen offset:3072  lds
    s_add_u32 m0, s43, 40960
    s_add_u32 s42, s56, 3
    s_and_b32 s42, s42, 3
    s_mul_i32 s42, s42, 393216
    buffer_load_dwordx4 v6, s[8:11], s42 offen offset:0  lds
    buffer_load_dwordx4 v7, s[8:11], s42 offen offset:1024  lds
    buffer_load_dwordx4 v8, s[8:11], s42 offen offset:2048  lds
    buffer_load_dwordx4 v9, s[8:11], s42 offen offset:3072  lds
    s_add_u32 m0, s43, 45056
    s_nop 0
    buffer_load_dwordx4 v10, s[8:11], s42 offen offset:0  lds
    buffer_load_dwordx4 v11, s[8:11], s42 offen offset:1024  lds
    buffer_load_dwordx2 v[134:135], v174, s[16:19], s50 offen offset:0
    buffer_load_dwordx2 v[136:137], v174, s[16:19], s50 offen offset:2048
    buffer_load_dwordx2 v[138:139], v174, s[16:19], s51 offen offset:0
    buffer_load_dwordx2 v[140:141], v174, s[16:19], s51 offen offset:2048
    buffer_load_dwordx2 v[142:143], v174, s[16:19], s52 offen offset:0
    buffer_load_dwordx2 v[144:145], v174, s[16:19], s52 offen offset:2048
    buffer_load_dwordx2 v[146:147], v174, s[20:23], 0 offen offset:0
    s_add_u32 m0, s45, 122880
    s_add_u32 s42, s56, 4
    s_and_b32 s42, s42, 3
    s_add_u32 s42, s42, 4
    s_lshl_b32 s42, s42, 7
    buffer_load_dwordx4 v2, s[4:7], s42 offen offset:0  lds
    buffer_load_dwordx4 v3, s[4:7], s42 offen offset:1024  lds
    buffer_load_dwordx4 v4, s[4:7], s42 offen offset:2048  lds
    buffer_load_dwordx4 v5, s[4:7], s42 offen offset:3072  lds
    s_waitcnt vmcnt(21)
    s_barrier
    s_add_u32 m0, s43, 122880
    s_add_u32 s42, s56, 4
    s_and_b32 s42, s42, 3
    s_add_u32 s42, s42, 4
    s_mul_i32 s42, s42, 393216
    buffer_load_dwordx4 v6, s[8:11], s42 offen offset:0  lds
    buffer_load_dwordx4 v7, s[8:11], s42 offen offset:1024  lds
    buffer_load_dwordx4 v8, s[8:11], s42 offen offset:2048  lds
    buffer_load_dwordx4 v9, s[8:11], s42 offen offset:3072  lds
    s_add_u32 m0, s43, 126976
    s_nop 0
    buffer_load_dwordx4 v10, s[8:11], s42 offen offset:0  lds
    buffer_load_dwordx4 v11, s[8:11], s42 offen offset:1024  lds
    s_add_u32 m0, s45, 81920
    s_add_u32 s42, s56, 5
    s_and_b32 s42, s42, 3
    s_add_u32 s42, s42, 4
    s_lshl_b32 s42, s42, 7
    buffer_load_dwordx4 v2, s[4:7], s42 offen offset:0  lds
    buffer_load_dwordx4 v3, s[4:7], s42 offen offset:1024  lds
    buffer_load_dwordx4 v4, s[4:7], s42 offen offset:2048  lds
    buffer_load_dwordx4 v5, s[4:7], s42 offen offset:3072  lds
    s_add_u32 m0, s43, 81920
    s_add_u32 s42, s56, 5
    s_and_b32 s42, s42, 3
    s_add_u32 s42, s42, 4
    s_mul_i32 s42, s42, 393216
    buffer_load_dwordx4 v6, s[8:11], s42 offen offset:0  lds
    buffer_load_dwordx4 v7, s[8:11], s42 offen offset:1024  lds
    buffer_load_dwordx4 v8, s[8:11], s42 offen offset:2048  lds
    buffer_load_dwordx4 v9, s[8:11], s42 offen offset:3072  lds
    s_add_u32 m0, s43, 86016
    s_nop 0
    buffer_load_dwordx4 v10, s[8:11], s42 offen offset:0  lds
    buffer_load_dwordx4 v11, s[8:11], s42 offen offset:1024  lds
    buffer_load_dwordx2 v[148:149], v174, s[20:23], 0 offen offset:2048
    buffer_load_dwordx2 v[150:151], v174, s[20:23], s50 offen offset:0
    buffer_load_dwordx2 v[152:153], v174, s[20:23], s50 offen offset:2048
    buffer_load_dwordx2 v[154:155], v174, s[20:23], s51 offen offset:0
    buffer_load_dwordx2 v[156:157], v174, s[20:23], s51 offen offset:2048
    buffer_load_dwordx2 v[158:159], v174, s[20:23], s52 offen offset:0
    buffer_load_dwordx2 v[160:161], v174, s[20:23], s52 offen offset:2048
    s_add_u32 s81, s81, s44
    s_andn2_b32 s81, s81, 1
    s_lshl_b32 s81, s81, 5
    v_lshlrev_b32 v22, 3, v20
    v_add_u32 v22, s80, v22
    v_lshlrev_b32 v23, 2, v21
    v_add_u32 v23, s81, v23
    v_lshlrev_b32 v216, 12, v23
    v_lshl_add_u32 v216, v22, 1, v216
    v_lshlrev_b32 v217, 11, v22
    v_lshl_add_u32 v217, v23, 1, v217
    v_lshlrev_b32 v218, 12, v22
    v_lshl_add_u32 v218, v23, 1, v218
    v_bfe_u32 v20, v0, 2, 4
    s_lshl_b32 s80, s44, 3
    s_and_b32 s80, s80, 16
    v_add_u32 v20, s80, v20
    v_lshlrev_b32 v20, 3, v20
    v_add_u32 v20, s3, v20
    v_lshlrev_b32 v20, 7, v20
    v_and_b32 v21, 3, v0
    v_lshl_add_u32 v20, v21, 3, v20
    v_add_u32 v219, 0x1810020, v20
    s_and_b32 s40, s44, 1
    s_lshr_b32 s41, s44, 1
    s_waitcnt lgkmcnt(0)
    s_lshl_b32 s80, s44, 4
    s_lshr_b64 s[38:39], s[76:77], s80
    s_lshl_b32 s39, s38, 16
    s_lshl_b32 s57, s57, 16
    s_lshl_b32 s40, s40, 1
    s_add_u32 s40, s40, 1
    v_and_b32 v192, 31, v0
    v_lshlrev_b32 v192, 3, v192
    v_add_u32 v192, s3, v192
    v_lshlrev_b32 v192, 7, v192
    s_lshr_b32 s80, s35, 3
    s_lshl_b32 s80, s80, 3
    s_add_u32 s80, s80, 0x1800020
    v_add_u32 v192, s80, v192
    s_lshl_b32 s80, s44, 11
    s_add_u32 s80, s80, 98304
    v_add_u32 v193, s80, v1
    v_lshlrev_b32 v180, 3, v0
    s_waitcnt vmcnt(34)
    s_barrier
    s_add_u32 m0, s45, 0
    s_add_u32 s42, s56, 6
    s_and_b32 s42, s42, 3
    s_add_u32 s42, s42, 4
    s_lshl_b32 s42, s42, 7
    buffer_load_dwordx4 v2, s[4:7], s42 offen offset:0  lds
    buffer_load_dwordx4 v3, s[4:7], s42 offen offset:1024  lds
    buffer_load_dwordx4 v4, s[4:7], s42 offen offset:2048  lds
    buffer_load_dwordx4 v5, s[4:7], s42 offen offset:3072  lds
    s_add_u32 m0, s43, 0
    s_add_u32 s42, s56, 6
    s_and_b32 s42, s42, 3
    s_add_u32 s42, s42, 4
    s_mul_i32 s42, s42, 393216
    buffer_load_dwordx4 v6, s[8:11], s42 offen offset:0  lds
    buffer_load_dwordx4 v7, s[8:11], s42 offen offset:1024  lds
    buffer_load_dwordx4 v8, s[8:11], s42 offen offset:2048  lds
    buffer_load_dwordx4 v9, s[8:11], s42 offen offset:3072  lds
    s_add_u32 m0, s43, 4096
    s_nop 0
    buffer_load_dwordx4 v10, s[8:11], s42 offen offset:0  lds
    buffer_load_dwordx4 v11, s[8:11], s42 offen offset:1024  lds
    v_add_u32 v180, s86, v180
    v_and_b32 v181, 1, v0
    v_mul_u32_u24 v181, 4160, v181
    v_bfe_u32 v182, v0, 1, 1
    v_lshl_add_u32 v181, v182, 4, v181
    v_add_u32 v181, s88, v181
    v_mov_b32 v182, s88
    v_mov_b32 v183, s57
    v_mov_b32 v184, 0
    v_mov_b32 v185, 0
    v_mov_b32 v186, 0
    v_mov_b32 v187, 0
    s_waitcnt vmcnt(27)
    s_barrier
    s_add_u32 m0, s45, 40960
    s_add_u32 s42, s56, 7
    s_and_b32 s42, s42, 3
    s_add_u32 s42, s42, 4
    s_lshl_b32 s42, s42, 7
    buffer_load_dwordx4 v2, s[4:7], s42 offen offset:0  lds
    buffer_load_dwordx4 v3, s[4:7], s42 offen offset:1024  lds
    buffer_load_dwordx4 v4, s[4:7], s42 offen offset:2048  lds
    buffer_load_dwordx4 v5, s[4:7], s42 offen offset:3072  lds
    s_add_u32 m0, s43, 40960
    s_add_u32 s42, s56, 7
    s_and_b32 s42, s42, 3
    s_add_u32 s42, s42, 4
    s_mul_i32 s42, s42, 393216
    buffer_load_dwordx4 v6, s[8:11], s42 offen offset:0  lds
    buffer_load_dwordx4 v7, s[8:11], s42 offen offset:1024  lds
    buffer_load_dwordx4 v8, s[8:11], s42 offen offset:2048  lds
    buffer_load_dwordx4 v9, s[8:11], s42 offen offset:3072  lds
    s_add_u32 m0, s43, 45056
    s_nop 0
    buffer_load_dwordx4 v10, s[8:11], s42 offen offset:0  lds
    buffer_load_dwordx4 v11, s[8:11], s42 offen offset:1024  lds
    buffer_load_dwordx2 v[172:173], v252, s[72:75], 0 offen sc1
    s_waitcnt vmcnt(28)
    s_barrier
    s_add_u32 m0, s45, 122880
    s_add_u32 s42, s56, 8
    s_and_b32 s42, s42, 3
    s_add_u32 s42, s42, 8
    s_lshl_b32 s42, s42, 7
    buffer_load_dwordx4 v2, s[4:7], s42 offen offset:0  lds
    buffer_load_dwordx4 v3, s[4:7], s42 offen offset:1024  lds
    buffer_load_dwordx4 v4, s[4:7], s42 offen offset:2048  lds
    buffer_load_dwordx4 v5, s[4:7], s42 offen offset:3072  lds
    s_add_u32 m0, s43, 122880
    s_add_u32 s42, s56, 8
    s_and_b32 s42, s42, 3
    s_add_u32 s42, s42, 8
    s_mul_i32 s42, s42, 393216
    buffer_load_dwordx4 v6, s[8:11], s42 offen offset:0  lds
    buffer_load_dwordx4 v7, s[8:11], s42 offen offset:1024  lds
    buffer_load_dwordx4 v8, s[8:11], s42 offen offset:2048  lds
    buffer_load_dwordx4 v9, s[8:11], s42 offen offset:3072  lds
    s_add_u32 m0, s43, 126976
    s_nop 0
    buffer_load_dwordx4 v10, s[8:11], s42 offen offset:0  lds
    buffer_load_dwordx4 v11, s[8:11], s42 offen offset:1024  lds
    buffer_load_dword v246, v243, s[28:31], s87 offen
    s_waitcnt vmcnt(32)
    v_lshlrev_b32 v56, 16, v162
    v_and_b32 v57, 0xffff0000, v162
    v_lshlrev_b32 v58, 16, v163
    v_and_b32 v59, 0xffff0000, v163
    v_lshlrev_b32 v60, 16, v164
    v_and_b32 v61, 0xffff0000, v164
    v_lshlrev_b32 v62, 16, v165
    v_and_b32 v63, 0xffff0000, v165
    v_lshlrev_b32 v64, 16, v166
    v_and_b32 v65, 0xffff0000, v166
    v_lshlrev_b32 v66, 16, v167
    v_and_b32 v67, 0xffff0000, v167
    v_lshlrev_b32 v68, 16, v168
    v_and_b32 v69, 0xffff0000, v168
    v_lshlrev_b32 v70, 16, v169
    v_and_b32 v71, 0xffff0000, v169
    v_lshlrev_b32 v12, 16, v124
    v_and_b32 v13, 0xffff0000, v124
    v_lshlrev_b32 v14, 16, v125
    v_and_b32 v15, 0xffff0000, v125
    v_lshlrev_b32 v16, 16, v126
    v_and_b32 v17, 0xffff0000, v126
    v_lshlrev_b32 v18, 16, v127
    v_and_b32 v19, 0xffff0000, v127
    v_lshlrev_b32 v20, 16, v128
    v_and_b32 v21, 0xffff0000, v128
    v_lshlrev_b32 v22, 16, v129
    v_and_b32 v23, 0xffff0000, v129
    v_lshlrev_b32 v24, 16, v130
    v_and_b32 v25, 0xffff0000, v130
    v_lshlrev_b32 v26, 16, v131
    v_and_b32 v27, 0xffff0000, v131
    v_lshlrev_b32 v28, 16, v132
    v_and_b32 v29, 0xffff0000, v132
    v_lshlrev_b32 v30, 16, v133
    v_and_b32 v31, 0xffff0000, v133
    v_lshlrev_b32 v32, 16, v134
    v_and_b32 v33, 0xffff0000, v134
    v_lshlrev_b32 v34, 16, v135
    v_and_b32 v35, 0xffff0000, v135
    v_lshlrev_b32 v36, 16, v136
    v_and_b32 v37, 0xffff0000, v136
    v_lshlrev_b32 v38, 16, v137
    v_and_b32 v39, 0xffff0000, v137
    v_lshlrev_b32 v40, 16, v138
    v_and_b32 v41, 0xffff0000, v138
    v_lshlrev_b32 v42, 16, v139
    v_and_b32 v43, 0xffff0000, v139
    v_lshlrev_b32 v44, 16, v140
    v_and_b32 v45, 0xffff0000, v140
    v_lshlrev_b32 v46, 16, v141
    v_and_b32 v47, 0xffff0000, v141
    v_lshlrev_b32 v48, 16, v142
    v_and_b32 v49, 0xffff0000, v142
    v_lshlrev_b32 v50, 16, v143
    v_and_b32 v51, 0xffff0000, v143
    v_lshlrev_b32 v52, 16, v144
    v_and_b32 v53, 0xffff0000, v144
    v_lshlrev_b32 v54, 16, v145
    v_and_b32 v55, 0xffff0000, v145
    v_mul_f32 v72, v24, v56
    v_fmac_f32 v72, v20, v57
    v_fmac_f32 v72, v16, v58
    v_fmac_f32 v72, v12, v59
    v_mul_f32 v73, v25, v60
    v_fmac_f32 v73, v21, v61
    v_fmac_f32 v73, v17, v62
    v_fmac_f32 v73, v13, v63
    v_mul_f32 v74, v26, v64
    v_fmac_f32 v74, v22, v65
    v_fmac_f32 v74, v18, v66
    v_fmac_f32 v74, v14, v67
    v_mul_f32 v75, v27, v68
    v_fmac_f32 v75, v23, v69
    v_fmac_f32 v75, v19, v70
    v_fmac_f32 v75, v15, v71
    v_mul_f32 v76, v28, v56
    v_fmac_f32 v76, v24, v57
    v_fmac_f32 v76, v20, v58
    v_fmac_f32 v76, v16, v59
    v_mul_f32 v77, v29, v60
    v_fmac_f32 v77, v25, v61
    v_fmac_f32 v77, v21, v62
    v_fmac_f32 v77, v17, v63
    v_mul_f32 v78, v30, v64
    v_fmac_f32 v78, v26, v65
    v_fmac_f32 v78, v22, v66
    v_fmac_f32 v78, v18, v67
    v_mul_f32 v79, v31, v68
    v_fmac_f32 v79, v27, v69
    v_fmac_f32 v79, v23, v70
    v_fmac_f32 v79, v19, v71
    v_mul_f32 v80, v32, v56
    v_fmac_f32 v80, v28, v57
    v_fmac_f32 v80, v24, v58
    s_waitcnt vmcnt(22)
    s_barrier
    s_add_u32 m0, s45, 81920
    s_add_u32 s42, s56, 9
    s_and_b32 s42, s42, 3
    s_add_u32 s42, s42, 8
    s_lshl_b32 s42, s42, 7
    buffer_load_dwordx4 v2, s[4:7], s42 offen offset:0  lds
    buffer_load_dwordx4 v3, s[4:7], s42 offen offset:1024  lds
    buffer_load_dwordx4 v4, s[4:7], s42 offen offset:2048  lds
    buffer_load_dwordx4 v5, s[4:7], s42 offen offset:3072  lds
    s_add_u32 m0, s43, 81920
    s_add_u32 s42, s56, 9
    s_and_b32 s42, s42, 3
    s_add_u32 s42, s42, 8
    s_mul_i32 s42, s42, 393216
    buffer_load_dwordx4 v6, s[8:11], s42 offen offset:0  lds
    buffer_load_dwordx4 v7, s[8:11], s42 offen offset:1024  lds
    buffer_load_dwordx4 v8, s[8:11], s42 offen offset:2048  lds
    buffer_load_dwordx4 v9, s[8:11], s42 offen offset:3072  lds
    s_add_u32 m0, s43, 86016
    s_nop 0
    buffer_load_dwordx4 v10, s[8:11], s42 offen offset:0  lds
    buffer_load_dwordx4 v11, s[8:11], s42 offen offset:1024  lds
    v_fmac_f32 v80, v20, v59
    v_mul_f32 v81, v33, v60
    v_fmac_f32 v81, v29, v61
    v_fmac_f32 v81, v25, v62
    v_fmac_f32 v81, v21, v63
    v_mul_f32 v82, v34, v64
    v_fmac_f32 v82, v30, v65
    v_fmac_f32 v82, v26, v66
    v_fmac_f32 v82, v22, v67
    v_mul_f32 v83, v35, v68
    v_fmac_f32 v83, v31, v69
    v_fmac_f32 v83, v27, v70
    v_fmac_f32 v83, v23, v71
    v_mul_f32 v84, v36, v56
    v_fmac_f32 v84, v32, v57
    v_fmac_f32 v84, v28, v58
    v_fmac_f32 v84, v24, v59
    v_mul_f32 v85, v37, v60
    v_fmac_f32 v85, v33, v61
    v_fmac_f32 v85, v29, v62
    v_fmac_f32 v85, v25, v63
    v_mul_f32 v86, v38, v64
    v_fmac_f32 v86, v34, v65
    v_fmac_f32 v86, v30, v66
    v_fmac_f32 v86, v26, v67
    v_mul_f32 v87, v39, v68
    v_fmac_f32 v87, v35, v69
    v_fmac_f32 v87, v31, v70
    v_fmac_f32 v87, v27, v71
    v_mul_f32 v88, v40, v56
    v_fmac_f32 v88, v36, v57
    v_fmac_f32 v88, v32, v58
    v_fmac_f32 v88, v28, v59
    v_mul_f32 v89, v41, v60
    v_fmac_f32 v89, v37, v61
    v_fmac_f32 v89, v33, v62
    v_fmac_f32 v89, v29, v63
    v_mul_f32 v90, v42, v64
    v_fmac_f32 v90, v38, v65
    v_fmac_f32 v90, v34, v66
    v_fmac_f32 v90, v30, v67
    v_mul_f32 v91, v43, v68
    v_fmac_f32 v91, v39, v69
    v_fmac_f32 v91, v35, v70
    v_fmac_f32 v91, v31, v71
    v_mul_f32 v92, v44, v56
    v_fmac_f32 v92, v40, v57
    v_fmac_f32 v92, v36, v58
    v_fmac_f32 v92, v32, v59
    v_mul_f32 v93, v45, v60
    v_fmac_f32 v93, v41, v61
    v_fmac_f32 v93, v37, v62
    v_fmac_f32 v93, v33, v63
    v_mul_f32 v94, v46, v64
    v_fmac_f32 v94, v42, v65
    v_fmac_f32 v94, v38, v66
    v_fmac_f32 v94, v34, v67
    v_mul_f32 v95, v47, v68
    v_fmac_f32 v95, v43, v69
    v_fmac_f32 v95, v39, v70
    v_fmac_f32 v95, v35, v71
    v_mul_f32 v96, v48, v56
    v_fmac_f32 v96, v44, v57
    v_fmac_f32 v96, v40, v58
    v_fmac_f32 v96, v36, v59
    v_mul_f32 v97, v49, v60
    v_fmac_f32 v97, v45, v61
    v_fmac_f32 v97, v41, v62
    v_fmac_f32 v97, v37, v63
    v_mul_f32 v98, v50, v64
    v_fmac_f32 v98, v46, v65
    v_fmac_f32 v98, v42, v66
    v_fmac_f32 v98, v38, v67
    v_mul_f32 v99, v51, v68
    v_fmac_f32 v99, v47, v69
    v_fmac_f32 v99, v43, v70
    v_fmac_f32 v99, v39, v71
    v_mul_f32 v100, v52, v56
    v_fmac_f32 v100, v48, v57
    v_fmac_f32 v100, v44, v58
    v_fmac_f32 v100, v40, v59
    v_mul_f32 v101, v53, v60
    v_fmac_f32 v101, v49, v61
    v_fmac_f32 v101, v45, v62
    v_fmac_f32 v101, v41, v63
    v_mul_f32 v102, v54, v64
    v_fmac_f32 v102, v50, v65
    v_fmac_f32 v102, v46, v66
    v_fmac_f32 v102, v42, v67
    v_mul_f32 v103, v55, v68
    v_fmac_f32 v103, v51, v69
    v_fmac_f32 v103, v47, v70
    v_fmac_f32 v103, v43, v71
    v_lshlrev_b32 v104, 16, v146
    v_mul_f32 v72, v72, v104
    s_waitcnt vmcnt(22)
    s_barrier
    s_add_u32 m0, s45, 0
    s_add_u32 s42, s56, 10
    s_and_b32 s42, s42, 3
    s_add_u32 s42, s42, 8
    s_lshl_b32 s42, s42, 7
    buffer_load_dwordx4 v2, s[4:7], s42 offen offset:0  lds
    buffer_load_dwordx4 v3, s[4:7], s42 offen offset:1024  lds
    buffer_load_dwordx4 v4, s[4:7], s42 offen offset:2048  lds
    buffer_load_dwordx4 v5, s[4:7], s42 offen offset:3072  lds
    s_add_u32 m0, s43, 0
    s_add_u32 s42, s56, 10
    s_and_b32 s42, s42, 3
    s_add_u32 s42, s42, 8
    s_mul_i32 s42, s42, 393216
    buffer_load_dwordx4 v6, s[8:11], s42 offen offset:0  lds
    buffer_load_dwordx4 v7, s[8:11], s42 offen offset:1024  lds
    buffer_load_dwordx4 v8, s[8:11], s42 offen offset:2048  lds
    buffer_load_dwordx4 v9, s[8:11], s42 offen offset:3072  lds
    s_add_u32 m0, s43, 4096
    s_nop 0
    buffer_load_dwordx4 v10, s[8:11], s42 offen offset:0  lds
    buffer_load_dwordx4 v11, s[8:11], s42 offen offset:1024  lds
    v_and_b32 v105, 0xffff0000, v146
    v_mul_f32 v73, v73, v105
    v_lshlrev_b32 v104, 16, v147
    v_mul_f32 v74, v74, v104
    v_and_b32 v105, 0xffff0000, v147
    v_mul_f32 v75, v75, v105
    v_lshlrev_b32 v104, 16, v148
    v_mul_f32 v76, v76, v104
    v_and_b32 v105, 0xffff0000, v148
    v_mul_f32 v77, v77, v105
    v_lshlrev_b32 v104, 16, v149
    v_mul_f32 v78, v78, v104
    v_and_b32 v105, 0xffff0000, v149
    v_mul_f32 v79, v79, v105
    v_lshlrev_b32 v104, 16, v150
    v_mul_f32 v80, v80, v104
    v_and_b32 v105, 0xffff0000, v150
    v_mul_f32 v81, v81, v105
    v_lshlrev_b32 v104, 16, v151
    v_mul_f32 v82, v82, v104
    v_and_b32 v105, 0xffff0000, v151
    v_mul_f32 v83, v83, v105
    v_lshlrev_b32 v104, 16, v152
    v_mul_f32 v84, v84, v104
    v_and_b32 v105, 0xffff0000, v152
    v_mul_f32 v85, v85, v105
    v_lshlrev_b32 v104, 16, v153
    v_mul_f32 v86, v86, v104
    v_and_b32 v105, 0xffff0000, v153
    v_mul_f32 v87, v87, v105
    v_lshlrev_b32 v104, 16, v154
    v_mul_f32 v88, v88, v104
    v_and_b32 v105, 0xffff0000, v154
    v_mul_f32 v89, v89, v105
    v_lshlrev_b32 v104, 16, v155
    v_mul_f32 v90, v90, v104
    v_and_b32 v105, 0xffff0000, v155
    v_mul_f32 v91, v91, v105
    v_lshlrev_b32 v104, 16, v156
    v_mul_f32 v92, v92, v104
    v_and_b32 v105, 0xffff0000, v156
    v_mul_f32 v93, v93, v105
    v_lshlrev_b32 v104, 16, v157
    v_mul_f32 v94, v94, v104
    v_and_b32 v105, 0xffff0000, v157
    v_mul_f32 v95, v95, v105
    v_lshlrev_b32 v104, 16, v158
    v_mul_f32 v96, v96, v104
    v_and_b32 v105, 0xffff0000, v158
    v_mul_f32 v97, v97, v105
    v_lshlrev_b32 v104, 16, v159
    v_mul_f32 v98, v98, v104
    v_and_b32 v105, 0xffff0000, v159
    v_mul_f32 v99, v99, v105
    v_lshlrev_b32 v104, 16, v160
    v_mul_f32 v100, v100, v104
    v_and_b32 v105, 0xffff0000, v160
    v_mul_f32 v101, v101, v105
    v_lshlrev_b32 v104, 16, v161
    v_mul_f32 v102, v102, v104
    v_and_b32 v105, 0xffff0000, v161
    v_mul_f32 v103, v103, v105
    s_mov_b32 s53, 0xc00000
    v_cvt_pk_bf16_f32 v108, v100, v96
    v_cvt_pk_bf16_f32 v109, v92, v88
    v_cvt_pk_bf16_f32 v110, v84, v80
    v_cvt_pk_bf16_f32 v111, v76, v72
    buffer_store_dwordx4 v[108:111], v177, s[12:15], s53 offen sc1
    s_add_u32 s53, s53, 4096
    v_cvt_pk_bf16_f32 v112, v101, v97
    v_cvt_pk_bf16_f32 v113, v93, v89
    v_cvt_pk_bf16_f32 v114, v85, v81
    v_cvt_pk_bf16_f32 v115, v77, v73
    buffer_store_dwordx4 v[112:115], v177, s[12:15], s53 offen sc1
    s_add_u32 s53, s53, 4096
    v_cvt_pk_bf16_f32 v116, v102, v98
    v_cvt_pk_bf16_f32 v117, v94, v90
    v_cvt_pk_bf16_f32 v118, v86, v82
    v_cvt_pk_bf16_f32 v119, v78, v74
    buffer_store_dwordx4 v[116:119], v177, s[12:15], s53 offen sc1
    s_add_u32 s53, s53, 4096
    v_cvt_pk_bf16_f32 v120, v103, v99
    v_cvt_pk_bf16_f32 v121, v95, v91
    v_cvt_pk_bf16_f32 v122, v87, v83
    v_cvt_pk_bf16_f32 v123, v79, v75
    buffer_store_dwordx4 v[120:123], v177, s[12:15], s53 offen sc1
    s_waitcnt vmcnt(25)
    s_barrier
    s_add_u32 m0, s45, 40960
    s_add_u32 s42, s56, 11
    s_and_b32 s42, s42, 3
    s_add_u32 s42, s42, 8
    s_lshl_b32 s42, s42, 7
    buffer_load_dwordx4 v2, s[4:7], s42 offen offset:0  lds
    buffer_load_dwordx4 v3, s[4:7], s42 offen offset:1024  lds
    buffer_load_dwordx4 v4, s[4:7], s42 offen offset:2048  lds
    buffer_load_dwordx4 v5, s[4:7], s42 offen offset:3072  lds
    s_add_u32 m0, s43, 40960
    s_add_u32 s42, s56, 11
    s_and_b32 s42, s42, 3
    s_add_u32 s42, s42, 8
    s_mul_i32 s42, s42, 393216
    buffer_load_dwordx4 v6, s[8:11], s42 offen offset:0  lds
    buffer_load_dwordx4 v7, s[8:11], s42 offen offset:1024  lds
    buffer_load_dwordx4 v8, s[8:11], s42 offen offset:2048  lds
    buffer_load_dwordx4 v9, s[8:11], s42 offen offset:3072  lds
    s_add_u32 m0, s43, 45056
    s_nop 0
    buffer_load_dwordx4 v10, s[8:11], s42 offen offset:0  lds
    buffer_load_dwordx4 v11, s[8:11], s42 offen offset:1024  lds
    s_waitcnt vmcnt(24)
    s_barrier
    s_add_u32 m0, s45, 122880
    s_add_u32 s42, s56, 12
    s_and_b32 s42, s42, 3
    s_add_u32 s42, s42, 12
    s_lshl_b32 s42, s42, 7
    buffer_load_dwordx4 v2, s[4:7], s42 offen offset:0  lds
    buffer_load_dwordx4 v3, s[4:7], s42 offen offset:1024  lds
    buffer_load_dwordx4 v4, s[4:7], s42 offen offset:2048  lds
    buffer_load_dwordx4 v5, s[4:7], s42 offen offset:3072  lds
    s_add_u32 m0, s43, 122880
    s_add_u32 s42, s56, 12
    s_and_b32 s42, s42, 3
    s_add_u32 s42, s42, 12
    s_mul_i32 s42, s42, 393216
    buffer_load_dwordx4 v6, s[8:11], s42 offen offset:0  lds
    buffer_load_dwordx4 v7, s[8:11], s42 offen offset:1024  lds
    buffer_load_dwordx4 v8, s[8:11], s42 offen offset:2048  lds
    buffer_load_dwordx4 v9, s[8:11], s42 offen offset:3072  lds
    s_add_u32 m0, s43, 126976
    s_nop 0
    buffer_load_dwordx4 v10, s[8:11], s42 offen offset:0  lds
    buffer_load_dwordx4 v11, s[8:11], s42 offen offset:1024  lds
    buffer_load_dword v178, v179, s[60:63], 0 offen
    s_waitcnt vmcnt(21)
    s_mov_b32 s85, 0
L_tok_1:
    v_readfirstlane_b32 s78, v172
    v_readfirstlane_b32 s79, v173
    s_add_u32 s85, s85, 1
    s_cmp_lg_u64 s[78:79], 0
    s_cbranch_scc1 L_tokd_2
    buffer_load_dwordx2 v[172:173], v252, s[72:75], 0 offen sc1
    s_waitcnt vmcnt(0)
    s_cmp_lt_u32 s85, 0x40000
    s_cbranch_scc1 L_tok_1
L_tokd_2:
    s_add_u32 s80, s89, 0x1800000
    v_mov_b32 v194, s78
    v_mov_b32 v195, s79
    s_mov_b64 exec, 1
    buffer_store_dwordx2 v[194:195], v252, s[12:15], s80 offen sc1
    s_mov_b64 exec, -1
    s_waitcnt vmcnt(26)
    s_barrier
    s_add_u32 m0, s45, 81920
    s_add_u32 s42, s56, 13
    s_and_b32 s42, s42, 3
    s_add_u32 s42, s42, 12
    s_lshl_b32 s42, s42, 7
    buffer_load_dwordx4 v2, s[4:7], s42 offen offset:0  lds
    buffer_load_dwordx4 v3, s[4:7], s42 offen offset:1024  lds
    buffer_load_dwordx4 v4, s[4:7], s42 offen offset:2048  lds
    buffer_load_dwordx4 v5, s[4:7], s42 offen offset:3072  lds
    s_add_u32 m0, s43, 81920
    s_add_u32 s42, s56, 13
    s_and_b32 s42, s42, 3
    s_add_u32 s42, s42, 12
    s_mul_i32 s42, s42, 393216
    buffer_load_dwordx4 v6, s[8:11], s42 offen offset:0  lds
    buffer_load_dwordx4 v7, s[8:11], s42 offen offset:1024  lds
    buffer_load_dwordx4 v8, s[8:11], s42 offen offset:2048  lds
    buffer_load_dwordx4 v9, s[8:11], s42 offen offset:3072  lds
    s_add_u32 m0, s43, 86016
    s_nop 0
    buffer_load_dwordx4 v10, s[8:11], s42 offen offset:0  lds
    buffer_load_dwordx4 v11, s[8:11], s42 offen offset:1024  lds
    s_waitcnt vmcnt(22)
    s_barrier
    s_add_u32 m0, s45, 0
    s_add_u32 s42, s56, 14
    s_and_b32 s42, s42, 3
    s_add_u32 s42, s42, 12
    s_lshl_b32 s42, s42, 7
    buffer_load_dwordx4 v2, s[4:7], s42 offen offset:0  lds
    buffer_load_dwordx4 v3, s[4:7], s42 offen offset:1024  lds
    buffer_load_dwordx4 v4, s[4:7], s42 offen offset:2048  lds
    buffer_load_dwordx4 v5, s[4:7], s42 offen offset:3072  lds
    s_add_u32 m0, s43, 0
    s_add_u32 s42, s56, 14
    s_and_b32 s42, s42, 3
    s_add_u32 s42, s42, 12
    s_mul_i32 s42, s42, 393216
    buffer_load_dwordx4 v6, s[8:11], s42 offen offset:0  lds
    buffer_load_dwordx4 v7, s[8:11], s42 offen offset:1024  lds
    buffer_load_dwordx4 v8, s[8:11], s42 offen offset:2048  lds
    buffer_load_dwordx4 v9, s[8:11], s42 offen offset:3072  lds
    s_add_u32 m0, s43, 4096
    s_nop 0
    buffer_load_dwordx4 v10, s[8:11], s42 offen offset:0  lds
    buffer_load_dwordx4 v11, s[8:11], s42 offen offset:1024  lds
    s_waitcnt vmcnt(22)
    s_barrier
    s_add_u32 m0, s45, 40960
    s_add_u32 s42, s56, 15
    s_and_b32 s42, s42, 3
    s_add_u32 s42, s42, 12
    s_lshl_b32 s42, s42, 7
    buffer_load_dwordx4 v2, s[4:7], s42 offen offset:0  lds
    buffer_load_dwordx4 v3, s[4:7], s42 offen offset:1024  lds
    buffer_load_dwordx4 v4, s[4:7], s42 offen offset:2048  lds
    buffer_load_dwordx4 v5, s[4:7], s42 offen offset:3072  lds
    s_add_u32 m0, s43, 40960
    s_add_u32 s42, s56, 15
    s_and_b32 s42, s42, 3
    s_add_u32 s42, s42, 12
    s_mul_i32 s42, s42, 393216
    buffer_load_dwordx4 v6, s[8:11], s42 offen offset:0  lds
    buffer_load_dwordx4 v7, s[8:11], s42 offen offset:1024  lds
    buffer_load_dwordx4 v8, s[8:11], s42 offen offset:2048  lds
    buffer_load_dwordx4 v9, s[8:11], s42 offen offset:3072  lds
    s_add_u32 m0, s43, 45056
    s_nop 0
    buffer_load_dwordx4 v10, s[8:11], s42 offen offset:0  lds
    buffer_load_dwordx4 v11, s[8:11], s42 offen offset:1024  lds
    buffer_load_dwordx2 v[198:199], v192, s[12:15], 0 offen sc1
    s_waitcnt vmcnt(11)
    s_barrier
    ds_write_b128 v181, v[184:187]
    ds_write_b32 v182, v183 offset:4188
    s_add_u32 m0, s88, 32
    s_add_u32 s80, s87, 0
    buffer_load_dwordx4 v1, s[28:31], s80 offen offset:0  lds
    buffer_load_dwordx4 v1, s[28:31], s80 offen offset:1024  lds
    buffer_load_dwordx4 v1, s[28:31], s80 offen offset:2048  lds
    buffer_load_dwordx4 v1, s[28:31], s80 offen offset:3072  lds
    s_add_u32 m0, s88, 4192
    s_add_u32 s80, s87, 2
    buffer_load_dwordx4 v1, s[28:31], s80 offen offset:0  lds
    buffer_load_dwordx4 v1, s[28:31], s80 offen offset:1024  lds
    buffer_load_dwordx4 v1, s[28:31], s80 offen offset:2048  lds
    buffer_load_dwordx4 v1, s[28:31], s80 offen offset:3072  lds
    buffer_load_dword v248, v241, s[60:63], 0 offen
    s_waitcnt vmcnt(10)
    s_barrier
    ds_write_b64 v180, v[184:185] offset:12416
    s_waitcnt vmcnt(9)
    v_cmp_eq_u64 vcc, s[78:79], v[198:199]
    s_mov_b32 s38, 0
    s_nop 0
    s_cmp_eq_u32 vcc_lo, -1
    s_cbranch_scc0 L_urskip_3
    s_mov_b32 s38, 1
    s_add_u32 m0, s86, 8320
    s_add_u32 s80, s87, 0xc00000
    buffer_load_dwordx4 v1, s[12:15], s80 offen offset:0  lds
    buffer_load_dwordx4 v1, s[12:15], s80 offen offset:1024  lds
    buffer_load_dwordx4 v1, s[12:15], s80 offen offset:2048  lds
    buffer_load_dwordx4 v1, s[12:15], s80 offen offset:3072  lds
L_urskip_3:
    s_barrier
    s_cmp_eq_u32 s38, 1
    s_cbranch_scc1 L_urskip_4
    s_mov_b32 s80, 0xffffffff
    s_mov_b32 s81, 0x0
    s_mov_b32 s85, 0
L_pollc_6:
    s_waitcnt vmcnt(0)
    v_cmp_eq_u64 vcc, s[78:79], v[198:199]
    s_add_u32 s85, s85, 1
    s_and_b64 s[82:83], vcc, s[80:81]
    s_cmp_eq_u64 s[82:83], s[80:81]
    s_cbranch_scc1 L_polld_7
    buffer_load_dwordx2 v[198:199], v192, s[12:15], 0 offen sc1
    s_cmp_lt_u32 s85, 0x40000
    s_cbranch_scc1 L_pollc_6
    s_waitcnt vmcnt(0)
L_polld_7:
    s_add_u32 m0, s86, 8320
    s_add_u32 s80, s87, 0xc00000
    buffer_load_dwordx4 v1, s[12:15], s80 offen offset:0  lds
    buffer_load_dwordx4 v1, s[12:15], s80 offen offset:1024  lds
    buffer_load_dwordx4 v1, s[12:15], s80 offen offset:2048  lds
    buffer_load_dwordx4 v1, s[12:15], s80 offen offset:3072  lds
L_urskip_4:
    s_mov_b32 s46, s88
    s_add_u32 s36, s87, 0xc00000
    v_and_b32 v2, 15, v0
    v_lshrrev_b32 v3, 4, v0
    v_add_u32 v4, 1, v2
    v_and_b32 v5, 1, v4
    v_sub_u32 v4, v4, v5
    v_lshl_add_u32 v4, v3, 3, v4
    v_lshlrev_b32 v4, 1, v4
    v_mul_u32_u24 v5, 4160, v5
    v_add3_u32 v168, v4, v5, s46
    v_add_u32 v169, 1024, v168
    v_add_u32 v170, 2048, v168
    v_add_u32 v171, 3072, v168
    v_lshlrev_b32 v4, 5, v2
    v_lshlrev_b32 v5, 4, v3
    v_sub_u32 v172, v5, v4
    v_add_u32 v172, 8800, v172
    v_add_u32 v172, s86, v172
    v_lshlrev_b32 v5, 3, v3
    v_add_u32 v174, v4, v5
    v_sub_u32 v173, 8824, v174
    v_add_u32 v173, s86, v173
    s_waitcnt vmcnt(4) lgkmcnt(0)
    ds_read2_b32 v[40:41], v168 offset0:0 offset1:1
    ds_read2_b32 v[42:43], v168 offset0:2 offset1:3
    ds_read2_b32 v[44:45], v168 offset0:128 offset1:129
    ds_read2_b32 v[46:47], v168 offset0:130 offset1:131
    ds_read2_b32 v[48:49], v169 offset0:0 offset1:1
    ds_read2_b32 v[50:51], v169 offset0:2 offset1:3
    ds_read2_b32 v[52:53], v169 offset0:128 offset1:129
    ds_read2_b32 v[54:55], v169 offset0:130 offset1:131
    ds_read2_b32 v[56:57], v170 offset0:0 offset1:1
    ds_read2_b32 v[58:59], v170 offset0:2 offset1:3
    ds_read2_b32 v[60:61], v170 offset0:128 offset1:129
    ds_read2_b32 v[62:63], v170 offset0:130 offset1:131
    s_waitcnt lgkmcnt(6)
    ds_read2_b32 v[64:65], v171 offset0:0 offset1:1
    ds_read2_b32 v[66:67], v171 offset0:2 offset1:3
    ds_read2_b32 v[68:69], v171 offset0:128 offset1:129
    ds_read2_b32 v[70:71], v171 offset0:130 offset1:131
    s_waitcnt vmcnt(0) lgkmcnt(6)
    ds_read_b128 v[72:75], v172 offset:3584
    ds_read_b128 v[76:79], v172 offset:3072
    ds_read_b128 v[80:83], v172 offset:2560
    ds_read_b128 v[84:87], v172 offset:2048
    ds_read_b128 v[88:91], v172 offset:1536
    ds_read_b128 v[92:95], v172 offset:1024
    ds_read_b128 v[96:99], v172 offset:512
    ds_read_b128 v[100:103], v172 offset:0
    s_waitcnt lgkmcnt(0)
    s_setprio 1
    s_waitcnt lgkmcnt(0)
    v_mfma_f32_16x16x32_bf16 v[8:11], v[40:43], v[72:75], 0
    ds_read2_b32 v[104:105], v168 offset0:16 offset1:17
    v_mfma_f32_16x16x32_bf16 v[12:15], v[40:43], v[76:79], 0
    ds_read2_b32 v[106:107], v168 offset0:18 offset1:19
    v_mfma_f32_16x16x32_bf16 v[16:19], v[44:47], v[76:79], 0
    ds_read_b128 v[136:139], v172 offset:3648
    v_mfma_f32_16x16x32_bf16 v[20:23], v[44:47], v[80:83], 0
    ds_read2_b32 v[108:109], v168 offset0:144 offset1:145
    v_mfma_f32_16x16x32_bf16 v[12:15], v[44:47], v[72:75], v[12:15]
    ds_read2_b32 v[110:111], v168 offset0:146 offset1:147
    v_mfma_f32_16x16x32_bf16 v[16:19], v[40:43], v[80:83], v[16:19]
    ds_read_b128 v[140:143], v172 offset:3136
    v_mfma_f32_16x16x32_bf16 v[20:23], v[48:51], v[76:79], v[20:23]
    ds_read2_b32 v[112:113], v169 offset0:16 offset1:17
    v_mfma_f32_16x16x32_bf16 v[24:27], v[48:51], v[80:83], 0
    ds_read2_b32 v[114:115], v169 offset0:18 offset1:19
    v_mfma_f32_16x16x32_bf16 v[16:19], v[48:51], v[72:75], v[16:19]
    ds_read_b128 v[144:147], v172 offset:2624
    v_mfma_f32_16x16x32_bf16 v[20:23], v[40:43], v[84:87], v[20:23]
    ds_read2_b32 v[116:117], v169 offset0:144 offset1:145
    v_mfma_f32_16x16x32_bf16 v[24:27], v[44:47], v[84:87], v[24:27]
    ds_read2_b32 v[118:119], v169 offset0:146 offset1:147
    v_mfma_f32_16x16x32_bf16 v[28:31], v[48:51], v[84:87], 0
    ds_read_b128 v[148:151], v172 offset:2112
    v_mfma_f32_16x16x32_bf16 v[20:23], v[52:55], v[72:75], v[20:23]
    ds_read2_b32 v[120:121], v170 offset0:16 offset1:17
    v_mfma_f32_16x16x32_bf16 v[24:27], v[52:55], v[76:79], v[24:27]
    ds_read2_b32 v[122:123], v170 offset0:18 offset1:19
    v_mfma_f32_16x16x32_bf16 v[28:31], v[52:55], v[80:83], v[28:31]
    ds_read_b128 v[152:155], v172 offset:1600
    v_mfma_f32_16x16x32_bf16 v[32:35], v[52:55], v[84:87], 0
    ds_read2_b32 v[124:125], v170 offset0:144 offset1:145
    v_mfma_f32_16x16x32_bf16 v[24:27], v[40:43], v[88:91], v[24:27]
    ds_read2_b32 v[126:127], v170 offset0:146 offset1:147
    v_mfma_f32_16x16x32_bf16 v[28:31], v[44:47], v[88:91], v[28:31]
    ds_read_b128 v[156:159], v172 offset:1088
    v_mfma_f32_16x16x32_bf16 v[32:35], v[48:51], v[88:91], v[32:35]
    ds_read2_b32 v[128:129], v171 offset0:16 offset1:17
    v_mfma_f32_16x16x32_bf16 v[24:27], v[56:59], v[72:75], v[24:27]
    ds_read2_b32 v[130:131], v171 offset0:18 offset1:19
    v_mfma_f32_16x16x32_bf16 v[28:31], v[56:59], v[76:79], v[28:31]
    ds_read_b128 v[160:163], v172 offset:576
    v_mfma_f32_16x16x32_bf16 v[32:35], v[56:59], v[80:83], v[32:35]
    ds_read2_b32 v[132:133], v171 offset0:144 offset1:145
    v_mfma_f32_16x16x32_bf16 v[36:39], v[52:55], v[88:91], 0
    ds_read2_b32 v[134:135], v171 offset0:146 offset1:147
    v_mfma_f32_16x16x32_bf16 v[28:31], v[40:43], v[92:95], v[28:31]
    ds_read_b128 v[164:167], v172 offset:64
    v_mfma_f32_16x16x32_bf16 v[32:35], v[44:47], v[92:95], v[32:35]
    v_mfma_f32_16x16x32_bf16 v[36:39], v[56:59], v[84:87], v[36:39]
    v_mfma_f32_16x16x32_bf16 v[28:31], v[60:63], v[72:75], v[28:31]
    v_mfma_f32_16x16x32_bf16 v[32:35], v[60:63], v[76:79], v[32:35]
    v_mfma_f32_16x16x32_bf16 v[36:39], v[48:51], v[92:95], v[36:39]
    v_mfma_f32_16x16x32_bf16 v[36:39], v[60:63], v[80:83], v[36:39]
    v_mfma_f32_16x16x32_bf16 v[32:35], v[40:43], v[96:99], v[32:35]
    v_mfma_f32_16x16x32_bf16 v[32:35], v[64:67], v[72:75], v[32:35]
    v_mfma_f32_16x16x32_bf16 v[36:39], v[44:47], v[96:99], v[36:39]
    v_mfma_f32_16x16x32_bf16 v[36:39], v[64:67], v[76:79], v[36:39]
    v_mfma_f32_16x16x32_bf16 v[36:39], v[40:43], v[100:103], v[36:39]
    v_mfma_f32_16x16x32_bf16 v[36:39], v[68:71], v[72:75], v[36:39]
    s_waitcnt lgkmcnt(0)
    v_mfma_f32_16x16x32_bf16 v[8:11], v[104:107], v[136:139], v[8:11]
    ds_read2_b32 v[40:41], v168 offset0:32 offset1:33
    v_and_b32 v4, 31, v0
    v_mfma_f32_16x16x32_bf16 v[12:15], v[104:107], v[140:143], v[12:15]
    ds_read2_b32 v[42:43], v168 offset0:34 offset1:35
    v_lshrrev_b32 v5, 5, v0
    v_mfma_f32_16x16x32_bf16 v[16:19], v[108:111], v[140:143], v[16:19]
    ds_read_b128 v[72:75], v172 offset:3712
    v_lshlrev_b32 v5, 2, v5
    v_mfma_f32_16x16x32_bf16 v[20:23], v[108:111], v[144:147], v[20:23]
    ds_read2_b32 v[44:45], v168 offset0:160 offset1:161
    v_sub_u32 v4, v4, v5
    v_mfma_f32_16x16x32_bf16 v[12:15], v[108:111], v[136:139], v[12:15]
    ds_read2_b32 v[46:47], v168 offset0:162 offset1:163
    v_cmp_le_i32 s[4:5], 0, v4
    v_mfma_f32_16x16x32_bf16 v[16:19], v[104:107], v[144:147], v[16:19]
    ds_read_b128 v[76:79], v172 offset:3200
    v_cmp_le_i32 s[6:7], 1, v4
    v_mfma_f32_16x16x32_bf16 v[20:23], v[112:115], v[140:143], v[20:23]
    ds_read2_b32 v[48:49], v169 offset0:32 offset1:33
    v_cmp_le_i32 s[8:9], 2, v4
    v_mfma_f32_16x16x32_bf16 v[24:27], v[112:115], v[144:147], v[24:27]
    ds_read2_b32 v[50:51], v169 offset0:34 offset1:35
    v_cmp_le_i32 s[10:11], 3, v4
    v_mfma_f32_16x16x32_bf16 v[16:19], v[112:115], v[136:139], v[16:19]
    ds_read_b128 v[80:83], v172 offset:2688
    v_cmp_le_i32 s[16:17], 8, v4
    v_mfma_f32_16x16x32_bf16 v[20:23], v[104:107], v[148:151], v[20:23]
    ds_read2_b32 v[52:53], v169 offset0:160 offset1:161
    v_cmp_le_i32 s[18:19], 9, v4
    v_mfma_f32_16x16x32_bf16 v[24:27], v[108:111], v[148:151], v[24:27]
    ds_read2_b32 v[54:55], v169 offset0:162 offset1:163
    v_cmp_le_i32 s[20:21], 10, v4
    v_mfma_f32_16x16x32_bf16 v[28:31], v[112:115], v[148:151], v[28:31]
    ds_read_b128 v[84:87], v172 offset:2176
    v_cmp_le_i32 s[22:23], 11, v4
    v_mfma_f32_16x16x32_bf16 v[20:23], v[116:119], v[136:139], v[20:23]
    ds_read2_b32 v[56:57], v170 offset0:32 offset1:33
    v_cmp_le_i32 s[24:25], 16, v4
    v_mfma_f32_16x16x32_bf16 v[24:27], v[116:119], v[140:143], v[24:27]
    ds_read2_b32 v[58:59], v170 offset0:34 offset1:35
    v_cmp_le_i32 s[26:27], 17, v4
    v_mfma_f32_16x16x32_bf16 v[28:31], v[116:119], v[144:147], v[28:31]
    ds_read_b128 v[88:91], v172 offset:1664
    v_cmp_le_i32 s[48:49], 18, v4
    v_mfma_f32_16x16x32_bf16 v[32:35], v[116:119], v[148:151], v[32:35]
    ds_read2_b32 v[60:61], v170 offset0:160 offset1:161
    v_cmp_le_i32 s[50:51], 19, v4
    v_mfma_f32_16x16x32_bf16 v[24:27], v[104:107], v[152:155], v[24:27]
    ds_read2_b32 v[62:63], v170 offset0:162 offset1:163
    v_cmp_le_i32 s[52:53], 24, v4
    v_mfma_f32_16x16x32_bf16 v[28:31], v[108:111], v[152:155], v[28:31]
    ds_read_b128 v[92:95], v172 offset:1152
    v_cmp_le_i32 s[54:55], 25, v4
    v_mfma_f32_16x16x32_bf16 v[32:35], v[112:115], v[152:155], v[32:35]
    ds_read2_b32 v[64:65], v171 offset0:32 offset1:33
    v_cmp_le_i32 s[56:57], 26, v4
    v_mfma_f32_16x16x32_bf16 v[24:27], v[120:123], v[136:139], v[24:27]
    ds_read2_b32 v[66:67], v171 offset0:34 offset1:35
    v_cmp_le_i32 s[58:59], 27, v4
    v_mfma_f32_16x16x32_bf16 v[28:31], v[120:123], v[140:143], v[28:31]
    ds_read_b128 v[96:99], v172 offset:640
    v_mov_b32 v244, 0xf149f2ca
    v_mfma_f32_16x16x32_bf16 v[32:35], v[120:123], v[144:147], v[32:35]
    ds_read2_b32 v[68:69], v171 offset0:160 offset1:161
    v_mov_b32 v4, 0xffff
    v_mfma_f32_16x16x32_bf16 v[36:39], v[116:119], v[152:155], v[36:39]
    ds_read2_b32 v[70:71], v171 offset0:162 offset1:163
    v_mov_b32 v5, 0xffff0000
    v_mfma_f32_16x16x32_bf16 v[28:31], v[104:107], v[156:159], v[28:31]
    ds_read_b128 v[100:103], v172 offset:128
    v_cndmask_b32 v232, 0, v4, s[4:5]
    v_mfma_f32_16x16x32_bf16 v[32:35], v[108:111], v[156:159], v[32:35]
    v_cndmask_b32 v6, 0, v5, s[6:7]
    v_mfma_f32_16x16x32_bf16 v[36:39], v[120:123], v[148:151], v[36:39]
    v_or_b32 v232, v232, v6
    v_mfma_f32_16x16x32_bf16 v[28:31], v[124:127], v[136:139], v[28:31]
    v_cndmask_b32 v233, 0, v4, s[8:9]
    v_mfma_f32_16x16x32_bf16 v[32:35], v[124:127], v[140:143], v[32:35]
    v_cndmask_b32 v6, 0, v5, s[10:11]
    v_mfma_f32_16x16x32_bf16 v[36:39], v[112:115], v[156:159], v[36:39]
    v_or_b32 v233, v233, v6
    v_mfma_f32_16x16x32_bf16 v[36:39], v[124:127], v[144:147], v[36:39]
    v_cndmask_b32 v234, 0, v4, s[16:17]
    v_mfma_f32_16x16x32_bf16 v[32:35], v[104:107], v[160:163], v[32:35]
    v_cndmask_b32 v6, 0, v5, s[18:19]
    v_mfma_f32_16x16x32_bf16 v[32:35], v[128:131], v[136:139], v[32:35]
    v_or_b32 v234, v234, v6
    v_mfma_f32_16x16x32_bf16 v[36:39], v[108:111], v[160:163], v[36:39]
    v_cndmask_b32 v235, 0, v4, s[20:21]
    v_mfma_f32_16x16x32_bf16 v[36:39], v[128:131], v[140:143], v[36:39]
    v_cndmask_b32 v6, 0, v5, s[22:23]
    v_mfma_f32_16x16x32_bf16 v[36:39], v[104:107], v[164:167], v[36:39]
    v_or_b32 v235, v235, v6
    v_mfma_f32_16x16x32_bf16 v[36:39], v[132:135], v[136:139], v[36:39]
    v_cndmask_b32 v236, 0, v4, s[24:25]
    s_waitcnt lgkmcnt(0)
    v_mfma_f32_16x16x32_bf16 v[8:11], v[40:43], v[72:75], v[8:11]
    ds_read2_b32 v[104:105], v168 offset0:48 offset1:49
    v_cndmask_b32 v6, 0, v5, s[26:27]
    v_mfma_f32_16x16x32_bf16 v[12:15], v[40:43], v[76:79], v[12:15]
    ds_read2_b32 v[106:107], v168 offset0:50 offset1:51
    v_or_b32 v236, v236, v6
    v_mfma_f32_16x16x32_bf16 v[16:19], v[44:47], v[76:79], v[16:19]
    ds_read_b128 v[136:139], v172 offset:3776
    v_cndmask_b32 v237, 0, v4, s[48:49]
    v_mfma_f32_16x16x32_bf16 v[20:23], v[44:47], v[80:83], v[20:23]
    ds_read2_b32 v[108:109], v168 offset0:176 offset1:177
    v_cndmask_b32 v6, 0, v5, s[50:51]
    v_mfma_f32_16x16x32_bf16 v[12:15], v[44:47], v[72:75], v[12:15]
    ds_read2_b32 v[110:111], v168 offset0:178 offset1:179
    v_or_b32 v237, v237, v6
    v_mfma_f32_16x16x32_bf16 v[16:19], v[40:43], v[80:83], v[16:19]
    ds_read_b128 v[140:143], v172 offset:3264
    v_cndmask_b32 v238, 0, v4, s[52:53]
    v_mfma_f32_16x16x32_bf16 v[20:23], v[48:51], v[76:79], v[20:23]
    ds_read2_b32 v[112:113], v169 offset0:48 offset1:49
    v_cndmask_b32 v6, 0, v5, s[54:55]
    v_mfma_f32_16x16x32_bf16 v[24:27], v[48:51], v[80:83], v[24:27]
    ds_read2_b32 v[114:115], v169 offset0:50 offset1:51
    v_or_b32 v238, v238, v6
    v_mfma_f32_16x16x32_bf16 v[16:19], v[48:51], v[72:75], v[16:19]
    ds_read_b128 v[144:147], v172 offset:2752
    v_cndmask_b32 v239, 0, v4, s[56:57]
    v_mfma_f32_16x16x32_bf16 v[20:23], v[40:43], v[84:87], v[20:23]
    ds_read2_b32 v[116:117], v169 offset0:176 offset1:177
    v_cndmask_b32 v6, 0, v5, s[58:59]
    v_mfma_f32_16x16x32_bf16 v[24:27], v[44:47], v[84:87], v[24:27]
    ds_read2_b32 v[118:119], v169 offset0:178 offset1:179
    v_or_b32 v239, v239, v6
    v_mfma_f32_16x16x32_bf16 v[28:31], v[48:51], v[84:87], v[28:31]
    ds_read_b128 v[148:151], v172 offset:2240
    v_lshrrev_b32 v4, 4, v0
    v_mfma_f32_16x16x32_bf16 v[20:23], v[52:55], v[72:75], v[20:23]
    ds_read2_b32 v[120:121], v170 offset0:48 offset1:49
    v_lshrrev_b32 v5, 2, v0
    v_mfma_f32_16x16x32_bf16 v[24:27], v[52:55], v[76:79], v[24:27]
    ds_read2_b32 v[122:123], v170 offset0:50 offset1:51
    v_xor_b32 v4, v4, v5
    v_mfma_f32_16x16x32_bf16 v[28:31], v[52:55], v[80:83], v[28:31]
    ds_read_b128 v[152:155], v172 offset:1728
    v_and_b32 v4, 1, v4
    v_mfma_f32_16x16x32_bf16 v[32:35], v[52:55], v[84:87], v[32:35]
    ds_read2_b32 v[124:125], v170 offset0:176 offset1:177
    v_cmp_eq_u32 vcc, 0, v4
    v_mfma_f32_16x16x32_bf16 v[24:27], v[40:43], v[88:91], v[24:27]
    ds_read2_b32 v[126:127], v170 offset0:178 offset1:179
    v_mov_b32 v5, 0x3f803f80
    v_mfma_f32_16x16x32_bf16 v[28:31], v[44:47], v[88:91], v[28:31]
    ds_read_b128 v[156:159], v172 offset:1216
    v_cndmask_b32 v240, 0, v5, vcc
    v_mfma_f32_16x16x32_bf16 v[32:35], v[48:51], v[88:91], v[32:35]
    ds_read2_b32 v[128:129], v171 offset0:48 offset1:49
    v_cndmask_b32 v241, 0, v5, vcc
    v_mfma_f32_16x16x32_bf16 v[24:27], v[56:59], v[72:75], v[24:27]
    ds_read2_b32 v[130:131], v171 offset0:50 offset1:51
    v_cndmask_b32 v242, 0, v5, vcc
    v_mfma_f32_16x16x32_bf16 v[28:31], v[56:59], v[76:79], v[28:31]
    ds_read_b128 v[160:163], v172 offset:704
    v_cndmask_b32 v243, 0, v5, vcc
    v_mfma_f32_16x16x32_bf16 v[32:35], v[56:59], v[80:83], v[32:35]
    ds_read2_b32 v[132:133], v171 offset0:176 offset1:177
    s_mul_i32 s42, s41, 49152
    v_mfma_f32_16x16x32_bf16 v[36:39], v[52:55], v[88:91], v[36:39]
    ds_read2_b32 v[134:135], v171 offset0:178 offset1:179
    s_lshl_b32 s43, s40, 11
    v_mfma_f32_16x16x32_bf16 v[28:31], v[40:43], v[92:95], v[28:31]
    ds_read_b128 v[164:167], v172 offset:192
    s_add_u32 s42, s42, s43
    v_mfma_f32_16x16x32_bf16 v[32:35], v[44:47], v[92:95], v[32:35]
    v_add_u32 v245, s42, v1
    v_mfma_f32_16x16x32_bf16 v[36:39], v[56:59], v[84:87], v[36:39]
    s_lshl_b32 s45, s33, 2
    v_mfma_f32_16x16x32_bf16 v[28:31], v[60:63], v[72:75], v[28:31]
    s_add_u32 s45, s45, s40
    v_mfma_f32_16x16x32_bf16 v[32:35], v[60:63], v[76:79], v[32:35]
    s_sub_u32 s46, 8, s45
    v_mfma_f32_16x16x32_bf16 v[36:39], v[48:51], v[92:95], v[36:39]
    s_cmp_lt_u32 s45, 8
    v_mfma_f32_16x16x32_bf16 v[36:39], v[60:63], v[80:83], v[36:39]
    s_cselect_b32 s46, s46, 0
    v_mfma_f32_16x16x32_bf16 v[32:35], v[40:43], v[96:99], v[32:35]
    s_cselect_b32 s43, 0x4000, 0
    v_mfma_f32_16x16x32_bf16 v[32:35], v[64:67], v[72:75], v[32:35]
    v_add_u32 v246, s43, v245
    v_mfma_f32_16x16x32_bf16 v[36:39], v[44:47], v[96:99], v[36:39]
    s_lshl_b32 s47, s45, 5
    v_mfma_f32_16x16x32_bf16 v[36:39], v[64:67], v[76:79], v[36:39]
    s_lshl_b32 s42, s34, 1
    v_mfma_f32_16x16x32_bf16 v[36:39], v[40:43], v[100:103], v[36:39]
    s_add_u32 s47, s47, s42
    v_mfma_f32_16x16x32_bf16 v[36:39], v[68:71], v[72:75], v[36:39]
    s_add_u32 s47, s47, s41
    s_waitcnt lgkmcnt(0)
    v_mfma_f32_16x16x32_bf16 v[8:11], v[104:107], v[136:139], v[8:11]
    ds_read2_b32 v[40:41], v168 offset0:64 offset1:65
    s_lshl_b32 s47, s47, 11
    v_mfma_f32_16x16x32_bf16 v[12:15], v[104:107], v[140:143], v[12:15]
    ds_read2_b32 v[42:43], v168 offset0:66 offset1:67
    s_add_u32 s47, s47, 0x1000000
    v_mfma_f32_16x16x32_bf16 v[16:19], v[108:111], v[140:143], v[16:19]
    ds_read_b128 v[72:75], v172 offset:3840
    s_and_b32 s86, s3, 1
    v_mfma_f32_16x16x32_bf16 v[20:23], v[108:111], v[144:147], v[20:23]
    ds_read2_b32 v[44:45], v168 offset0:192 offset1:193
    s_lshl_b32 s86, s86, 1
    v_mfma_f32_16x16x32_bf16 v[12:15], v[108:111], v[136:139], v[12:15]
    ds_read2_b32 v[46:47], v168 offset0:194 offset1:195
    s_bfe_u32 s80, s3, 0x10001
    v_mfma_f32_16x16x32_bf16 v[16:19], v[104:107], v[144:147], v[16:19]
    ds_read_b128 v[76:79], v172 offset:3328
    s_add_u32 s86, s86, s80
    v_mfma_f32_16x16x32_bf16 v[20:23], v[112:115], v[140:143], v[20:23]
    ds_read2_b32 v[48:49], v169 offset0:64 offset1:65
    s_lshl_b32 s86, s86, 2
    v_mfma_f32_16x16x32_bf16 v[24:27], v[112:115], v[144:147], v[24:27]
    ds_read2_b32 v[50:51], v169 offset0:66 offset1:67
    s_and_b32 s80, s35, 3
    v_mfma_f32_16x16x32_bf16 v[16:19], v[112:115], v[136:139], v[16:19]
    ds_read_b128 v[80:83], v172 offset:2816
    s_add_u32 s86, s86, s80
    v_mfma_f32_16x16x32_bf16 v[20:23], v[104:107], v[148:151], v[20:23]
    ds_read2_b32 v[52:53], v169 offset0:192 offset1:193
    s_lshr_b32 s42, s3, 2
    v_mfma_f32_16x16x32_bf16 v[24:27], v[108:111], v[148:151], v[24:27]
    ds_read2_b32 v[54:55], v169 offset0:194 offset1:195
    s_lshl_b32 s42, s42, 3
    v_mfma_f32_16x16x32_bf16 v[28:31], v[112:115], v[148:151], v[28:31]
    ds_read_b128 v[84:87], v172 offset:2304
    s_lshr_b32 s43, s35, 2
    v_mfma_f32_16x16x32_bf16 v[20:23], v[116:119], v[136:139], v[20:23]
    ds_read2_b32 v[56:57], v170 offset0:64 offset1:65
    s_add_u32 s42, s42, s43
    v_mfma_f32_16x16x32_bf16 v[24:27], v[116:119], v[140:143], v[24:27]
    ds_read2_b32 v[58:59], v170 offset0:66 offset1:67
    v_lshrrev_b32 v4, 3, v0
    v_mfma_f32_16x16x32_bf16 v[28:31], v[116:119], v[144:147], v[28:31]
    ds_read_b128 v[88:91], v172 offset:1792
    v_and_b32 v5, 7, v0
    v_mfma_f32_16x16x32_bf16 v[32:35], v[116:119], v[148:151], v[32:35]
    ds_read2_b32 v[60:61], v170 offset0:192 offset1:193
    v_bfe_u32 v6, v0, 4, 1
    v_mfma_f32_16x16x32_bf16 v[24:27], v[104:107], v[152:155], v[24:27]
    ds_read2_b32 v[62:63], v170 offset0:194 offset1:195
    v_lshlrev_b32 v6, 2, v6
    v_mfma_f32_16x16x32_bf16 v[28:31], v[108:111], v[152:155], v[28:31]
    ds_read_b128 v[92:95], v172 offset:1280
    v_xor_b32 v6, v6, v5
    v_mfma_f32_16x16x32_bf16 v[32:35], v[112:115], v[152:155], v[32:35]
    ds_read2_b32 v[64:65], v171 offset0:64 offset1:65
    v_bfe_u32 v5, v0, 5, 1
    v_mfma_f32_16x16x32_bf16 v[24:27], v[120:123], v[136:139], v[24:27]
    ds_read2_b32 v[66:67], v171 offset0:66 offset1:67
    v_lshlrev_b32 v5, 1, v5
    v_mfma_f32_16x16x32_bf16 v[28:31], v[120:123], v[140:143], v[28:31]
    ds_read_b128 v[96:99], v172 offset:768
    v_xor_b32 v6, v6, v5
    v_mfma_f32_16x16x32_bf16 v[32:35], v[120:123], v[144:147], v[32:35]
    ds_read2_b32 v[68:69], v171 offset0:192 offset1:193
    v_lshlrev_b32 v250, 11, v4
    v_mfma_f32_16x16x32_bf16 v[36:39], v[116:119], v[152:155], v[36:39]
    ds_read2_b32 v[70:71], v171 offset0:194 offset1:195
    v_lshl_add_u32 v250, v6, 4, v250
    v_mfma_f32_16x16x32_bf16 v[28:31], v[104:107], v[156:159], v[28:31]
    ds_read_b128 v[100:103], v172 offset:256
    s_lshl_b32 s80, s42, 7
    v_mfma_f32_16x16x32_bf16 v[32:35], v[108:111], v[156:159], v[32:35]
    v_add_u32 v250, s80, v250
    v_mfma_f32_16x16x32_bf16 v[36:39], v[120:123], v[148:151], v[36:39]
    s_lshl_b32 s84, s32, 11
    v_mfma_f32_16x16x32_bf16 v[28:31], v[124:127], v[136:139], v[28:31]
    s_lshl_b32 s88, s32, 15
    v_mfma_f32_16x16x32_bf16 v[32:35], v[124:127], v[140:143], v[32:35]
    v_mfma_f32_16x16x32_bf16 v[36:39], v[112:115], v[156:159], v[36:39]
    v_mfma_f32_16x16x32_bf16 v[36:39], v[124:127], v[144:147], v[36:39]
    v_mfma_f32_16x16x32_bf16 v[32:35], v[104:107], v[160:163], v[32:35]
    v_mfma_f32_16x16x32_bf16 v[32:35], v[128:131], v[136:139], v[32:35]
    v_mfma_f32_16x16x32_bf16 v[36:39], v[108:111], v[160:163], v[36:39]
    v_mfma_f32_16x16x32_bf16 v[36:39], v[128:131], v[140:143], v[36:39]
    v_mfma_f32_16x16x32_bf16 v[36:39], v[104:107], v[164:167], v[36:39]
    v_mfma_f32_16x16x32_bf16 v[36:39], v[132:135], v[136:139], v[36:39]
    s_waitcnt lgkmcnt(0)
    v_mfma_f32_16x16x32_bf16 v[8:11], v[40:43], v[72:75], v[8:11]
    ds_read2_b32 v[104:105], v168 offset0:80 offset1:81
    v_mfma_f32_16x16x32_bf16 v[12:15], v[40:43], v[76:79], v[12:15]
    ds_read2_b32 v[106:107], v168 offset0:82 offset1:83
    v_mfma_f32_16x16x32_bf16 v[16:19], v[44:47], v[76:79], v[16:19]
    ds_read_b128 v[136:139], v172 offset:3904
    v_mfma_f32_16x16x32_bf16 v[20:23], v[44:47], v[80:83], v[20:23]
    ds_read2_b32 v[108:109], v168 offset0:208 offset1:209
    v_mfma_f32_16x16x32_bf16 v[12:15], v[44:47], v[72:75], v[12:15]
    ds_read2_b32 v[110:111], v168 offset0:210 offset1:211
    v_mfma_f32_16x16x32_bf16 v[16:19], v[40:43], v[80:83], v[16:19]
    ds_read_b128 v[140:143], v172 offset:3392
    v_mfma_f32_16x16x32_bf16 v[20:23], v[48:51], v[76:79], v[20:23]
    ds_read2_b32 v[112:113], v169 offset0:80 offset1:81
    v_mfma_f32_16x16x32_bf16 v[24:27], v[48:51], v[80:83], v[24:27]
    ds_read2_b32 v[114:115], v169 offset0:82 offset1:83
    v_mfma_f32_16x16x32_bf16 v[16:19], v[48:51], v[72:75], v[16:19]
    ds_read_b128 v[144:147], v172 offset:2880
    v_mfma_f32_16x16x32_bf16 v[20:23], v[40:43], v[84:87], v[20:23]
    ds_read2_b32 v[116:117], v169 offset0:208 offset1:209
    v_mfma_f32_16x16x32_bf16 v[24:27], v[44:47], v[84:87], v[24:27]
    ds_read2_b32 v[118:119], v169 offset0:210 offset1:211
    v_mfma_f32_16x16x32_bf16 v[28:31], v[48:51], v[84:87], v[28:31]
    ds_read_b128 v[148:151], v172 offset:2368
    v_mfma_f32_16x16x32_bf16 v[20:23], v[52:55], v[72:75], v[20:23]
    ds_read2_b32 v[120:121], v170 offset0:80 offset1:81
    v_mfma_f32_16x16x32_bf16 v[24:27], v[52:55], v[76:79], v[24:27]
    ds_read2_b32 v[122:123], v170 offset0:82 offset1:83
    v_mfma_f32_16x16x32_bf16 v[28:31], v[52:55], v[80:83], v[28:31]
    ds_read_b128 v[152:155], v172 offset:1856
    v_mfma_f32_16x16x32_bf16 v[32:35], v[52:55], v[84:87], v[32:35]
    ds_read2_b32 v[124:125], v170 offset0:208 offset1:209
    v_mfma_f32_16x16x32_bf16 v[24:27], v[40:43], v[88:91], v[24:27]
    ds_read2_b32 v[126:127], v170 offset0:210 offset1:211
    v_mfma_f32_16x16x32_bf16 v[28:31], v[44:47], v[88:91], v[28:31]
    ds_read_b128 v[156:159], v172 offset:1344
    v_mfma_f32_16x16x32_bf16 v[32:35], v[48:51], v[88:91], v[32:35]
    ds_read2_b32 v[128:129], v171 offset0:80 offset1:81
    v_mfma_f32_16x16x32_bf16 v[24:27], v[56:59], v[72:75], v[24:27]
    ds_read2_b32 v[130:131], v171 offset0:82 offset1:83
    v_mfma_f32_16x16x32_bf16 v[28:31], v[56:59], v[76:79], v[28:31]
    ds_read_b128 v[160:163], v172 offset:832
    v_mfma_f32_16x16x32_bf16 v[32:35], v[56:59], v[80:83], v[32:35]
    ds_read2_b32 v[132:133], v171 offset0:208 offset1:209
    v_mfma_f32_16x16x32_bf16 v[36:39], v[52:55], v[88:91], v[36:39]
    ds_read2_b32 v[134:135], v171 offset0:210 offset1:211
    v_mfma_f32_16x16x32_bf16 v[28:31], v[40:43], v[92:95], v[28:31]
    ds_read_b128 v[164:167], v172 offset:320
    v_mfma_f32_16x16x32_bf16 v[32:35], v[44:47], v[92:95], v[32:35]
    v_mfma_f32_16x16x32_bf16 v[36:39], v[56:59], v[84:87], v[36:39]
    v_mfma_f32_16x16x32_bf16 v[28:31], v[60:63], v[72:75], v[28:31]
    v_mfma_f32_16x16x32_bf16 v[32:35], v[60:63], v[76:79], v[32:35]
    v_mfma_f32_16x16x32_bf16 v[36:39], v[48:51], v[92:95], v[36:39]
    v_mfma_f32_16x16x32_bf16 v[36:39], v[60:63], v[80:83], v[36:39]
    v_mfma_f32_16x16x32_bf16 v[32:35], v[40:43], v[96:99], v[32:35]
    v_mfma_f32_16x16x32_bf16 v[32:35], v[64:67], v[72:75], v[32:35]
    v_mfma_f32_16x16x32_bf16 v[36:39], v[44:47], v[96:99], v[36:39]
    v_mfma_f32_16x16x32_bf16 v[36:39], v[64:67], v[76:79], v[36:39]
    v_mfma_f32_16x16x32_bf16 v[36:39], v[40:43], v[100:103], v[36:39]
    v_mfma_f32_16x16x32_bf16 v[36:39], v[68:71], v[72:75], v[36:39]
    s_waitcnt lgkmcnt(0)
    v_mfma_f32_16x16x32_bf16 v[8:11], v[104:107], v[136:139], v[8:11]
    ds_read2_b32 v[40:41], v168 offset0:96 offset1:97
    v_mfma_f32_16x16x32_bf16 v[12:15], v[104:107], v[140:143], v[12:15]
    ds_read2_b32 v[42:43], v168 offset0:98 offset1:99
    v_mfma_f32_16x16x32_bf16 v[16:19], v[108:111], v[140:143], v[16:19]
    ds_read_b128 v[72:75], v172 offset:3968
    v_mfma_f32_16x16x32_bf16 v[20:23], v[108:111], v[144:147], v[20:23]
    ds_read2_b32 v[44:45], v168 offset0:224 offset1:225
    v_mfma_f32_16x16x32_bf16 v[12:15], v[108:111], v[136:139], v[12:15]
    ds_read2_b32 v[46:47], v168 offset0:226 offset1:227
    v_mfma_f32_16x16x32_bf16 v[16:19], v[104:107], v[144:147], v[16:19]
    ds_read_b128 v[76:79], v172 offset:3456
    v_mfma_f32_16x16x32_bf16 v[20:23], v[112:115], v[140:143], v[20:23]
    ds_read2_b32 v[48:49], v169 offset0:96 offset1:97
    v_mfma_f32_16x16x32_bf16 v[24:27], v[112:115], v[144:147], v[24:27]
    ds_read2_b32 v[50:51], v169 offset0:98 offset1:99
    v_mfma_f32_16x16x32_bf16 v[16:19], v[112:115], v[136:139], v[16:19]
    ds_read_b128 v[80:83], v172 offset:2944
    v_mfma_f32_16x16x32_bf16 v[20:23], v[104:107], v[148:151], v[20:23]
    ds_read2_b32 v[52:53], v169 offset0:224 offset1:225
    v_mfma_f32_16x16x32_bf16 v[24:27], v[108:111], v[148:151], v[24:27]
    ds_read2_b32 v[54:55], v169 offset0:226 offset1:227
    v_mfma_f32_16x16x32_bf16 v[28:31], v[112:115], v[148:151], v[28:31]
    ds_read_b128 v[84:87], v172 offset:2432
    v_mfma_f32_16x16x32_bf16 v[20:23], v[116:119], v[136:139], v[20:23]
    ds_read2_b32 v[56:57], v170 offset0:96 offset1:97
    v_mfma_f32_16x16x32_bf16 v[24:27], v[116:119], v[140:143], v[24:27]
    ds_read2_b32 v[58:59], v170 offset0:98 offset1:99
    v_mfma_f32_16x16x32_bf16 v[28:31], v[116:119], v[144:147], v[28:31]
    ds_read_b128 v[88:91], v172 offset:1920
    v_mfma_f32_16x16x32_bf16 v[32:35], v[116:119], v[148:151], v[32:35]
    ds_read2_b32 v[60:61], v170 offset0:224 offset1:225
    v_mfma_f32_16x16x32_bf16 v[24:27], v[104:107], v[152:155], v[24:27]
    ds_read2_b32 v[62:63], v170 offset0:226 offset1:227
    v_mfma_f32_16x16x32_bf16 v[28:31], v[108:111], v[152:155], v[28:31]
    ds_read_b128 v[92:95], v172 offset:1408
    v_mfma_f32_16x16x32_bf16 v[32:35], v[112:115], v[152:155], v[32:35]
    ds_read2_b32 v[64:65], v171 offset0:96 offset1:97
    v_mfma_f32_16x16x32_bf16 v[24:27], v[120:123], v[136:139], v[24:27]
    ds_read2_b32 v[66:67], v171 offset0:98 offset1:99
    v_mfma_f32_16x16x32_bf16 v[28:31], v[120:123], v[140:143], v[28:31]
    ds_read_b128 v[96:99], v172 offset:896
    v_mfma_f32_16x16x32_bf16 v[32:35], v[120:123], v[144:147], v[32:35]
    ds_read2_b32 v[68:69], v171 offset0:224 offset1:225
    v_mfma_f32_16x16x32_bf16 v[36:39], v[116:119], v[152:155], v[36:39]
    ds_read2_b32 v[70:71], v171 offset0:226 offset1:227
    v_mfma_f32_16x16x32_bf16 v[28:31], v[104:107], v[156:159], v[28:31]
    ds_read_b128 v[100:103], v172 offset:384
    v_mfma_f32_16x16x32_bf16 v[32:35], v[108:111], v[156:159], v[32:35]
    v_mfma_f32_16x16x32_bf16 v[36:39], v[120:123], v[148:151], v[36:39]
    v_mfma_f32_16x16x32_bf16 v[28:31], v[124:127], v[136:139], v[28:31]
    v_mfma_f32_16x16x32_bf16 v[32:35], v[124:127], v[140:143], v[32:35]
    v_mfma_f32_16x16x32_bf16 v[36:39], v[112:115], v[156:159], v[36:39]
    v_mfma_f32_16x16x32_bf16 v[36:39], v[124:127], v[144:147], v[36:39]
    v_mfma_f32_16x16x32_bf16 v[32:35], v[104:107], v[160:163], v[32:35]
    v_mfma_f32_16x16x32_bf16 v[32:35], v[128:131], v[136:139], v[32:35]
    v_mfma_f32_16x16x32_bf16 v[36:39], v[108:111], v[160:163], v[36:39]
    v_mfma_f32_16x16x32_bf16 v[36:39], v[128:131], v[140:143], v[36:39]
    v_mfma_f32_16x16x32_bf16 v[36:39], v[104:107], v[164:167], v[36:39]
    v_mfma_f32_16x16x32_bf16 v[36:39], v[132:135], v[136:139], v[36:39]
    s_waitcnt lgkmcnt(0)
    v_mfma_f32_16x16x32_bf16 v[8:11], v[40:43], v[72:75], v[8:11]
    ds_read2_b32 v[104:105], v168 offset0:112 offset1:113
    v_mfma_f32_16x16x32_bf16 v[12:15], v[40:43], v[76:79], v[12:15]
    ds_read2_b32 v[106:107], v168 offset0:114 offset1:115
    v_mfma_f32_16x16x32_bf16 v[16:19], v[44:47], v[76:79], v[16:19]
    ds_read_b128 v[136:139], v172 offset:4032
    v_mfma_f32_16x16x32_bf16 v[20:23], v[44:47], v[80:83], v[20:23]
    ds_read2_b32 v[108:109], v168 offset0:240 offset1:241
    v_mfma_f32_16x16x32_bf16 v[12:15], v[44:47], v[72:75], v[12:15]
    ds_read2_b32 v[110:111], v168 offset0:242 offset1:243
    v_mfma_f32_16x16x32_bf16 v[16:19], v[40:43], v[80:83], v[16:19]
    ds_read_b128 v[140:143], v172 offset:3520
    v_mfma_f32_16x16x32_bf16 v[20:23], v[48:51], v[76:79], v[20:23]
    ds_read2_b32 v[112:113], v169 offset0:112 offset1:113
    v_mfma_f32_16x16x32_bf16 v[24:27], v[48:51], v[80:83], v[24:27]
    ds_read2_b32 v[114:115], v169 offset0:114 offset1:115
    v_mfma_f32_16x16x32_bf16 v[16:19], v[48:51], v[72:75], v[16:19]
    ds_read_b128 v[144:147], v172 offset:3008
    v_mfma_f32_16x16x32_bf16 v[20:23], v[40:43], v[84:87], v[20:23]
    ds_read2_b32 v[116:117], v169 offset0:240 offset1:241
    v_mfma_f32_16x16x32_bf16 v[24:27], v[44:47], v[84:87], v[24:27]
    ds_read2_b32 v[118:119], v169 offset0:242 offset1:243
    v_mfma_f32_16x16x32_bf16 v[28:31], v[48:51], v[84:87], v[28:31]
    ds_read_b128 v[148:151], v172 offset:2496
    v_mfma_f32_16x16x32_bf16 v[20:23], v[52:55], v[72:75], v[20:23]
    ds_read2_b32 v[120:121], v170 offset0:112 offset1:113
    v_mfma_f32_16x16x32_bf16 v[24:27], v[52:55], v[76:79], v[24:27]
    ds_read2_b32 v[122:123], v170 offset0:114 offset1:115
    v_mfma_f32_16x16x32_bf16 v[28:31], v[52:55], v[80:83], v[28:31]
    ds_read_b128 v[152:155], v172 offset:1984
    v_mfma_f32_16x16x32_bf16 v[32:35], v[52:55], v[84:87], v[32:35]
    ds_read2_b32 v[124:125], v170 offset0:240 offset1:241
    v_mfma_f32_16x16x32_bf16 v[24:27], v[40:43], v[88:91], v[24:27]
    ds_read2_b32 v[126:127], v170 offset0:242 offset1:243
    v_mfma_f32_16x16x32_bf16 v[28:31], v[44:47], v[88:91], v[28:31]
    ds_read_b128 v[156:159], v172 offset:1472
    v_mfma_f32_16x16x32_bf16 v[32:35], v[48:51], v[88:91], v[32:35]
    ds_read2_b32 v[128:129], v171 offset0:112 offset1:113
    v_mfma_f32_16x16x32_bf16 v[24:27], v[56:59], v[72:75], v[24:27]
    ds_read2_b32 v[130:131], v171 offset0:114 offset1:115
    v_mfma_f32_16x16x32_bf16 v[28:31], v[56:59], v[76:79], v[28:31]
    ds_read_b128 v[160:163], v172 offset:960
    v_mfma_f32_16x16x32_bf16 v[32:35], v[56:59], v[80:83], v[32:35]
    ds_read2_b32 v[132:133], v171 offset0:240 offset1:241
    v_mfma_f32_16x16x32_bf16 v[36:39], v[52:55], v[88:91], v[36:39]
    ds_read2_b32 v[134:135], v171 offset0:242 offset1:243
    v_mfma_f32_16x16x32_bf16 v[28:31], v[40:43], v[92:95], v[28:31]
    ds_read_b128 v[164:167], v172 offset:448
    v_mfma_f32_16x16x32_bf16 v[32:35], v[44:47], v[92:95], v[32:35]
    v_mfma_f32_16x16x32_bf16 v[36:39], v[56:59], v[84:87], v[36:39]
    v_mfma_f32_16x16x32_bf16 v[28:31], v[60:63], v[72:75], v[28:31]
    v_mfma_f32_16x16x32_bf16 v[32:35], v[60:63], v[76:79], v[32:35]
    v_mfma_f32_16x16x32_bf16 v[36:39], v[48:51], v[92:95], v[36:39]
    v_mfma_f32_16x16x32_bf16 v[36:39], v[60:63], v[80:83], v[36:39]
    v_mfma_f32_16x16x32_bf16 v[32:35], v[40:43], v[96:99], v[32:35]
    v_mfma_f32_16x16x32_bf16 v[32:35], v[64:67], v[72:75], v[32:35]
    v_mfma_f32_16x16x32_bf16 v[36:39], v[44:47], v[96:99], v[36:39]
    v_mfma_f32_16x16x32_bf16 v[36:39], v[64:67], v[76:79], v[36:39]
    v_mfma_f32_16x16x32_bf16 v[36:39], v[40:43], v[100:103], v[36:39]
    v_mfma_f32_16x16x32_bf16 v[36:39], v[68:71], v[72:75], v[36:39]
    s_waitcnt lgkmcnt(0)
    ds_read_b64 v[40:41], v173 offset:3584
    ds_read_b64 v[42:43], v173 offset:3072
    ds_read_b64 v[44:45], v173 offset:2560
    ds_read_b64 v[46:47], v173 offset:2048
    ds_read_b64 v[48:49], v173 offset:1536
    ds_read_b64 v[50:51], v173 offset:1024
    ds_read_b64 v[52:53], v173 offset:512
    ds_read_b64 v[54:55], v173 offset:0
    v_mfma_f32_16x16x32_bf16 v[8:11], v[104:107], v[136:139], v[8:11]
    v_mfma_f32_16x16x32_bf16 v[12:15], v[108:111], v[136:139], v[12:15]
    v_mfma_f32_16x16x32_bf16 v[16:19], v[112:115], v[136:139], v[16:19]
    v_mfma_f32_16x16x32_bf16 v[20:23], v[116:119], v[136:139], v[20:23]
    v_mfma_f32_16x16x32_bf16 v[12:15], v[104:107], v[140:143], v[12:15]
    v_mfma_f32_16x16x32_bf16 v[16:19], v[108:111], v[140:143], v[16:19]
    s_waitcnt lgkmcnt(0)
    v_and_b32 v56, 0xffff0000, v41
    v_lshlrev_b32 v57, 16, v41
    v_mfma_f32_16x16x32_bf16 v[20:23], v[112:115], v[140:143], v[20:23]
    v_and_b32 v58, 0xffff0000, v40
    v_lshlrev_b32 v59, 16, v40
    v_mfma_f32_16x16x32_bf16 v[24:27], v[120:123], v[136:139], v[24:27]
    v_fmac_f32 v8, s39, v56
    v_fmac_f32 v9, s39, v57
    v_mfma_f32_16x16x32_bf16 v[16:19], v[104:107], v[144:147], v[16:19]
    v_fmac_f32 v10, s39, v58
    v_fmac_f32 v11, s39, v59
    v_mfma_f32_16x16x32_bf16 v[20:23], v[108:111], v[144:147], v[20:23]
    v_cvt_pk_bf16_f32 v176, v8, v9
    v_cvt_pk_bf16_f32 v177, v10, v11
    v_mfma_f32_16x16x32_bf16 v[24:27], v[116:119], v[140:143], v[24:27]
    v_and_b32 v60, 0xffff0000, v43
    v_lshlrev_b32 v61, 16, v43
    v_mfma_f32_16x16x32_bf16 v[28:31], v[124:127], v[136:139], v[28:31]
    v_and_b32 v62, 0xffff0000, v42
    v_lshlrev_b32 v63, 16, v42
    v_mfma_f32_16x16x32_bf16 v[36:39], v[132:135], v[136:139], v[36:39]
    v_fmac_f32 v12, s39, v60
    v_fmac_f32 v13, s39, v61
    v_mfma_f32_16x16x32_bf16 v[20:23], v[104:107], v[148:151], v[20:23]
    v_fmac_f32 v14, s39, v62
    v_fmac_f32 v15, s39, v63
    v_mfma_f32_16x16x32_bf16 v[24:27], v[112:115], v[144:147], v[24:27]
    v_cvt_pk_bf16_f32 v178, v12, v13
    v_cvt_pk_bf16_f32 v179, v14, v15
    v_mfma_f32_16x16x32_bf16 v[32:35], v[128:131], v[136:139], v[32:35]
    v_and_b32 v64, 0xffff0000, v45
    v_lshlrev_b32 v65, 16, v45
    v_mfma_f32_16x16x32_bf16 v[36:39], v[128:131], v[140:143], v[36:39]
    v_and_b32 v66, 0xffff0000, v44
    v_lshlrev_b32 v67, 16, v44
    v_mfma_f32_16x16x32_bf16 v[24:27], v[108:111], v[148:151], v[24:27]
    v_fmac_f32 v16, s39, v64
    v_fmac_f32 v17, s39, v65
    v_mfma_f32_16x16x32_bf16 v[32:35], v[124:127], v[140:143], v[32:35]
    v_fmac_f32 v18, s39, v66
    v_fmac_f32 v19, s39, v67
    v_mfma_f32_16x16x32_bf16 v[36:39], v[124:127], v[144:147], v[36:39]
    v_cvt_pk_bf16_f32 v180, v16, v17
    v_cvt_pk_bf16_f32 v181, v18, v19
    v_mfma_f32_16x16x32_bf16 v[24:27], v[104:107], v[152:155], v[24:27]
    v_and_b32 v68, 0xffff0000, v47
    v_lshlrev_b32 v69, 16, v47
    v_mfma_f32_16x16x32_bf16 v[28:31], v[120:123], v[140:143], v[28:31]
    v_and_b32 v70, 0xffff0000, v46
    v_lshlrev_b32 v71, 16, v46
    v_mfma_f32_16x16x32_bf16 v[32:35], v[120:123], v[144:147], v[32:35]
    v_fmac_f32 v20, s39, v68
    v_fmac_f32 v21, s39, v69
    v_mfma_f32_16x16x32_bf16 v[36:39], v[120:123], v[148:151], v[36:39]
    v_fmac_f32 v22, s39, v70
    v_fmac_f32 v23, s39, v71
    v_mfma_f32_16x16x32_bf16 v[28:31], v[116:119], v[144:147], v[28:31]
    v_cvt_pk_bf16_f32 v182, v20, v21
    v_cvt_pk_bf16_f32 v183, v22, v23
    v_mfma_f32_16x16x32_bf16 v[32:35], v[116:119], v[148:151], v[32:35]
    v_and_b32 v72, 0xffff0000, v49
    v_lshlrev_b32 v73, 16, v49
    v_mfma_f32_16x16x32_bf16 v[36:39], v[116:119], v[152:155], v[36:39]
    v_and_b32 v74, 0xffff0000, v48
    v_lshlrev_b32 v75, 16, v48
    v_mfma_f32_16x16x32_bf16 v[28:31], v[112:115], v[148:151], v[28:31]
    v_fmac_f32 v24, s39, v72
    v_fmac_f32 v25, s39, v73
    v_mfma_f32_16x16x32_bf16 v[32:35], v[112:115], v[152:155], v[32:35]
    v_fmac_f32 v26, s39, v74
    v_fmac_f32 v27, s39, v75
    v_mfma_f32_16x16x32_bf16 v[36:39], v[112:115], v[156:159], v[36:39]
    v_cvt_pk_bf16_f32 v184, v24, v25
    v_cvt_pk_bf16_f32 v185, v26, v27
    v_mfma_f32_16x16x32_bf16 v[28:31], v[108:111], v[152:155], v[28:31]
    v_and_b32 v76, 0xffff0000, v51
    v_lshlrev_b32 v77, 16, v51
    v_mfma_f32_16x16x32_bf16 v[32:35], v[108:111], v[156:159], v[32:35]
    v_and_b32 v78, 0xffff0000, v50
    v_lshlrev_b32 v79, 16, v50
    v_mfma_f32_16x16x32_bf16 v[36:39], v[108:111], v[160:163], v[36:39]
    v_and_b32 v80, 0xffff0000, v53
    v_lshlrev_b32 v81, 16, v53
    v_mfma_f32_16x16x32_bf16 v[28:31], v[104:107], v[156:159], v[28:31]
    v_and_b32 v82, 0xffff0000, v52
    v_lshlrev_b32 v83, 16, v52
    v_mfma_f32_16x16x32_bf16 v[32:35], v[104:107], v[160:163], v[32:35]
    v_and_b32 v84, 0xffff0000, v55
    v_lshlrev_b32 v85, 16, v55
    v_mfma_f32_16x16x32_bf16 v[36:39], v[104:107], v[164:167], v[36:39]
    v_and_b32 v86, 0xffff0000, v54
    v_lshlrev_b32 v87, 16, v54
    s_nop 1
    s_nop 1
    v_fmac_f32 v28, s39, v76
    v_fmac_f32 v29, s39, v77
    v_fmac_f32 v30, s39, v78
    v_fmac_f32 v31, s39, v79
    v_cvt_pk_bf16_f32 v186, v28, v29
    v_cvt_pk_bf16_f32 v187, v30, v31
    v_fmac_f32 v32, s39, v80
    v_fmac_f32 v33, s39, v81
    v_fmac_f32 v34, s39, v82
    v_fmac_f32 v35, s39, v83
    v_cvt_pk_bf16_f32 v188, v32, v33
    v_cvt_pk_bf16_f32 v189, v34, v35
    v_fmac_f32 v36, s39, v84
    v_fmac_f32 v37, s39, v85
    v_fmac_f32 v38, s39, v86
    v_fmac_f32 v39, s39, v87
    v_cvt_pk_bf16_f32 v190, v36, v37
    v_cvt_pk_bf16_f32 v191, v38, v39
    s_setprio 0
    s_barrier
    ds_read_b128 v[224:227], v193
    ds_read_b128 v[228:231], v193 offset:1024
    buffer_store_dwordx2 v[176:177], v174, s[12:15], s36 offen offset:0 sc1
    buffer_store_dwordx2 v[178:179], v174, s[12:15], s36 offen offset:512 sc1
    buffer_store_dwordx2 v[180:181], v174, s[12:15], s36 offen offset:1024 sc1
    buffer_store_dwordx2 v[182:183], v174, s[12:15], s36 offen offset:1536 sc1
    buffer_store_dwordx2 v[184:185], v174, s[12:15], s36 offen offset:2048 sc1
    buffer_store_dwordx2 v[186:187], v174, s[12:15], s36 offen offset:2560 sc1
    buffer_store_dwordx2 v[188:189], v174, s[12:15], s36 offen offset:3072 sc1
    buffer_store_dwordx2 v[190:191], v174, s[12:15], s36 offen offset:3584 sc1
    s_setprio 3
    ds_read_b128 v[56:59], v245 offset:16384
    ds_read_b128 v[60:63], v245 offset:17408
    ds_read_b128 v[64:67], v245 offset:0
    ds_read_b128 v[68:71], v245 offset:1024
    ds_read_b128 v[72:75], v245 offset:14336
    ds_read_b128 v[76:79], v245 offset:15360
    ds_read_b128 v[80:83], v245 offset:40960
    ds_read_b128 v[84:87], v245 offset:41984
    ds_read_b128 v[88:91], v246 offset:24576
    ds_read_b128 v[92:95], v246 offset:25600
    s_waitcnt lgkmcnt(8)
    v_mfma_f32_32x32x16_bf16 v[8:23], v[56:59], v[224:227], 0
    v_mfma_f32_32x32x16_bf16 v[8:23], v[60:63], v[228:231], v[8:23]
    s_waitcnt lgkmcnt(6)
    v_mfma_f32_32x32x16_bf16 v[24:39], v[64:67], v[224:227], 0
    v_mfma_f32_32x32x16_bf16 v[24:39], v[68:71], v[228:231], v[24:39]
    s_waitcnt lgkmcnt(4)
    v_mfma_f32_32x32x16_bf16 v[40:55], v[72:75], v[224:227], 0
    v_mfma_f32_32x32x16_bf16 v[40:55], v[76:79], v[228:231], v[40:55]
    ds_read_b128 v[56:59], v245 offset:12288
    ds_read_b128 v[60:63], v245 offset:13312
    s_cmp_gt_u32 s46, 0
    s_cbranch_scc1 L_mneg_9
    v_cndmask_b32 v24, v24, v8, s[4:5]
    v_cndmask_b32 v25, v25, v9, s[6:7]
    v_cndmask_b32 v26, v26, v10, s[8:9]
    v_cndmask_b32 v27, v27, v11, s[10:11]
    v_cndmask_b32 v28, v28, v12, s[16:17]
    v_cndmask_b32 v29, v29, v13, s[18:19]
    v_cndmask_b32 v30, v30, v14, s[20:21]
    v_cndmask_b32 v31, v31, v15, s[22:23]
    v_cndmask_b32 v32, v32, v16, s[24:25]
    v_cndmask_b32 v33, v33, v17, s[26:27]
    v_cndmask_b32 v34, v34, v18, s[48:49]
    v_cndmask_b32 v35, v35, v19, s[50:51]
    v_cndmask_b32 v36, v36, v20, s[52:53]
    v_cndmask_b32 v37, v37, v21, s[54:55]
    v_cndmask_b32 v38, v38, v22, s[56:57]
    v_cndmask_b32 v39, v39, v23, s[58:59]
L_mback_10:
    v_exp_f32 v24, v24
    v_exp_f32 v25, v25
    v_exp_f32 v26, v26
    v_exp_f32 v27, v27
    v_exp_f32 v28, v28
    v_exp_f32 v29, v29
    v_exp_f32 v30, v30
    v_exp_f32 v31, v31
    v_exp_f32 v32, v32
    v_exp_f32 v33, v33
    v_exp_f32 v34, v34
    v_exp_f32 v35, v35
    v_exp_f32 v36, v36
    v_exp_f32 v37, v37
    v_exp_f32 v38, v38
    v_exp_f32 v39, v39
    v_cvt_pk_bf16_f32 v24, v24, v25
    v_cvt_pk_bf16_f32 v25, v26, v27
    v_cvt_pk_bf16_f32 v26, v28, v29
    v_cvt_pk_bf16_f32 v27, v30, v31
    v_cvt_pk_bf16_f32 v28, v32, v33
    v_cvt_pk_bf16_f32 v29, v34, v35
    v_cvt_pk_bf16_f32 v30, v36, v37
    v_cvt_pk_bf16_f32 v31, v38, v39
    v_and_b32 v32, v24, v232
    v_and_b32 v33, v25, v233
    v_and_b32 v34, v26, v234
    v_and_b32 v35, v27, v235
    v_and_b32 v36, v28, v236
    v_and_b32 v37, v29, v237
    v_and_b32 v38, v30, v238
    v_and_b32 v39, v31, v239
    v_xor_b32 v144, v24, v32
    v_xor_b32 v145, v25, v33
    v_xor_b32 v146, v26, v34
    v_xor_b32 v147, v27, v35
    v_xor_b32 v148, v28, v36
    v_xor_b32 v149, v29, v37
    v_xor_b32 v150, v30, v38
    v_xor_b32 v151, v31, v39
    s_waitcnt lgkmcnt(0)
    s_cmp_gt_u32 s46, 7
    s_cbranch_scc1 L_aexit_11
    ds_read_b128 v[160:163], v245 offset:38912
    ds_read_b128 v[164:167], v245 offset:39936
    ds_read_b128 v[64:67], v245 offset:10240
    ds_read_b128 v[68:71], v245 offset:11264
    v_mfma_f32_32x32x16_bf16 v[8:23], v[56:59], v[224:227], 0
    v_exp_f32 v40, v40
    v_exp_f32 v41, v41
    v_exp_f32 v42, v42
    v_mfma_f32_32x32x16_bf16 v[8:23], v[60:63], v[228:231], v[8:23]
    v_exp_f32 v43, v43
    v_exp_f32 v44, v44
    v_exp_f32 v45, v45
    v_mfma_f32_32x32x16_bf16 v[96:111], v[80:83], v[32:35], 0
    v_exp_f32 v46, v46
    v_exp_f32 v47, v47
    v_exp_f32 v48, v48
    v_mfma_f32_16x16x32_bf16 v[128:131], v[240:243], v[24:27], 0
    v_exp_f32 v49, v49
    v_mfma_f32_32x32x16_bf16 v[96:111], v[84:87], v[36:39], v[96:111]
    v_exp_f32 v50, v50
    v_exp_f32 v51, v51
    v_exp_f32 v52, v52
    v_mfma_f32_16x16x32_bf16 v[128:131], v[240:243], v[28:31], v[128:131]
    v_exp_f32 v53, v53
    v_mfma_f32_32x32x16_bf16 v[96:111], v[88:91], v[144:147], v[96:111]
    v_exp_f32 v54, v54
    v_exp_f32 v55, v55
    v_cvt_pk_bf16_f32 v40, v40, v41
    v_cvt_pk_bf16_f32 v41, v42, v43
    v_mfma_f32_32x32x16_bf16 v[96:111], v[92:95], v[148:151], v[96:111]
    v_cvt_pk_bf16_f32 v42, v44, v45
    v_cvt_pk_bf16_f32 v43, v46, v47
    v_cvt_pk_bf16_f32 v44, v48, v49
    v_cvt_pk_bf16_f32 v45, v50, v51
    v_cvt_pk_bf16_f32 v46, v52, v53
    v_cvt_pk_bf16_f32 v47, v54, v55
    s_waitcnt lgkmcnt(0)
    s_cmp_gt_u32 s46, 6
    s_cbranch_scc1 L_aexit_12
    s_waitcnt vmcnt(0)
    s_add_u32 s80, s89, 0x1810000
    v_mov_b32 v194, s78
    v_mov_b32 v195, s79
    s_mov_b64 exec, 1
    buffer_store_dwordx2 v[194:195], v252, s[12:15], s80 offen sc1
    s_mov_b64 exec, -1
    s_add_u32 m0, s84, 106496
    s_add_u32 s81, s43, 0
    s_and_b32 s81, s81, 7
    s_lshl_b32 s81, s81, 18
    s_add_u32 s81, s81, s88
    buffer_load_dwordx4 v250, s[60:63], s81 offen lds
    s_add_u32 s81, s81, 15360
    buffer_load_dwordx4 v250, s[60:63], s81 offen offset:1024 lds
    ds_read_b128 v[80:83], v245 offset:36864
    ds_read_b128 v[84:87], v245 offset:37888
    ds_read_b128 v[72:75], v245 offset:8192
    ds_read_b128 v[76:79], v245 offset:9216
    v_mfma_f32_32x32x16_bf16 v[24:39], v[64:67], v[224:227], 0
    v_exp_f32 v8, v8
    v_exp_f32 v9, v9
    v_exp_f32 v10, v10
    v_mfma_f32_32x32x16_bf16 v[24:39], v[68:71], v[228:231], v[24:39]
    v_exp_f32 v11, v11
    v_exp_f32 v12, v12
    v_exp_f32 v13, v13
    v_mfma_f32_32x32x16_bf16 v[96:111], v[160:163], v[40:43], v[96:111]
    v_exp_f32 v14, v14
    v_exp_f32 v15, v15
    v_exp_f32 v16, v16
    v_mfma_f32_16x16x32_bf16 v[128:131], v[240:243], v[40:43], v[128:131]
    v_exp_f32 v17, v17
    v_mfma_f32_32x32x16_bf16 v[96:111], v[164:167], v[44:47], v[96:111]
    v_exp_f32 v18, v18
    v_exp_f32 v19, v19
    v_exp_f32 v20, v20
    v_mfma_f32_16x16x32_bf16 v[128:131], v[240:243], v[44:47], v[128:131]
    v_exp_f32 v21, v21
    v_exp_f32 v22, v22
    v_exp_f32 v23, v23
    v_cvt_pk_bf16_f32 v8, v8, v9
    v_cvt_pk_bf16_f32 v9, v10, v11
    v_cvt_pk_bf16_f32 v10, v12, v13
    v_cvt_pk_bf16_f32 v11, v14, v15
    v_cvt_pk_bf16_f32 v12, v16, v17
    v_cvt_pk_bf16_f32 v13, v18, v19
    v_cvt_pk_bf16_f32 v14, v20, v21
    v_cvt_pk_bf16_f32 v15, v22, v23
    s_waitcnt lgkmcnt(0)
    s_cmp_gt_u32 s46, 5
    s_cbranch_scc1 L_aexit_13
    s_setprio 2
    s_add_u32 m0, s84, 122880
    s_add_u32 s81, s43, 1
    s_and_b32 s81, s81, 7
    s_lshl_b32 s81, s81, 18
    s_add_u32 s81, s81, s88
    buffer_load_dwordx4 v250, s[60:63], s81 offen lds
    s_add_u32 s81, s81, 15360
    buffer_load_dwordx4 v250, s[60:63], s81 offen offset:1024 lds
    ds_read_b128 v[88:91], v245 offset:34816
    ds_read_b128 v[92:95], v245 offset:35840
    ds_read_b128 v[56:59], v245 offset:6144
    ds_read_b128 v[60:63], v245 offset:7168
    v_mfma_f32_32x32x16_bf16 v[40:55], v[72:75], v[224:227], 0
    v_exp_f32 v24, v24
    v_exp_f32 v25, v25
    v_exp_f32 v26, v26
    v_mfma_f32_32x32x16_bf16 v[40:55], v[76:79], v[228:231], v[40:55]
    v_exp_f32 v27, v27
    v_exp_f32 v28, v28
    v_exp_f32 v29, v29
    v_mfma_f32_32x32x16_bf16 v[96:111], v[80:83], v[8:11], v[96:111]
    v_exp_f32 v30, v30
    v_exp_f32 v31, v31
    v_exp_f32 v32, v32
    v_mfma_f32_16x16x32_bf16 v[128:131], v[240:243], v[8:11], v[128:131]
    v_exp_f32 v33, v33
    v_mfma_f32_32x32x16_bf16 v[96:111], v[84:87], v[12:15], v[96:111]
    v_exp_f32 v34, v34
    v_exp_f32 v35, v35
    v_exp_f32 v36, v36
    v_mfma_f32_16x16x32_bf16 v[128:131], v[240:243], v[12:15], v[128:131]
    v_exp_f32 v37, v37
    v_exp_f32 v38, v38
    v_exp_f32 v39, v39
    v_cvt_pk_bf16_f32 v24, v24, v25
    v_cvt_pk_bf16_f32 v25, v26, v27
    v_cvt_pk_bf16_f32 v26, v28, v29
    v_cvt_pk_bf16_f32 v27, v30, v31
    v_cvt_pk_bf16_f32 v28, v32, v33
    v_cvt_pk_bf16_f32 v29, v34, v35
    v_cvt_pk_bf16_f32 v30, v36, v37
    v_cvt_pk_bf16_f32 v31, v38, v39
    s_waitcnt lgkmcnt(0)
    s_cmp_gt_u32 s46, 4
    s_cbranch_scc1 L_aexit_14
    s_add_u32 m0, s84, 139264
    s_add_u32 s81, s43, 2
    s_and_b32 s81, s81, 7
    s_lshl_b32 s81, s81, 18
    s_add_u32 s81, s81, s88
    buffer_load_dwordx4 v250, s[60:63], s81 offen lds
    s_add_u32 s81, s81, 15360
    buffer_load_dwordx4 v250, s[60:63], s81 offen offset:1024 lds
    ds_read_b128 v[160:163], v245 offset:32768
    ds_read_b128 v[164:167], v245 offset:33792
    ds_read_b128 v[64:67], v245 offset:4096
    ds_read_b128 v[68:71], v245 offset:5120
    v_mfma_f32_32x32x16_bf16 v[8:23], v[56:59], v[224:227], 0
    v_exp_f32 v40, v40
    v_exp_f32 v41, v41
    v_exp_f32 v42, v42
    v_mfma_f32_32x32x16_bf16 v[8:23], v[60:63], v[228:231], v[8:23]
    v_exp_f32 v43, v43
    v_exp_f32 v44, v44
    v_exp_f32 v45, v45
    v_mfma_f32_32x32x16_bf16 v[96:111], v[88:91], v[24:27], v[96:111]
    v_exp_f32 v46, v46
    v_exp_f32 v47, v47
    v_exp_f32 v48, v48
    v_mfma_f32_16x16x32_bf16 v[128:131], v[240:243], v[24:27], v[128:131]
    v_exp_f32 v49, v49
    v_mfma_f32_32x32x16_bf16 v[96:111], v[92:95], v[28:31], v[96:111]
    v_exp_f32 v50, v50
    v_exp_f32 v51, v51
    v_exp_f32 v52, v52
    v_mfma_f32_16x16x32_bf16 v[128:131], v[240:243], v[28:31], v[128:131]
    v_exp_f32 v53, v53
    v_exp_f32 v54, v54
    v_exp_f32 v55, v55
    v_cvt_pk_bf16_f32 v40, v40, v41
    v_cvt_pk_bf16_f32 v41, v42, v43
    v_cvt_pk_bf16_f32 v42, v44, v45
    v_cvt_pk_bf16_f32 v43, v46, v47
    v_cvt_pk_bf16_f32 v44, v48, v49
    v_cvt_pk_bf16_f32 v45, v50, v51
    v_cvt_pk_bf16_f32 v46, v52, v53
    v_cvt_pk_bf16_f32 v47, v54, v55
    s_waitcnt lgkmcnt(0)
    s_cmp_gt_u32 s46, 3
    s_cbranch_scc1 L_aexit_15
    s_setprio 1
    ds_read_b128 v[80:83], v245 offset:30720
    ds_read_b128 v[84:87], v245 offset:31744
    ds_read_b128 v[72:75], v245 offset:2048
    ds_read_b128 v[76:79], v245 offset:3072
    v_mfma_f32_32x32x16_bf16 v[24:39], v[64:67], v[224:227], 0
    v_exp_f32 v8, v8
    v_exp_f32 v9, v9
    v_exp_f32 v10, v10
    v_mfma_f32_32x32x16_bf16 v[24:39], v[68:71], v[228:231], v[24:39]
    v_exp_f32 v11, v11
    v_exp_f32 v12, v12
    v_exp_f32 v13, v13
    v_mfma_f32_32x32x16_bf16 v[96:111], v[160:163], v[40:43], v[96:111]
    v_exp_f32 v14, v14
    v_exp_f32 v15, v15
    v_exp_f32 v16, v16
    v_mfma_f32_16x16x32_bf16 v[128:131], v[240:243], v[40:43], v[128:131]
    v_exp_f32 v17, v17
    v_mfma_f32_32x32x16_bf16 v[96:111], v[164:167], v[44:47], v[96:111]
    v_exp_f32 v18, v18
    v_exp_f32 v19, v19
    v_exp_f32 v20, v20
    v_mfma_f32_16x16x32_bf16 v[128:131], v[240:243], v[44:47], v[128:131]
    v_exp_f32 v21, v21
    v_exp_f32 v22, v22
    v_exp_f32 v23, v23
    v_cvt_pk_bf16_f32 v8, v8, v9
    v_cvt_pk_bf16_f32 v9, v10, v11
    v_cvt_pk_bf16_f32 v10, v12, v13
    v_cvt_pk_bf16_f32 v11, v14, v15
    v_cvt_pk_bf16_f32 v12, v16, v17
    v_cvt_pk_bf16_f32 v13, v18, v19
    v_cvt_pk_bf16_f32 v14, v20, v21
    v_cvt_pk_bf16_f32 v15, v22, v23
    s_waitcnt lgkmcnt(0)
    s_cmp_gt_u32 s46, 2
    s_cbranch_scc1 L_aexit_16
    s_lshl_b32 s80, s32, 2
    v_add_u32 v158, s80, v251
    v_mov_b32 v159, 1
    ds_write_b32 v158, v159 offset:64
    s_mov_b32 s80, 0
    buffer_load_dwordx2 v[112:113], v217, s[64:67], s80 offen offset:0
    buffer_load_dwordx2 v[114:115], v217, s[64:67], s80 offen offset:2048
    s_mov_b32 s80, 4096
    buffer_load_dwordx2 v[116:117], v217, s[64:67], s80 offen offset:0
    buffer_load_dwordx2 v[118:119], v217, s[64:67], s80 offen offset:2048
    s_mov_b32 s80, 8192
    buffer_load_dwordx2 v[120:121], v217, s[64:67], s80 offen offset:0
    buffer_load_dwordx2 v[122:123], v217, s[64:67], s80 offen offset:2048
    s_mov_b32 s80, 12288
    buffer_load_dwordx2 v[124:125], v217, s[64:67], s80 offen offset:0
    buffer_load_dwordx2 v[126:127], v217, s[64:67], s80 offen offset:2048
    buffer_load_dwordx2 v[196:197], v219, s[12:15], 0 offen sc1
    ds_read_b128 v[88:91], v245 offset:28672
    ds_read_b128 v[92:95], v245 offset:29696
    v_mfma_f32_32x32x16_bf16 v[40:55], v[72:75], v[224:227], 0
    v_exp_f32 v24, v24
    v_exp_f32 v25, v25
    v_exp_f32 v26, v26
    v_mfma_f32_32x32x16_bf16 v[40:55], v[76:79], v[228:231], v[40:55]
    v_exp_f32 v27, v27
    v_exp_f32 v28, v28
    v_exp_f32 v29, v29
    v_mfma_f32_32x32x16_bf16 v[96:111], v[80:83], v[8:11], v[96:111]
    v_exp_f32 v30, v30
    v_exp_f32 v31, v31
    v_exp_f32 v32, v32
    v_mfma_f32_16x16x32_bf16 v[128:131], v[240:243], v[8:11], v[128:131]
    v_exp_f32 v33, v33
    v_mfma_f32_32x32x16_bf16 v[96:111], v[84:87], v[12:15], v[96:111]
    v_exp_f32 v34, v34
    v_exp_f32 v35, v35
    v_exp_f32 v36, v36
    v_mfma_f32_16x16x32_bf16 v[128:131], v[240:243], v[12:15], v[128:131]
    v_exp_f32 v37, v37
    v_exp_f32 v38, v38
    v_exp_f32 v39, v39
    v_cvt_pk_bf16_f32 v24, v24, v25
    v_cvt_pk_bf16_f32 v25, v26, v27
    v_cvt_pk_bf16_f32 v26, v28, v29
    v_cvt_pk_bf16_f32 v27, v30, v31
    v_cvt_pk_bf16_f32 v28, v32, v33
    v_cvt_pk_bf16_f32 v29, v34, v35
    v_cvt_pk_bf16_f32 v30, v36, v37
    v_cvt_pk_bf16_f32 v31, v38, v39
    s_waitcnt lgkmcnt(0)
    s_cmp_gt_u32 s46, 1
    s_cbranch_scc1 L_aexit_17
    s_setprio 0
    ds_read_b128 v[160:163], v245 offset:26624
    ds_read_b128 v[164:167], v245 offset:27648
    v_mfma_f32_32x32x16_bf16 v[96:111], v[88:91], v[24:27], v[96:111]
    v_exp_f32 v40, v40
    v_exp_f32 v41, v41
    v_exp_f32 v42, v42
    v_mfma_f32_16x16x32_bf16 v[128:131], v[240:243], v[24:27], v[128:131]
    v_exp_f32 v43, v43
    v_mfma_f32_32x32x16_bf16 v[96:111], v[92:95], v[28:31], v[96:111]
    v_exp_f32 v44, v44
    v_exp_f32 v45, v45
    v_exp_f32 v46, v46
    v_mfma_f32_16x16x32_bf16 v[128:131], v[240:243], v[28:31], v[128:131]
    v_exp_f32 v47, v47
    v_exp_f32 v48, v48
    v_exp_f32 v49, v49
    v_exp_f32 v50, v50
    v_exp_f32 v51, v51
    v_exp_f32 v52, v52
    v_exp_f32 v53, v53
    v_exp_f32 v54, v54
    v_exp_f32 v55, v55
    v_cvt_pk_bf16_f32 v40, v40, v41
    v_cvt_pk_bf16_f32 v41, v42, v43
    v_cvt_pk_bf16_f32 v42, v44, v45
    v_cvt_pk_bf16_f32 v43, v46, v47
    v_cvt_pk_bf16_f32 v44, v48, v49
    v_cvt_pk_bf16_f32 v45, v50, v51
    v_cvt_pk_bf16_f32 v46, v52, v53
    v_cvt_pk_bf16_f32 v47, v54, v55
    s_waitcnt lgkmcnt(0)
    v_mfma_f32_32x32x16_bf16 v[96:111], v[160:163], v[40:43], v[96:111]
    v_mfma_f32_16x16x32_bf16 v[128:131], v[240:243], v[40:43], v[128:131]
    v_mfma_f32_32x32x16_bf16 v[96:111], v[164:167], v[44:47], v[96:111]
    v_mfma_f32_16x16x32_bf16 v[128:131], v[240:243], v[44:47], v[128:131]
L_afin_8:
    s_setprio 1
    s_nop 7
    s_nop 3
    v_rcp_f32 v154, v128
    v_mul_f32 v153, 0, v96
    v_fmac_f32 v128, 0, v97
    v_fmac_f32 v153, 0, v98
    v_fmac_f32 v128, 0, v99
    v_fmac_f32 v153, 0, v100
    v_fmac_f32 v128, 0, v101
    v_fmac_f32 v153, 0, v102
    v_fmac_f32 v128, 0, v103
    v_fmac_f32 v153, 0, v104
    v_fmac_f32 v128, 0, v105
    v_fmac_f32 v153, 0, v106
    v_fmac_f32 v128, 0, v107
    v_fmac_f32 v153, 0, v108
    v_fmac_f32 v128, 0, v109
    v_fmac_f32 v153, 0, v110
    v_fmac_f32 v128, 0, v111
    v_add_f32 v153, v153, v128
    v_add_f32 v153, v153, v154
    v_cmp_gt_f32 vcc, 0x4e800000, v153
    s_mov_b32 s101, 0
    s_nop 0
    s_cmp_eq_u64 vcc, -1
    s_cbranch_scc0 L_exact
L_normH:
    v_mul_f32 v96, v96, v154
    v_mul_f32 v97, v97, v154
    v_mul_f32 v98, v98, v154
    v_mul_f32 v99, v99, v154
    v_mul_f32 v100, v100, v154
    v_mul_f32 v101, v101, v154
    v_mul_f32 v102, v102, v154
    v_mul_f32 v103, v103, v154
    v_mul_f32 v104, v104, v154
    v_mul_f32 v105, v105, v154
    v_mul_f32 v106, v106, v154
    v_mul_f32 v107, v107, v154
    v_mul_f32 v108, v108, v154
    v_mul_f32 v109, v109, v154
    v_mul_f32 v110, v110, v154
    v_mul_f32 v111, v111, v154
    v_cvt_pk_bf16_f32 v96, v96, v97
    v_cvt_pk_bf16_f32 v97, v98, v99
    v_cvt_pk_bf16_f32 v98, v100, v101
    v_cvt_pk_bf16_f32 v99, v102, v103
    v_cvt_pk_bf16_f32 v100, v104, v105
    v_cvt_pk_bf16_f32 v101, v106, v107
    v_cvt_pk_bf16_f32 v102, v108, v109
    v_cvt_pk_bf16_f32 v103, v110, v111
    buffer_store_dwordx4 v[96:99], v1, s[12:15], s47 offen sc1
    buffer_store_dwordx4 v[100:103], v1, s[12:15], s47 offen offset:1024 sc1
    s_waitcnt vmcnt(2)
    v_cmp_eq_u64 vcc, s[78:79], v[196:197]
    v_mov_b32 v4, 0x80000000
    s_nop 0
    s_cmp_eq_u64 vcc, -1
    s_cselect_b32 s38, 1, 0
    s_cselect_b64 vcc, -1, 0
    s_nop 0
    v_cndmask_b32 v4, v4, v216, vcc
    s_mov_b32 s80, 0xc00000
    buffer_load_dwordx4 v[168:171], v4, s[12:15], s80 offen
    s_add_u32 s80, s80, 4096
    buffer_load_dwordx4 v[172:175], v4, s[12:15], s80 offen
    s_add_u32 s80, s80, 4096
    buffer_load_dwordx4 v[176:179], v4, s[12:15], s80 offen
    s_add_u32 s80, s80, 4096
    buffer_load_dwordx4 v[180:183], v4, s[12:15], s80 offen
    s_waitcnt vmcnt(4)
    s_add_u32 s80, s89, 0x1818000
    v_mov_b32 v220, s78
    v_mov_b32 v221, s79
    s_mov_b64 exec, 1
    buffer_store_dwordx2 v[220:221], v252, s[12:15], s80 offen sc1
    s_mov_b64 exec, -1
    s_lshl_b32 s80, s32, 2
    v_add_u32 v222, s80, v251
    v_mov_b32 v223, 1
    ds_write_b32 v222, v223 offset:32
    s_mov_b32 s85, 0
L_lw_20:
    ds_read_b128 v[8:11], v251 offset:32
    s_waitcnt lgkmcnt(0)
    v_and_b32 v8, v8, v9
    v_and_b32 v10, v10, v11
    v_and_b32 v8, v8, v10
    s_add_u32 s85, s85, 1
    v_readfirstlane_b32 s80, v8
    s_nop 1
    s_cmp_lg_u32 s80, 0
    s_cbranch_scc1 L_lwd_21
    s_cmp_lt_u32 s85, 0x40000
    s_cbranch_scc1 L_lw_20
L_lwd_21:
    s_mov_b32 s85, 0
L_lw_22:
    ds_read_b128 v[8:11], v251 offset:48
    s_waitcnt lgkmcnt(0)
    v_and_b32 v8, v8, v9
    v_and_b32 v10, v10, v11
    v_and_b32 v8, v8, v10
    s_add_u32 s85, s85, 1
    v_readfirstlane_b32 s80, v8
    s_nop 1
    s_cmp_lg_u32 s80, 0
    s_cbranch_scc1 L_lwd_23
    s_cmp_lt_u32 s85, 0x40000
    s_cbranch_scc1 L_lw_22
L_lwd_23:
    s_and_b32 s83, s32, 3
    s_lshl_b32 s82, s83, 10
    s_lshl_b32 s81, s43, 4
    s_add_u32 s83, s83, s81
    s_add_u32 m0, s82, 4096
    s_add_u32 s81, s83, 52
    s_and_b32 s81, s81, 127
    s_lshl_b32 s81, s81, 14
    buffer_load_dwordx4 v250, s[60:63], s81 offen lds
    s_add_u32 m0, s82, 12288
    s_add_u32 s81, s83, 60
    s_and_b32 s81, s81, 127
    s_lshl_b32 s81, s81, 14
    buffer_load_dwordx4 v250, s[60:63], s81 offen lds
    s_add_u32 m0, s82, 20480
    s_add_u32 s81, s83, 68
    s_and_b32 s81, s81, 127
    s_lshl_b32 s81, s81, 14
    buffer_load_dwordx4 v250, s[60:63], s81 offen lds
    s_add_u32 m0, s82, 40960
    s_add_u32 s81, s83, 76
    s_and_b32 s81, s81, 127
    s_lshl_b32 s81, s81, 14
    buffer_load_dwordx4 v250, s[60:63], s81 offen lds
    s_add_u32 m0, s82, 49152
    s_add_u32 s81, s83, 84
    s_and_b32 s81, s81, 127
    s_lshl_b32 s81, s81, 14
    buffer_load_dwordx4 v250, s[60:63], s81 offen lds
    s_add_u32 m0, s82, 57344
    s_add_u32 s81, s83, 92
    s_and_b32 s81, s81, 127
    s_lshl_b32 s81, s81, 14
    buffer_load_dwordx4 v250, s[60:63], s81 offen lds
    s_add_u32 m0, s82, 65536
    s_add_u32 s81, s83, 100
    s_and_b32 s81, s81, 127
    s_lshl_b32 s81, s81, 14
    buffer_load_dwordx4 v250, s[60:63], s81 offen lds
    s_add_u32 m0, s82, 86016
    s_add_u32 s81, s83, 108
    s_and_b32 s81, s81, 127
    s_lshl_b32 s81, s81, 14
    buffer_load_dwordx4 v250, s[60:63], s81 offen lds
    s_add_u32 m0, s82, 94208
    s_add_u32 s81, s83, 116
    s_and_b32 s81, s81, 127
    s_lshl_b32 s81, s81, 14
    buffer_load_dwordx4 v250, s[60:63], s81 offen lds
    s_add_u32 m0, s82, 102400
    s_add_u32 s81, s83, 124
    s_and_b32 s81, s81, 127
    s_lshl_b32 s81, s81, 14
    buffer_load_dwordx4 v250, s[60:63], s81 offen lds
    s_cmp_eq_u32 s38, 0
    s_cbranch_scc1 L_ylate_18
    s_waitcnt vmcnt(10)
L_yback_19:
    v_lshlrev_b32 v4, 16, v168
    v_lshlrev_b32 v5, 16, v112
    v_mul_f32 v24, v4, v5
    v_lshlrev_b32 v4, 16, v172
    v_and_b32 v5, 0xffff0000, v112
    v_mul_f32 v25, v4, v5
    v_lshlrev_b32 v4, 16, v176
    v_lshlrev_b32 v5, 16, v113
    v_mul_f32 v26, v4, v5
    v_lshlrev_b32 v4, 16, v180
    v_and_b32 v5, 0xffff0000, v113
    v_mul_f32 v27, v4, v5
    v_cvt_pk_bf16_f32 v24, v24, v25
    v_cvt_pk_bf16_f32 v25, v26, v27
    v_and_b32 v4, 0xffff0000, v168
    v_lshlrev_b32 v5, 16, v114
    v_mul_f32 v28, v4, v5
    v_and_b32 v4, 0xffff0000, v172
    v_and_b32 v5, 0xffff0000, v114
    v_mul_f32 v29, v4, v5
    v_and_b32 v4, 0xffff0000, v176
    v_lshlrev_b32 v5, 16, v115
    v_mul_f32 v30, v4, v5
    v_and_b32 v4, 0xffff0000, v180
    v_and_b32 v5, 0xffff0000, v115
    v_mul_f32 v31, v4, v5
    v_cvt_pk_bf16_f32 v28, v28, v29
    v_cvt_pk_bf16_f32 v29, v30, v31
    v_lshlrev_b32 v4, 16, v169
    v_lshlrev_b32 v5, 16, v116
    v_mul_f32 v32, v4, v5
    v_lshlrev_b32 v4, 16, v173
    v_and_b32 v5, 0xffff0000, v116
    v_mul_f32 v33, v4, v5
    v_lshlrev_b32 v4, 16, v177
    v_lshlrev_b32 v5, 16, v117
    v_mul_f32 v34, v4, v5
    v_lshlrev_b32 v4, 16, v181
    v_and_b32 v5, 0xffff0000, v117
    v_mul_f32 v35, v4, v5
    v_cvt_pk_bf16_f32 v32, v32, v33
    v_cvt_pk_bf16_f32 v33, v34, v35
    v_and_b32 v4, 0xffff0000, v169
    v_lshlrev_b32 v5, 16, v118
    v_mul_f32 v36, v4, v5
    v_and_b32 v4, 0xffff0000, v173
    v_and_b32 v5, 0xffff0000, v118
    v_mul_f32 v37, v4, v5
    v_and_b32 v4, 0xffff0000, v177
    v_lshlrev_b32 v5, 16, v119
    v_mul_f32 v38, v4, v5
    v_and_b32 v4, 0xffff0000, v181
    v_and_b32 v5, 0xffff0000, v119
    v_mul_f32 v39, v4, v5
    v_cvt_pk_bf16_f32 v36, v36, v37
    v_cvt_pk_bf16_f32 v37, v38, v39
    v_lshlrev_b32 v4, 16, v170
    v_lshlrev_b32 v5, 16, v120
    v_mul_f32 v40, v4, v5
    v_lshlrev_b32 v4, 16, v174
    v_and_b32 v5, 0xffff0000, v120
    v_mul_f32 v41, v4, v5
    v_lshlrev_b32 v4, 16, v178
    v_lshlrev_b32 v5, 16, v121
    v_mul_f32 v42, v4, v5
    v_lshlrev_b32 v4, 16, v182
    v_and_b32 v5, 0xffff0000, v121
    v_mul_f32 v43, v4, v5
    v_cvt_pk_bf16_f32 v40, v40, v41
    v_cvt_pk_bf16_f32 v41, v42, v43
    v_and_b32 v4, 0xffff0000, v170
    v_lshlrev_b32 v5, 16, v122
    v_mul_f32 v44, v4, v5
    v_and_b32 v4, 0xffff0000, v174
    v_and_b32 v5, 0xffff0000, v122
    v_mul_f32 v45, v4, v5
    v_and_b32 v4, 0xffff0000, v178
    v_lshlrev_b32 v5, 16, v123
    v_mul_f32 v46, v4, v5
    v_and_b32 v4, 0xffff0000, v182
    v_and_b32 v5, 0xffff0000, v123
    v_mul_f32 v47, v4, v5
    v_cvt_pk_bf16_f32 v44, v44, v45
    v_cvt_pk_bf16_f32 v45, v46, v47
    v_lshlrev_b32 v4, 16, v171
    v_lshlrev_b32 v5, 16, v124
    v_mul_f32 v48, v4, v5
    v_lshlrev_b32 v4, 16, v175
    v_and_b32 v5, 0xffff0000, v124
    v_mul_f32 v49, v4, v5
    v_lshlrev_b32 v4, 16, v179
    v_lshlrev_b32 v5, 16, v125
    v_mul_f32 v50, v4, v5
    v_lshlrev_b32 v4, 16, v183
    v_and_b32 v5, 0xffff0000, v125
    v_mul_f32 v51, v4, v5
    v_cvt_pk_bf16_f32 v48, v48, v49
    v_cvt_pk_bf16_f32 v49, v50, v51
    v_and_b32 v4, 0xffff0000, v171
    v_lshlrev_b32 v5, 16, v126
    v_mul_f32 v52, v4, v5
    v_and_b32 v4, 0xffff0000, v175
    v_and_b32 v5, 0xffff0000, v126
    v_mul_f32 v53, v4, v5
    v_and_b32 v4, 0xffff0000, v179
    v_lshlrev_b32 v5, 16, v127
    v_mul_f32 v54, v4, v5
    v_and_b32 v4, 0xffff0000, v183
    v_and_b32 v5, 0xffff0000, v127
    v_mul_f32 v55, v4, v5
    v_cvt_pk_bf16_f32 v52, v52, v53
    v_cvt_pk_bf16_f32 v53, v54, v55
    s_waitcnt vmcnt(0)
    s_lshl_b32 s80, s32, 2
    v_add_u32 v4, s80, v251
    v_mov_b32 v5, 1
    ds_write_b32 v4, v5 offset:0
    s_setprio 0
    s_mov_b32 s85, 0
L_aw_1027:
    ds_read_b32 v5, v4 offset:80
    s_add_u32 s85, s85, 1
    s_waitcnt lgkmcnt(0)
    v_cmp_ne_u32 vcc, 0, v5
    s_cbranch_vccnz L_awd_1028
    s_sleep 4
    s_cmp_lt_u32 s85, 64
    s_cbranch_scc1 L_aw_1027
L_awd_1028:
    s_mov_b32 s80, 0
    buffer_store_dwordx2 v[24:25], v218, s[68:71], s80 offen sc1
    s_mov_b32 s80, 4096
    buffer_store_dwordx2 v[28:29], v218, s[68:71], s80 offen sc1
    s_mov_b32 s80, 8192
    buffer_store_dwordx2 v[32:33], v218, s[68:71], s80 offen sc1
    s_mov_b32 s80, 12288
    buffer_store_dwordx2 v[36:37], v218, s[68:71], s80 offen sc1
    s_mov_b32 s80, 16384
    buffer_store_dwordx2 v[40:41], v218, s[68:71], s80 offen sc1
    s_mov_b32 s80, 20480
    buffer_store_dwordx2 v[44:45], v218, s[68:71], s80 offen sc1
    s_mov_b32 s80, 24576
    buffer_store_dwordx2 v[48:49], v218, s[68:71], s80 offen sc1
    s_mov_b32 s80, 28672
    buffer_store_dwordx2 v[52:53], v218, s[68:71], s80 offen sc1
    s_endpgm
L_M:
    s_load_dwordx2 s[12:13], s[0:1], 88
    s_load_dwordx2 s[60:61], s[0:1], 64
    s_load_dwordx2 s[64:65], s[0:1], 0
    s_load_dwordx2 s[68:69], s[0:1], 72
    s_load_dwordx2 s[72:73], s[0:1], 80
    s_getpc_b64 s[52:53]
L_pc:
    s_sub_u32 s52, s52, L_pc-concat_heads__ssm_conv_h3__sliding_block__prompt_kernel
    s_subb_u32 s53, s53, 0
    s_mov_b32 s54, L_end-concat_heads__ssm_conv_h3__sliding_block__prompt_kernel
    s_mov_b32 s55, 0x20000
    s_lshl_b32 s56, s35, 11
    v_lshlrev_b32 v189, 6, v0
    s_cmp_lg_u32 s32, 1
    s_cbranch_scc1 L_nocp_1029
    s_mov_b32 exec_hi, 0
    buffer_load_dword v188, v189, s[52:55], s56 offen
    s_mov_b32 exec_hi, -1
L_nocp_1029:
    s_lshl_b32 s80, s35, 2
    s_add_u32 s80, s80, s32
    s_mul_i32 s81, s80, 8
    v_and_b32 v3, 7, v0
    v_lshrrev_b32 v184, 3, v0
    v_mul_u32_u24 v184, 768, v184
    v_add3_u32 v184, v184, v3, s81
    v_lshlrev_b32 v184, 11, v184
    s_lshr_b32 s81, s3, 2
    s_lshl_b32 s81, s81, 10
    s_add_u32 s81, s81, 0x180
    v_add_u32 v184, s81, v184
    s_bitcmp1_b32 s3, 1
    s_cselect_b32 s81, 0, 8
    s_cmp_lt_u32 s35, 24
    s_cselect_b32 s81, s81, 0
    v_mov_b32 v2, 0x80000000
    v_cmp_gt_u32 vcc, s81, v3
    s_nop 1
    v_cndmask_b32 v184, v2, v184, vcc
    s_or_b32 s80, s2, s32
    s_cbranch_scc1 L_notok_1030
    s_mov_b32 s74, 256
    s_mov_b32 s75, 0x20000
    s_memrealtime s[78:79]
    s_waitcnt lgkmcnt(0)
    s_or_b32 s78, s78, 1
    v_mov_b32 v180, s78
    v_mov_b32 v181, s79
    s_mov_b64 exec, 1
    buffer_store_dwordx2 v[180:181], v252, s[72:75], 0 offen sc1
    s_mov_b64 exec, -1
L_notok_1030:
    s_and_b32 s44, s32, 1
    s_lshr_b32 s41, s32, 1
    s_lshl_b32 s40, s44, 1
    v_and_b32 v10, 15, v0
    v_lshrrev_b32 v11, 4, v0
    v_lshrrev_b32 v12, 1, v10
    v_xor_b32 v12, v12, v11
    s_lshl_b32 s46, s44, 13
    v_lshl_add_u32 v13, v10, 7, s46
    v_lshl_add_u32 v2, v12, 4, v13
    v_xor_b32 v3, 64, v2
    v_add_u32 v4, 81920, v2
    v_add_u32 v5, 81920, v3
    v_lshrrev_b32 v12, 2, v10
    v_lshl_add_u32 v12, v11, 3, v12
    v_mul_u32_u24 v12, 384, v12
    v_lshrrev_b32 v13, 3, v10
    v_xor_b32 v13, s41, v13
    v_lshl_add_u32 v12, v13, 6, v12
    v_and_b32 v13, 1, v11
    v_lshl_add_u32 v12, v13, 5, v12
    v_and_b32 v13, 3, v10
    v_lshl_add_u32 v12, v13, 3, v12
    v_add_u32 v6, 16384, v12
    v_xor_b32 v7, 32, v6
    v_add_u32 v8, 81920, v6
    v_add_u32 v9, 81920, v7
    s_waitcnt lgkmcnt(0)
    s_barrier
    ds_read_b128 v[16:19], v4 offset:40960
    ds_read_b64_tr_b16 v[32:33], v8 offset:40960
    ds_read_b64_tr_b16 v[34:35], v8 offset:42496
    ds_read_b128 v[20:23], v4 offset:43008
    ds_read_b128 v[24:27], v4 offset:45056
    ds_read_b128 v[28:31], v4 offset:47104
    ds_read_b64_tr_b16 v[36:37], v9 offset:40960
    ds_read_b64_tr_b16 v[38:39], v9 offset:42496
    ds_read_b64_tr_b16 v[40:41], v8 offset:41088
    ds_read_b64_tr_b16 v[42:43], v8 offset:42624
    ds_read_b64_tr_b16 v[44:45], v9 offset:41088
    ds_read_b64_tr_b16 v[46:47], v9 offset:42624
    ds_read_b64_tr_b16 v[48:49], v8 offset:41216
    ds_read_b64_tr_b16 v[50:51], v8 offset:42752
    ds_read_b64_tr_b16 v[52:53], v9 offset:41216
    ds_read_b64_tr_b16 v[54:55], v9 offset:42752
    s_waitcnt lgkmcnt(6)
    v_mfma_f32_16x16x32_bf16 v[80:83], v[32:35], v[16:19], 0
    ds_read_b128 v[200:203], v5 offset:40960
    v_mfma_f32_16x16x32_bf16 v[88:91], v[32:35], v[20:23], 0
    ds_read_b64_tr_b16 v[56:57], v8 offset:53248
    v_mfma_f32_16x16x32_bf16 v[96:99], v[32:35], v[24:27], 0
    ds_read_b64_tr_b16 v[58:59], v8 offset:54784
    v_mfma_f32_16x16x32_bf16 v[104:107], v[32:35], v[28:31], 0
    ds_read_b128 v[204:207], v5 offset:43008
    v_mfma_f32_16x16x32_bf16 v[84:87], v[36:39], v[16:19], 0
    ds_read_b128 v[208:211], v5 offset:45056
    v_mfma_f32_16x16x32_bf16 v[92:95], v[36:39], v[20:23], 0
    ds_read_b128 v[212:215], v5 offset:47104
    v_mfma_f32_16x16x32_bf16 v[100:103], v[36:39], v[24:27], 0
    ds_read_b64_tr_b16 v[60:61], v9 offset:53248
    v_mfma_f32_16x16x32_bf16 v[108:111], v[36:39], v[28:31], 0
    ds_read_b64_tr_b16 v[62:63], v9 offset:54784
    v_mfma_f32_16x16x32_bf16 v[112:115], v[40:43], v[16:19], 0
    ds_read_b64_tr_b16 v[64:65], v8 offset:53376
    v_mfma_f32_16x16x32_bf16 v[120:123], v[40:43], v[20:23], 0
    ds_read_b64_tr_b16 v[66:67], v8 offset:54912
    v_mfma_f32_16x16x32_bf16 v[128:131], v[40:43], v[24:27], 0
    ds_read_b64_tr_b16 v[68:69], v9 offset:53376
    v_mfma_f32_16x16x32_bf16 v[136:139], v[40:43], v[28:31], 0
    ds_read_b64_tr_b16 v[70:71], v9 offset:54912
    s_waitcnt lgkmcnt(12)
    v_mfma_f32_16x16x32_bf16 v[116:119], v[44:47], v[16:19], 0
    ds_read_b64_tr_b16 v[72:73], v8 offset:53504
    v_mfma_f32_16x16x32_bf16 v[124:127], v[44:47], v[20:23], 0
    ds_read_b64_tr_b16 v[74:75], v8 offset:55040
    v_mfma_f32_16x16x32_bf16 v[132:135], v[44:47], v[24:27], 0
    ds_read_b64_tr_b16 v[76:77], v9 offset:53504
    v_mfma_f32_16x16x32_bf16 v[140:143], v[44:47], v[28:31], 0
    ds_read_b64_tr_b16 v[78:79], v9 offset:55040
    v_mfma_f32_16x16x32_bf16 v[144:147], v[16:19], v[48:51], 0
    v_mfma_f32_16x16x32_bf16 v[152:155], v[20:23], v[48:51], 0
    v_mfma_f32_16x16x32_bf16 v[160:163], v[24:27], v[48:51], 0
    v_mfma_f32_16x16x32_bf16 v[168:171], v[28:31], v[48:51], 0
    v_mfma_f32_16x16x32_bf16 v[148:151], v[16:19], v[52:55], 0
    v_mfma_f32_16x16x32_bf16 v[156:159], v[20:23], v[52:55], 0
    v_mfma_f32_16x16x32_bf16 v[164:167], v[24:27], v[52:55], 0
    v_mfma_f32_16x16x32_bf16 v[172:175], v[28:31], v[52:55], 0
    s_waitcnt lgkmcnt(0)
    v_mfma_f32_16x16x32_bf16 v[80:83], v[56:59], v[200:203], v[80:83]
    v_mfma_f32_16x16x32_bf16 v[88:91], v[56:59], v[204:207], v[88:91]
    s_barrier
    ds_read_b128 v[16:19], v4 offset:0
    v_mfma_f32_16x16x32_bf16 v[96:99], v[56:59], v[208:211], v[96:99]
    ds_read_b64_tr_b16 v[32:33], v8 offset:0
    v_mfma_f32_16x16x32_bf16 v[104:107], v[56:59], v[212:215], v[104:107]
    ds_read_b64_tr_b16 v[34:35], v8 offset:1536
    v_mfma_f32_16x16x32_bf16 v[84:87], v[60:63], v[200:203], v[84:87]
    ds_read_b128 v[20:23], v4 offset:2048
    v_mfma_f32_16x16x32_bf16 v[92:95], v[60:63], v[204:207], v[92:95]
    ds_read_b128 v[24:27], v4 offset:4096
    v_mfma_f32_16x16x32_bf16 v[100:103], v[60:63], v[208:211], v[100:103]
    ds_read_b128 v[28:31], v4 offset:6144
    v_mfma_f32_16x16x32_bf16 v[108:111], v[60:63], v[212:215], v[108:111]
    ds_read_b64_tr_b16 v[36:37], v9 offset:0
    v_mfma_f32_16x16x32_bf16 v[112:115], v[64:67], v[200:203], v[112:115]
    ds_read_b64_tr_b16 v[38:39], v9 offset:1536
    v_mfma_f32_16x16x32_bf16 v[120:123], v[64:67], v[204:207], v[120:123]
    ds_read_b64_tr_b16 v[40:41], v8 offset:128
    v_mfma_f32_16x16x32_bf16 v[128:131], v[64:67], v[208:211], v[128:131]
    ds_read_b64_tr_b16 v[42:43], v8 offset:1664
    s_mov_b64 exec, 0xffffff00
    buffer_load_dword v177, v184, s[8:11], 0 offen
    s_mov_b64 exec, -1
    v_mfma_f32_16x16x32_bf16 v[136:139], v[64:67], v[212:215], v[136:139]
    ds_read_b64_tr_b16 v[44:45], v9 offset:128
    v_mfma_f32_16x16x32_bf16 v[116:119], v[68:71], v[200:203], v[116:119]
    ds_read_b64_tr_b16 v[46:47], v9 offset:1664
    v_mfma_f32_16x16x32_bf16 v[124:127], v[68:71], v[204:207], v[124:127]
    ds_read_b64_tr_b16 v[48:49], v8 offset:256
    v_mfma_f32_16x16x32_bf16 v[132:135], v[68:71], v[208:211], v[132:135]
    ds_read_b64_tr_b16 v[50:51], v8 offset:1792
    v_mfma_f32_16x16x32_bf16 v[140:143], v[68:71], v[212:215], v[140:143]
    ds_read_b64_tr_b16 v[52:53], v9 offset:256
    v_mfma_f32_16x16x32_bf16 v[144:147], v[200:203], v[72:75], v[144:147]
    ds_read_b64_tr_b16 v[54:55], v9 offset:1792
    v_mfma_f32_16x16x32_bf16 v[152:155], v[204:207], v[72:75], v[152:155]
    v_mfma_f32_16x16x32_bf16 v[160:163], v[208:211], v[72:75], v[160:163]
    v_mfma_f32_16x16x32_bf16 v[168:171], v[212:215], v[72:75], v[168:171]
    v_mfma_f32_16x16x32_bf16 v[148:151], v[200:203], v[76:79], v[148:151]
    v_mfma_f32_16x16x32_bf16 v[156:159], v[204:207], v[76:79], v[156:159]
    v_mfma_f32_16x16x32_bf16 v[164:167], v[208:211], v[76:79], v[164:167]
    v_mfma_f32_16x16x32_bf16 v[172:175], v[212:215], v[76:79], v[172:175]
    s_waitcnt lgkmcnt(6)
    v_mfma_f32_16x16x32_bf16 v[80:83], v[32:35], v[16:19], v[80:83]
    ds_read_b128 v[200:203], v5 offset:0
    v_mfma_f32_16x16x32_bf16 v[88:91], v[32:35], v[20:23], v[88:91]
    ds_read_b64_tr_b16 v[56:57], v8 offset:12288
    v_mfma_f32_16x16x32_bf16 v[96:99], v[32:35], v[24:27], v[96:99]
    ds_read_b64_tr_b16 v[58:59], v8 offset:13824
    v_mfma_f32_16x16x32_bf16 v[104:107], v[32:35], v[28:31], v[104:107]
    ds_read_b128 v[204:207], v5 offset:2048
    v_mfma_f32_16x16x32_bf16 v[84:87], v[36:39], v[16:19], v[84:87]
    ds_read_b128 v[208:211], v5 offset:4096
    v_mfma_f32_16x16x32_bf16 v[92:95], v[36:39], v[20:23], v[92:95]
    ds_read_b128 v[212:215], v5 offset:6144
    v_mfma_f32_16x16x32_bf16 v[100:103], v[36:39], v[24:27], v[100:103]
    ds_read_b64_tr_b16 v[60:61], v9 offset:12288
    v_mfma_f32_16x16x32_bf16 v[108:111], v[36:39], v[28:31], v[108:111]
    ds_read_b64_tr_b16 v[62:63], v9 offset:13824
    v_mfma_f32_16x16x32_bf16 v[112:115], v[40:43], v[16:19], v[112:115]
    ds_read_b64_tr_b16 v[64:65], v8 offset:12416
    v_mfma_f32_16x16x32_bf16 v[120:123], v[40:43], v[20:23], v[120:123]
    ds_read_b64_tr_b16 v[66:67], v8 offset:13952
    v_mfma_f32_16x16x32_bf16 v[128:131], v[40:43], v[24:27], v[128:131]
    ds_read_b64_tr_b16 v[68:69], v9 offset:12416
    v_mfma_f32_16x16x32_bf16 v[136:139], v[40:43], v[28:31], v[136:139]
    ds_read_b64_tr_b16 v[70:71], v9 offset:13952
    s_waitcnt lgkmcnt(12)
    v_mfma_f32_16x16x32_bf16 v[116:119], v[44:47], v[16:19], v[116:119]
    ds_read_b64_tr_b16 v[72:73], v8 offset:12544
    v_mfma_f32_16x16x32_bf16 v[124:127], v[44:47], v[20:23], v[124:127]
    ds_read_b64_tr_b16 v[74:75], v8 offset:14080
    v_mfma_f32_16x16x32_bf16 v[132:135], v[44:47], v[24:27], v[132:135]
    ds_read_b64_tr_b16 v[76:77], v9 offset:12544
    v_mfma_f32_16x16x32_bf16 v[140:143], v[44:47], v[28:31], v[140:143]
    ds_read_b64_tr_b16 v[78:79], v9 offset:14080
    v_mfma_f32_16x16x32_bf16 v[144:147], v[16:19], v[48:51], v[144:147]
    v_mfma_f32_16x16x32_bf16 v[152:155], v[20:23], v[48:51], v[152:155]
    v_mfma_f32_16x16x32_bf16 v[160:163], v[24:27], v[48:51], v[160:163]
    v_mfma_f32_16x16x32_bf16 v[168:171], v[28:31], v[48:51], v[168:171]
    v_mfma_f32_16x16x32_bf16 v[148:151], v[16:19], v[52:55], v[148:151]
    v_mfma_f32_16x16x32_bf16 v[156:159], v[20:23], v[52:55], v[156:159]
    v_mfma_f32_16x16x32_bf16 v[164:167], v[24:27], v[52:55], v[164:167]
    v_mfma_f32_16x16x32_bf16 v[172:175], v[28:31], v[52:55], v[172:175]
    s_waitcnt lgkmcnt(0)
    v_mfma_f32_16x16x32_bf16 v[80:83], v[56:59], v[200:203], v[80:83]
    v_mfma_f32_16x16x32_bf16 v[88:91], v[56:59], v[204:207], v[88:91]
    s_lshl_b32 s89, s2, 7
    s_lshl_b32 s81, s32, 3
    s_add_u32 s89, s89, s81
    s_mov_b32 s14, 0x1a00000
    s_mov_b32 s15, 0x20000
    s_mov_b32 s62, 0x200000
    s_mov_b32 s63, 0x20000
    s_mov_b32 s66, 0x400000
    s_mov_b32 s67, 0x20000
    s_mov_b32 s70, 0x800000
    s_mov_b32 s71, 0x20000
    s_mov_b32 s74, 0x100
    s_mov_b32 s75, 0x20000
    v_mov_b32 v251, 158208
    s_lshl_b32 s46, s34, 1
    s_add_u32 s46, s46, s41
    s_lshl_b32 s46, s46, 6
    s_lshl_b32 s47, s33, 2
    s_add_u32 s46, s46, s47
    s_add_u32 s48, s46, s40
    s_lshl_b32 s48, s48, 11
    s_add_u32 s49, s48, 0x800000
    s_add_u32 s48, s48, 0x400000
    s_mul_i32 s80, s41, 49152
    s_lshl_b32 s81, s44, 12
    s_add_u32 s80, s80, s81
    v_add_u32 v182, s80, v1
    s_lshl_b32 s80, s32, 11
    s_add_u32 s80, s80, 98304
    v_add_u32 v183, s80, v1
    s_add_u32 s38, s33, s44
    s_sub_u32 s80, s38, 2
    s_max_i32 s80, s80, 0
    v_mov_b32 v13, s80
    v_mov_b32 v14, s34
    v_lshrrev_b32 v190, 3, v13
    v_lshrrev_b32 v12, 2, v14
    v_lshl_add_u32 v190, v12, 1, v190
    v_and_b32 v12, 7, v13
    v_lshl_add_u32 v190, v12, 3, v190
    v_and_b32 v12, 3, v14
    v_lshl_add_u32 v190, v12, 6, v190
    v_lshlrev_b32 v190, 7, v190
    v_and_b32 v13, 1, v0
    v_lshl_add_u32 v190, v13, 3, v190
    s_lshl_b32 s80, s41, 4
    s_add_u32 s80, s80, 0x1808000
    v_add_u32 v190, s80, v190
    s_lshl_b32 s80, s44, 2
    s_add_u32 s36, s46, s80
    s_lshl_b32 s36, s36, 11
    s_add_u32 s36, s36, 0x3fc000
    s_mul_i32 s37, s41, 49152
    s_lshl_b32 s80, s44, 13
    s_add_u32 s37, s37, s80
    s_barrier
    ds_read_b128 v[16:19], v2 offset:0
    v_mfma_f32_16x16x32_bf16 v[96:99], v[56:59], v[208:211], v[96:99]
    ds_read_b64_tr_b16 v[32:33], v6 offset:0
    v_mfma_f32_16x16x32_bf16 v[104:107], v[56:59], v[212:215], v[104:107]
    ds_read_b64_tr_b16 v[34:35], v6 offset:1536
    v_mfma_f32_16x16x32_bf16 v[84:87], v[60:63], v[200:203], v[84:87]
    ds_read_b128 v[20:23], v2 offset:2048
    v_mfma_f32_16x16x32_bf16 v[92:95], v[60:63], v[204:207], v[92:95]
    ds_read_b128 v[24:27], v2 offset:4096
    v_mfma_f32_16x16x32_bf16 v[100:103], v[60:63], v[208:211], v[100:103]
    ds_read_b128 v[28:31], v2 offset:6144
    v_mfma_f32_16x16x32_bf16 v[108:111], v[60:63], v[212:215], v[108:111]
    ds_read_b64_tr_b16 v[36:37], v7 offset:0
    v_mfma_f32_16x16x32_bf16 v[112:115], v[64:67], v[200:203], v[112:115]
    ds_read_b64_tr_b16 v[38:39], v7 offset:1536
    v_mfma_f32_16x16x32_bf16 v[120:123], v[64:67], v[204:207], v[120:123]
    ds_read_b64_tr_b16 v[40:41], v6 offset:128
    v_mfma_f32_16x16x32_bf16 v[128:131], v[64:67], v[208:211], v[128:131]
    ds_read_b64_tr_b16 v[42:43], v6 offset:1664
    v_mfma_f32_16x16x32_bf16 v[136:139], v[64:67], v[212:215], v[136:139]
    ds_read_b64_tr_b16 v[44:45], v7 offset:128
    v_mfma_f32_16x16x32_bf16 v[116:119], v[68:71], v[200:203], v[116:119]
    ds_read_b64_tr_b16 v[46:47], v7 offset:1664
    v_mfma_f32_16x16x32_bf16 v[124:127], v[68:71], v[204:207], v[124:127]
    ds_read_b64_tr_b16 v[48:49], v6 offset:256
    v_mfma_f32_16x16x32_bf16 v[132:135], v[68:71], v[208:211], v[132:135]
    ds_read_b64_tr_b16 v[50:51], v6 offset:1792
    v_mfma_f32_16x16x32_bf16 v[140:143], v[68:71], v[212:215], v[140:143]
    ds_read_b64_tr_b16 v[52:53], v7 offset:256
    v_mfma_f32_16x16x32_bf16 v[144:147], v[200:203], v[72:75], v[144:147]
    ds_read_b64_tr_b16 v[54:55], v7 offset:1792
    v_mfma_f32_16x16x32_bf16 v[152:155], v[204:207], v[72:75], v[152:155]
    v_mfma_f32_16x16x32_bf16 v[160:163], v[208:211], v[72:75], v[160:163]
    v_mfma_f32_16x16x32_bf16 v[168:171], v[212:215], v[72:75], v[168:171]
    v_mfma_f32_16x16x32_bf16 v[148:151], v[200:203], v[76:79], v[148:151]
    v_mfma_f32_16x16x32_bf16 v[156:159], v[204:207], v[76:79], v[156:159]
    v_mfma_f32_16x16x32_bf16 v[164:167], v[208:211], v[76:79], v[164:167]
    v_mfma_f32_16x16x32_bf16 v[172:175], v[212:215], v[76:79], v[172:175]
    s_waitcnt lgkmcnt(6)
    v_mfma_f32_16x16x32_bf16 v[80:83], v[32:35], v[16:19], v[80:83]
    ds_read_b128 v[200:203], v3 offset:0
    v_mfma_f32_16x16x32_bf16 v[88:91], v[32:35], v[20:23], v[88:91]
    ds_read_b64_tr_b16 v[56:57], v6 offset:12288
    v_mfma_f32_16x16x32_bf16 v[96:99], v[32:35], v[24:27], v[96:99]
    ds_read_b64_tr_b16 v[58:59], v6 offset:13824
    v_mfma_f32_16x16x32_bf16 v[104:107], v[32:35], v[28:31], v[104:107]
    ds_read_b128 v[204:207], v3 offset:2048
    v_mfma_f32_16x16x32_bf16 v[84:87], v[36:39], v[16:19], v[84:87]
    ds_read_b128 v[208:211], v3 offset:4096
    v_mfma_f32_16x16x32_bf16 v[92:95], v[36:39], v[20:23], v[92:95]
    ds_read_b128 v[212:215], v3 offset:6144
    v_mfma_f32_16x16x32_bf16 v[100:103], v[36:39], v[24:27], v[100:103]
    ds_read_b64_tr_b16 v[60:61], v7 offset:12288
    v_mfma_f32_16x16x32_bf16 v[108:111], v[36:39], v[28:31], v[108:111]
    ds_read_b64_tr_b16 v[62:63], v7 offset:13824
    v_mfma_f32_16x16x32_bf16 v[112:115], v[40:43], v[16:19], v[112:115]
    ds_read_b64_tr_b16 v[64:65], v6 offset:12416
    v_mfma_f32_16x16x32_bf16 v[120:123], v[40:43], v[20:23], v[120:123]
    ds_read_b64_tr_b16 v[66:67], v6 offset:13952
    v_mfma_f32_16x16x32_bf16 v[128:131], v[40:43], v[24:27], v[128:131]
    ds_read_b64_tr_b16 v[68:69], v7 offset:12416
    v_mfma_f32_16x16x32_bf16 v[136:139], v[40:43], v[28:31], v[136:139]
    ds_read_b64_tr_b16 v[70:71], v7 offset:13952
    s_waitcnt lgkmcnt(12)
    v_mfma_f32_16x16x32_bf16 v[116:119], v[44:47], v[16:19], v[116:119]
    ds_read_b64_tr_b16 v[72:73], v6 offset:12544
    v_mfma_f32_16x16x32_bf16 v[124:127], v[44:47], v[20:23], v[124:127]
    ds_read_b64_tr_b16 v[74:75], v6 offset:14080
    v_mfma_f32_16x16x32_bf16 v[132:135], v[44:47], v[24:27], v[132:135]
    ds_read_b64_tr_b16 v[76:77], v7 offset:12544
    v_mfma_f32_16x16x32_bf16 v[140:143], v[44:47], v[28:31], v[140:143]
    ds_read_b64_tr_b16 v[78:79], v7 offset:14080
    v_mfma_f32_16x16x32_bf16 v[144:147], v[16:19], v[48:51], v[144:147]
    v_mfma_f32_16x16x32_bf16 v[152:155], v[20:23], v[48:51], v[152:155]
    v_mfma_f32_16x16x32_bf16 v[160:163], v[24:27], v[48:51], v[160:163]
    v_mfma_f32_16x16x32_bf16 v[168:171], v[28:31], v[48:51], v[168:171]
    v_mfma_f32_16x16x32_bf16 v[148:151], v[16:19], v[52:55], v[148:151]
    v_mfma_f32_16x16x32_bf16 v[156:159], v[20:23], v[52:55], v[156:159]
    v_mfma_f32_16x16x32_bf16 v[164:167], v[24:27], v[52:55], v[164:167]
    v_mfma_f32_16x16x32_bf16 v[172:175], v[28:31], v[52:55], v[172:175]
    s_waitcnt lgkmcnt(0)
    v_mfma_f32_16x16x32_bf16 v[80:83], v[56:59], v[200:203], v[80:83]
    v_mfma_f32_16x16x32_bf16 v[88:91], v[56:59], v[204:207], v[88:91]
    v_and_b32 v13, 31, v0
    v_lshrrev_b32 v14, 5, v0
    v_lshlrev_b32 v14, 2, v14
    v_sub_u32 v13, v13, v14
    v_cmp_le_i32 s[4:5], 0, v13
    v_cmp_le_i32 s[6:7], 1, v13
    v_cmp_le_i32 s[16:17], 2, v13
    v_cmp_le_i32 s[18:19], 3, v13
    v_cmp_le_i32 s[20:21], 8, v13
    v_cmp_le_i32 s[22:23], 9, v13
    v_cmp_le_i32 s[24:25], 10, v13
    v_cmp_le_i32 s[26:27], 11, v13
    v_cmp_le_i32 s[28:29], 16, v13
    v_cmp_le_i32 s[30:31], 17, v13
    v_cmp_le_i32 s[58:59], 18, v13
    v_cmp_le_i32 s[76:77], 19, v13
    v_cmp_le_i32 s[92:93], 24, v13
    v_cmp_le_i32 s[94:95], 25, v13
    v_cmp_le_i32 s[96:97], 26, v13
    v_cmp_le_i32 s[98:99], 27, v13
    v_mov_b32 v244, 0xf149f2ca
    v_mov_b32 v13, 0xffff
    v_mov_b32 v14, 0xffff0000
    v_cndmask_b32 v232, 0, v13, s[4:5]
    v_cndmask_b32 v12, 0, v14, s[6:7]
    v_or_b32 v232, v232, v12
    v_cndmask_b32 v233, 0, v13, s[16:17]
    v_cndmask_b32 v12, 0, v14, s[18:19]
    v_or_b32 v233, v233, v12
    v_cndmask_b32 v234, 0, v13, s[20:21]
    v_cndmask_b32 v12, 0, v14, s[22:23]
    v_or_b32 v234, v234, v12
    v_cndmask_b32 v235, 0, v13, s[24:25]
    v_cndmask_b32 v12, 0, v14, s[26:27]
    v_or_b32 v235, v235, v12
    v_cndmask_b32 v236, 0, v13, s[28:29]
    v_cndmask_b32 v12, 0, v14, s[30:31]
    v_or_b32 v236, v236, v12
    v_cndmask_b32 v237, 0, v13, s[58:59]
    v_cndmask_b32 v12, 0, v14, s[76:77]
    v_or_b32 v237, v237, v12
    v_cndmask_b32 v238, 0, v13, s[92:93]
    v_cndmask_b32 v12, 0, v14, s[94:95]
    v_or_b32 v238, v238, v12
    v_cndmask_b32 v239, 0, v13, s[96:97]
    v_cndmask_b32 v12, 0, v14, s[98:99]
    v_or_b32 v239, v239, v12
    v_lshrrev_b32 v13, 4, v0
    v_lshrrev_b32 v14, 2, v0
    v_xor_b32 v13, v13, v14
    v_and_b32 v13, 1, v13
    v_cmp_eq_u32 vcc, 0, v13
    v_mov_b32 v14, 0x3f803f80
    v_cndmask_b32 v240, 0, v14, vcc
    v_cndmask_b32 v241, 0, v14, vcc
    v_cndmask_b32 v242, 0, v14, vcc
    v_cndmask_b32 v243, 0, v14, vcc
    s_mul_i32 s42, s41, 49152
    s_lshl_b32 s43, s40, 11
    s_add_u32 s42, s42, s43
    v_add_u32 v245, s42, v1
    s_lshl_b32 s45, s33, 2
    s_add_u32 s45, s45, s40
    s_sub_u32 s46, 8, s45
    s_cmp_lt_u32 s45, 8
    s_cselect_b32 s46, s46, 0
    s_cselect_b32 s43, 0x4000, 0
    v_add_u32 v246, s43, v245
    s_lshl_b32 s47, s45, 5
    s_lshl_b32 s42, s34, 1
    s_add_u32 s47, s47, s42
    s_add_u32 s47, s47, s41
    s_lshl_b32 s47, s47, 11
    s_add_u32 s47, s47, 0x1000000
    s_and_b32 s86, s3, 1
    s_lshl_b32 s86, s86, 1
    s_bfe_u32 s80, s3, 0x10001
    s_add_u32 s86, s86, s80
    s_lshl_b32 s86, s86, 2
    s_and_b32 s80, s35, 3
    s_add_u32 s86, s86, s80
    s_lshr_b32 s42, s3, 2
    s_lshl_b32 s42, s42, 3
    s_lshr_b32 s43, s35, 2
    s_add_u32 s42, s42, s43
    v_lshrrev_b32 v13, 3, v0
    v_and_b32 v14, 7, v0
    v_bfe_u32 v12, v0, 4, 1
    v_lshlrev_b32 v12, 2, v12
    v_xor_b32 v12, v12, v14
    v_bfe_u32 v14, v0, 5, 1
    v_lshlrev_b32 v14, 1, v14
    v_xor_b32 v12, v12, v14
    v_lshlrev_b32 v250, 11, v13
    v_lshl_add_u32 v250, v12, 4, v250
    s_lshl_b32 s80, s42, 7
    v_add_u32 v250, s80, v250
    s_lshl_b32 s84, s32, 11
    s_lshl_b32 s88, s32, 15
    s_lshl_b32 s80, s35, 2
    s_add_u32 s80, s80, s32
    s_lshl_b32 s80, s80, 6
    v_add_u32 v13, s80, v0
    v_lshrrev_b32 v198, 3, v13
    v_lshlrev_b32 v198, 11, v198
    v_and_b32 v13, 7, v13
    v_lshl_add_u32 v198, v13, 7, v198
    s_lshr_b32 s80, s3, 2
    s_lshl_b32 s80, s80, 10
    v_add_u32 v198, s80, v198
    s_lshl_b32 s80, s35, 6
    s_lshl_b32 s81, s32, 4
    s_add_u32 s80, s80, s81
    v_bfe_u32 v13, v0, 1, 4
    v_add_u32 v13, s80, v13
    v_lshlrev_b32 v13, 11, v13
    v_and_b32 v14, 1, v0
    v_lshl_add_u32 v13, v14, 7, v13
    s_lshl_b32 s80, s3, 8
    v_add_u32 v199, s80, v13
    v_lshlrev_b32 v194, 15, v0
    s_lshl_b32 s80, s2, 7
    s_add_u32 s80, s80, 0x1800000
    v_add_u32 v194, s80, v194
    s_cmp_eq_u32 s32, 2
    s_cselect_b32 s80, 4, 0
    v_mov_b32 v193, 0x80000000
    v_cmp_gt_u32 vcc, s80, v0
    s_nop 1
    v_cndmask_b32 v194, v193, v194, vcc
    s_barrier
    ds_read_b128 v[16:19], v2 offset:40960
    v_mfma_f32_16x16x32_bf16 v[96:99], v[56:59], v[208:211], v[96:99]
    ds_read_b64_tr_b16 v[32:33], v6 offset:40960
    v_mfma_f32_16x16x32_bf16 v[104:107], v[56:59], v[212:215], v[104:107]
    ds_read_b64_tr_b16 v[34:35], v6 offset:42496
    v_mfma_f32_16x16x32_bf16 v[84:87], v[60:63], v[200:203], v[84:87]
    ds_read_b128 v[20:23], v2 offset:43008
    v_mfma_f32_16x16x32_bf16 v[92:95], v[60:63], v[204:207], v[92:95]
    ds_read_b128 v[24:27], v2 offset:45056
    v_mfma_f32_16x16x32_bf16 v[100:103], v[60:63], v[208:211], v[100:103]
    ds_read_b128 v[28:31], v2 offset:47104
    v_mfma_f32_16x16x32_bf16 v[108:111], v[60:63], v[212:215], v[108:111]
    ds_read_b64_tr_b16 v[36:37], v7 offset:40960
    v_mfma_f32_16x16x32_bf16 v[112:115], v[64:67], v[200:203], v[112:115]
    ds_read_b64_tr_b16 v[38:39], v7 offset:42496
    v_mfma_f32_16x16x32_bf16 v[120:123], v[64:67], v[204:207], v[120:123]
    ds_read_b64_tr_b16 v[40:41], v6 offset:41088
    v_mfma_f32_16x16x32_bf16 v[128:131], v[64:67], v[208:211], v[128:131]
    ds_read_b64_tr_b16 v[42:43], v6 offset:42624
    v_mfma_f32_16x16x32_bf16 v[136:139], v[64:67], v[212:215], v[136:139]
    ds_read_b64_tr_b16 v[44:45], v7 offset:41088
    v_mfma_f32_16x16x32_bf16 v[116:119], v[68:71], v[200:203], v[116:119]
    ds_read_b64_tr_b16 v[46:47], v7 offset:42624
    v_mfma_f32_16x16x32_bf16 v[124:127], v[68:71], v[204:207], v[124:127]
    ds_read_b64_tr_b16 v[48:49], v6 offset:41216
    v_mfma_f32_16x16x32_bf16 v[132:135], v[68:71], v[208:211], v[132:135]
    ds_read_b64_tr_b16 v[50:51], v6 offset:42752
    v_mfma_f32_16x16x32_bf16 v[140:143], v[68:71], v[212:215], v[140:143]
    ds_read_b64_tr_b16 v[52:53], v7 offset:41216
    v_mfma_f32_16x16x32_bf16 v[144:147], v[200:203], v[72:75], v[144:147]
    ds_read_b64_tr_b16 v[54:55], v7 offset:42752
    v_mfma_f32_16x16x32_bf16 v[152:155], v[204:207], v[72:75], v[152:155]
    v_mfma_f32_16x16x32_bf16 v[160:163], v[208:211], v[72:75], v[160:163]
    v_mfma_f32_16x16x32_bf16 v[168:171], v[212:215], v[72:75], v[168:171]
    v_mfma_f32_16x16x32_bf16 v[148:151], v[200:203], v[76:79], v[148:151]
    v_mfma_f32_16x16x32_bf16 v[156:159], v[204:207], v[76:79], v[156:159]
    v_mfma_f32_16x16x32_bf16 v[164:167], v[208:211], v[76:79], v[164:167]
    v_mfma_f32_16x16x32_bf16 v[172:175], v[212:215], v[76:79], v[172:175]
    s_waitcnt lgkmcnt(6)
    v_mfma_f32_16x16x32_bf16 v[80:83], v[32:35], v[16:19], v[80:83]
    ds_read_b128 v[200:203], v3 offset:40960
    v_mfma_f32_16x16x32_bf16 v[88:91], v[32:35], v[20:23], v[88:91]
    ds_read_b64_tr_b16 v[56:57], v6 offset:53248
    v_mfma_f32_16x16x32_bf16 v[96:99], v[32:35], v[24:27], v[96:99]
    ds_read_b64_tr_b16 v[58:59], v6 offset:54784
    v_mfma_f32_16x16x32_bf16 v[104:107], v[32:35], v[28:31], v[104:107]
    ds_read_b128 v[204:207], v3 offset:43008
    v_mfma_f32_16x16x32_bf16 v[84:87], v[36:39], v[16:19], v[84:87]
    ds_read_b128 v[208:211], v3 offset:45056
    v_mfma_f32_16x16x32_bf16 v[92:95], v[36:39], v[20:23], v[92:95]
    ds_read_b128 v[212:215], v3 offset:47104
    v_mfma_f32_16x16x32_bf16 v[100:103], v[36:39], v[24:27], v[100:103]
    ds_read_b64_tr_b16 v[60:61], v7 offset:53248
    v_mfma_f32_16x16x32_bf16 v[108:111], v[36:39], v[28:31], v[108:111]
    ds_read_b64_tr_b16 v[62:63], v7 offset:54784
    v_mfma_f32_16x16x32_bf16 v[112:115], v[40:43], v[16:19], v[112:115]
    ds_read_b64_tr_b16 v[64:65], v6 offset:53376
    v_mfma_f32_16x16x32_bf16 v[120:123], v[40:43], v[20:23], v[120:123]
    ds_read_b64_tr_b16 v[66:67], v6 offset:54912
    v_mfma_f32_16x16x32_bf16 v[128:131], v[40:43], v[24:27], v[128:131]
    ds_read_b64_tr_b16 v[68:69], v7 offset:53376
    v_mfma_f32_16x16x32_bf16 v[136:139], v[40:43], v[28:31], v[136:139]
    ds_read_b64_tr_b16 v[70:71], v7 offset:54912
    s_waitcnt lgkmcnt(12)
    v_mfma_f32_16x16x32_bf16 v[116:119], v[44:47], v[16:19], v[116:119]
    ds_read_b64_tr_b16 v[72:73], v6 offset:53504
    v_mfma_f32_16x16x32_bf16 v[124:127], v[44:47], v[20:23], v[124:127]
    ds_read_b64_tr_b16 v[74:75], v6 offset:55040
    v_mfma_f32_16x16x32_bf16 v[132:135], v[44:47], v[24:27], v[132:135]
    ds_read_b64_tr_b16 v[76:77], v7 offset:53504
    v_mfma_f32_16x16x32_bf16 v[140:143], v[44:47], v[28:31], v[140:143]
    ds_read_b64_tr_b16 v[78:79], v7 offset:55040
    v_mfma_f32_16x16x32_bf16 v[144:147], v[16:19], v[48:51], v[144:147]
    v_mfma_f32_16x16x32_bf16 v[152:155], v[20:23], v[48:51], v[152:155]
    v_mfma_f32_16x16x32_bf16 v[160:163], v[24:27], v[48:51], v[160:163]
    v_mfma_f32_16x16x32_bf16 v[168:171], v[28:31], v[48:51], v[168:171]
    v_mfma_f32_16x16x32_bf16 v[148:151], v[16:19], v[52:55], v[148:151]
    v_mfma_f32_16x16x32_bf16 v[156:159], v[20:23], v[52:55], v[156:159]
    v_mfma_f32_16x16x32_bf16 v[164:167], v[24:27], v[52:55], v[164:167]
    v_mfma_f32_16x16x32_bf16 v[172:175], v[28:31], v[52:55], v[172:175]
    s_waitcnt lgkmcnt(0)
    v_mfma_f32_16x16x32_bf16 v[80:83], v[56:59], v[200:203], v[80:83]
    v_mfma_f32_16x16x32_bf16 v[88:91], v[56:59], v[204:207], v[88:91]
    s_barrier
    ds_read_b128 v[16:19], v4 offset:40960
    v_mfma_f32_16x16x32_bf16 v[96:99], v[56:59], v[208:211], v[96:99]
    ds_read_b64_tr_b16 v[32:33], v8 offset:40960
    v_mfma_f32_16x16x32_bf16 v[104:107], v[56:59], v[212:215], v[104:107]
    ds_read_b64_tr_b16 v[34:35], v8 offset:42496
    v_mfma_f32_16x16x32_bf16 v[84:87], v[60:63], v[200:203], v[84:87]
    ds_read_b128 v[20:23], v4 offset:43008
    v_mfma_f32_16x16x32_bf16 v[92:95], v[60:63], v[204:207], v[92:95]
    ds_read_b128 v[24:27], v4 offset:45056
    v_mfma_f32_16x16x32_bf16 v[100:103], v[60:63], v[208:211], v[100:103]
    ds_read_b128 v[28:31], v4 offset:47104
    v_mfma_f32_16x16x32_bf16 v[108:111], v[60:63], v[212:215], v[108:111]
    ds_read_b64_tr_b16 v[36:37], v9 offset:40960
    v_mfma_f32_16x16x32_bf16 v[112:115], v[64:67], v[200:203], v[112:115]
    ds_read_b64_tr_b16 v[38:39], v9 offset:42496
    v_mfma_f32_16x16x32_bf16 v[120:123], v[64:67], v[204:207], v[120:123]
    ds_read_b64_tr_b16 v[40:41], v8 offset:41088
    v_mfma_f32_16x16x32_bf16 v[128:131], v[64:67], v[208:211], v[128:131]
    ds_read_b64_tr_b16 v[42:43], v8 offset:42624
    v_mfma_f32_16x16x32_bf16 v[136:139], v[64:67], v[212:215], v[136:139]
    ds_read_b64_tr_b16 v[44:45], v9 offset:41088
    v_mfma_f32_16x16x32_bf16 v[116:119], v[68:71], v[200:203], v[116:119]
    ds_read_b64_tr_b16 v[46:47], v9 offset:42624
    v_mfma_f32_16x16x32_bf16 v[124:127], v[68:71], v[204:207], v[124:127]
    ds_read_b64_tr_b16 v[48:49], v8 offset:41216
    v_mfma_f32_16x16x32_bf16 v[132:135], v[68:71], v[208:211], v[132:135]
    ds_read_b64_tr_b16 v[50:51], v8 offset:42752
    v_mfma_f32_16x16x32_bf16 v[140:143], v[68:71], v[212:215], v[140:143]
    ds_read_b64_tr_b16 v[52:53], v9 offset:41216
    v_mfma_f32_16x16x32_bf16 v[144:147], v[200:203], v[72:75], v[144:147]
    ds_read_b64_tr_b16 v[54:55], v9 offset:42752
    v_mfma_f32_16x16x32_bf16 v[152:155], v[204:207], v[72:75], v[152:155]
    v_mfma_f32_16x16x32_bf16 v[160:163], v[208:211], v[72:75], v[160:163]
    v_mfma_f32_16x16x32_bf16 v[168:171], v[212:215], v[72:75], v[168:171]
    v_mfma_f32_16x16x32_bf16 v[148:151], v[200:203], v[76:79], v[148:151]
    v_mfma_f32_16x16x32_bf16 v[156:159], v[204:207], v[76:79], v[156:159]
    v_mfma_f32_16x16x32_bf16 v[164:167], v[208:211], v[76:79], v[164:167]
    v_mfma_f32_16x16x32_bf16 v[172:175], v[212:215], v[76:79], v[172:175]
    s_waitcnt lgkmcnt(6)
    v_mfma_f32_16x16x32_bf16 v[80:83], v[32:35], v[16:19], v[80:83]
    ds_read_b128 v[200:203], v5 offset:40960
    v_mfma_f32_16x16x32_bf16 v[88:91], v[32:35], v[20:23], v[88:91]
    ds_read_b64_tr_b16 v[56:57], v8 offset:53248
    v_mfma_f32_16x16x32_bf16 v[96:99], v[32:35], v[24:27], v[96:99]
    ds_read_b64_tr_b16 v[58:59], v8 offset:54784
    v_mfma_f32_16x16x32_bf16 v[104:107], v[32:35], v[28:31], v[104:107]
    ds_read_b128 v[204:207], v5 offset:43008
    v_mfma_f32_16x16x32_bf16 v[84:87], v[36:39], v[16:19], v[84:87]
    ds_read_b128 v[208:211], v5 offset:45056
    v_mfma_f32_16x16x32_bf16 v[92:95], v[36:39], v[20:23], v[92:95]
    ds_read_b128 v[212:215], v5 offset:47104
    v_mfma_f32_16x16x32_bf16 v[100:103], v[36:39], v[24:27], v[100:103]
    ds_read_b64_tr_b16 v[60:61], v9 offset:53248
    v_mfma_f32_16x16x32_bf16 v[108:111], v[36:39], v[28:31], v[108:111]
    ds_read_b64_tr_b16 v[62:63], v9 offset:54784
    v_mfma_f32_16x16x32_bf16 v[112:115], v[40:43], v[16:19], v[112:115]
    ds_read_b64_tr_b16 v[64:65], v8 offset:53376
    v_mfma_f32_16x16x32_bf16 v[120:123], v[40:43], v[20:23], v[120:123]
    ds_read_b64_tr_b16 v[66:67], v8 offset:54912
    v_mfma_f32_16x16x32_bf16 v[128:131], v[40:43], v[24:27], v[128:131]
    ds_read_b64_tr_b16 v[68:69], v9 offset:53376
    v_mfma_f32_16x16x32_bf16 v[136:139], v[40:43], v[28:31], v[136:139]
    ds_read_b64_tr_b16 v[70:71], v9 offset:54912
    s_waitcnt lgkmcnt(12)
    v_mfma_f32_16x16x32_bf16 v[116:119], v[44:47], v[16:19], v[116:119]
    ds_read_b64_tr_b16 v[72:73], v8 offset:53504
    v_mfma_f32_16x16x32_bf16 v[124:127], v[44:47], v[20:23], v[124:127]
    ds_read_b64_tr_b16 v[74:75], v8 offset:55040
    v_mfma_f32_16x16x32_bf16 v[132:135], v[44:47], v[24:27], v[132:135]
    ds_read_b64_tr_b16 v[76:77], v9 offset:53504
    v_mfma_f32_16x16x32_bf16 v[140:143], v[44:47], v[28:31], v[140:143]
    ds_read_b64_tr_b16 v[78:79], v9 offset:55040
    v_mfma_f32_16x16x32_bf16 v[144:147], v[16:19], v[48:51], v[144:147]
    v_mfma_f32_16x16x32_bf16 v[152:155], v[20:23], v[48:51], v[152:155]
    v_mfma_f32_16x16x32_bf16 v[160:163], v[24:27], v[48:51], v[160:163]
    v_mfma_f32_16x16x32_bf16 v[168:171], v[28:31], v[48:51], v[168:171]
    v_mfma_f32_16x16x32_bf16 v[148:151], v[16:19], v[52:55], v[148:151]
    v_mfma_f32_16x16x32_bf16 v[156:159], v[20:23], v[52:55], v[156:159]
    v_mfma_f32_16x16x32_bf16 v[164:167], v[24:27], v[52:55], v[164:167]
    v_mfma_f32_16x16x32_bf16 v[172:175], v[28:31], v[52:55], v[172:175]
    s_waitcnt lgkmcnt(0)
    v_mfma_f32_16x16x32_bf16 v[80:83], v[56:59], v[200:203], v[80:83]
    v_mfma_f32_16x16x32_bf16 v[88:91], v[56:59], v[204:207], v[88:91]
    s_barrier
    ds_read_b128 v[16:19], v4 offset:0
    v_mfma_f32_16x16x32_bf16 v[96:99], v[56:59], v[208:211], v[96:99]
    ds_read_b64_tr_b16 v[32:33], v8 offset:0
    v_mfma_f32_16x16x32_bf16 v[104:107], v[56:59], v[212:215], v[104:107]
    ds_read_b64_tr_b16 v[34:35], v8 offset:1536
    v_mfma_f32_16x16x32_bf16 v[84:87], v[60:63], v[200:203], v[84:87]
    ds_read_b128 v[20:23], v4 offset:2048
    v_mfma_f32_16x16x32_bf16 v[92:95], v[60:63], v[204:207], v[92:95]
    ds_read_b128 v[24:27], v4 offset:4096
    v_mfma_f32_16x16x32_bf16 v[100:103], v[60:63], v[208:211], v[100:103]
    ds_read_b128 v[28:31], v4 offset:6144
    v_mfma_f32_16x16x32_bf16 v[108:111], v[60:63], v[212:215], v[108:111]
    ds_read_b64_tr_b16 v[36:37], v9 offset:0
    v_mfma_f32_16x16x32_bf16 v[112:115], v[64:67], v[200:203], v[112:115]
    ds_read_b64_tr_b16 v[38:39], v9 offset:1536
    v_mfma_f32_16x16x32_bf16 v[120:123], v[64:67], v[204:207], v[120:123]
    ds_read_b64_tr_b16 v[40:41], v8 offset:128
    v_mfma_f32_16x16x32_bf16 v[128:131], v[64:67], v[208:211], v[128:131]
    ds_read_b64_tr_b16 v[42:43], v8 offset:1664
    v_mfma_f32_16x16x32_bf16 v[136:139], v[64:67], v[212:215], v[136:139]
    ds_read_b64_tr_b16 v[44:45], v9 offset:128
    v_mfma_f32_16x16x32_bf16 v[116:119], v[68:71], v[200:203], v[116:119]
    ds_read_b64_tr_b16 v[46:47], v9 offset:1664
    v_mfma_f32_16x16x32_bf16 v[124:127], v[68:71], v[204:207], v[124:127]
    ds_read_b64_tr_b16 v[48:49], v8 offset:256
    v_mfma_f32_16x16x32_bf16 v[132:135], v[68:71], v[208:211], v[132:135]
    ds_read_b64_tr_b16 v[50:51], v8 offset:1792
    v_mfma_f32_16x16x32_bf16 v[140:143], v[68:71], v[212:215], v[140:143]
    ds_read_b64_tr_b16 v[52:53], v9 offset:256
    v_mfma_f32_16x16x32_bf16 v[144:147], v[200:203], v[72:75], v[144:147]
    ds_read_b64_tr_b16 v[54:55], v9 offset:1792
    v_mfma_f32_16x16x32_bf16 v[152:155], v[204:207], v[72:75], v[152:155]
    v_mfma_f32_16x16x32_bf16 v[160:163], v[208:211], v[72:75], v[160:163]
    v_mfma_f32_16x16x32_bf16 v[168:171], v[212:215], v[72:75], v[168:171]
    v_mfma_f32_16x16x32_bf16 v[148:151], v[200:203], v[76:79], v[148:151]
    v_mfma_f32_16x16x32_bf16 v[156:159], v[204:207], v[76:79], v[156:159]
    v_mfma_f32_16x16x32_bf16 v[164:167], v[208:211], v[76:79], v[164:167]
    v_mfma_f32_16x16x32_bf16 v[172:175], v[212:215], v[76:79], v[172:175]
    s_waitcnt lgkmcnt(6)
    v_mfma_f32_16x16x32_bf16 v[80:83], v[32:35], v[16:19], v[80:83]
    ds_read_b128 v[200:203], v5 offset:0
    v_mfma_f32_16x16x32_bf16 v[88:91], v[32:35], v[20:23], v[88:91]
    ds_read_b64_tr_b16 v[56:57], v8 offset:12288
    v_mfma_f32_16x16x32_bf16 v[96:99], v[32:35], v[24:27], v[96:99]
    ds_read_b64_tr_b16 v[58:59], v8 offset:13824
    v_mfma_f32_16x16x32_bf16 v[104:107], v[32:35], v[28:31], v[104:107]
    ds_read_b128 v[204:207], v5 offset:2048
    v_mfma_f32_16x16x32_bf16 v[84:87], v[36:39], v[16:19], v[84:87]
    ds_read_b128 v[208:211], v5 offset:4096
    v_mfma_f32_16x16x32_bf16 v[92:95], v[36:39], v[20:23], v[92:95]
    ds_read_b128 v[212:215], v5 offset:6144
    v_mfma_f32_16x16x32_bf16 v[100:103], v[36:39], v[24:27], v[100:103]
    ds_read_b64_tr_b16 v[60:61], v9 offset:12288
    v_mfma_f32_16x16x32_bf16 v[108:111], v[36:39], v[28:31], v[108:111]
    ds_read_b64_tr_b16 v[62:63], v9 offset:13824
    v_mfma_f32_16x16x32_bf16 v[112:115], v[40:43], v[16:19], v[112:115]
    ds_read_b64_tr_b16 v[64:65], v8 offset:12416
    v_mfma_f32_16x16x32_bf16 v[120:123], v[40:43], v[20:23], v[120:123]
    ds_read_b64_tr_b16 v[66:67], v8 offset:13952
    v_mfma_f32_16x16x32_bf16 v[128:131], v[40:43], v[24:27], v[128:131]
    ds_read_b64_tr_b16 v[68:69], v9 offset:12416
    v_mfma_f32_16x16x32_bf16 v[136:139], v[40:43], v[28:31], v[136:139]
    ds_read_b64_tr_b16 v[70:71], v9 offset:13952
    s_waitcnt lgkmcnt(12)
    v_mfma_f32_16x16x32_bf16 v[116:119], v[44:47], v[16:19], v[116:119]
    ds_read_b64_tr_b16 v[72:73], v8 offset:12544
    v_mfma_f32_16x16x32_bf16 v[124:127], v[44:47], v[20:23], v[124:127]
    ds_read_b64_tr_b16 v[74:75], v8 offset:14080
    v_mfma_f32_16x16x32_bf16 v[132:135], v[44:47], v[24:27], v[132:135]
    ds_read_b64_tr_b16 v[76:77], v9 offset:12544
    v_mfma_f32_16x16x32_bf16 v[140:143], v[44:47], v[28:31], v[140:143]
    ds_read_b64_tr_b16 v[78:79], v9 offset:14080
    v_mfma_f32_16x16x32_bf16 v[144:147], v[16:19], v[48:51], v[144:147]
    v_mfma_f32_16x16x32_bf16 v[152:155], v[20:23], v[48:51], v[152:155]
    v_mfma_f32_16x16x32_bf16 v[160:163], v[24:27], v[48:51], v[160:163]
    v_mfma_f32_16x16x32_bf16 v[168:171], v[28:31], v[48:51], v[168:171]
    v_mfma_f32_16x16x32_bf16 v[148:151], v[16:19], v[52:55], v[148:151]
    v_mfma_f32_16x16x32_bf16 v[156:159], v[20:23], v[52:55], v[156:159]
    v_mfma_f32_16x16x32_bf16 v[164:167], v[24:27], v[52:55], v[164:167]
    v_mfma_f32_16x16x32_bf16 v[172:175], v[28:31], v[52:55], v[172:175]
    s_waitcnt lgkmcnt(0)
    v_mfma_f32_16x16x32_bf16 v[80:83], v[56:59], v[200:203], v[80:83]
    v_mfma_f32_16x16x32_bf16 v[88:91], v[56:59], v[204:207], v[88:91]
    s_barrier
    ds_read_b128 v[16:19], v2 offset:0
    v_mfma_f32_16x16x32_bf16 v[96:99], v[56:59], v[208:211], v[96:99]
    ds_read_b64_tr_b16 v[32:33], v6 offset:0
    v_mfma_f32_16x16x32_bf16 v[104:107], v[56:59], v[212:215], v[104:107]
    ds_read_b64_tr_b16 v[34:35], v6 offset:1536
    v_mfma_f32_16x16x32_bf16 v[84:87], v[60:63], v[200:203], v[84:87]
    ds_read_b128 v[20:23], v2 offset:2048
    v_mfma_f32_16x16x32_bf16 v[92:95], v[60:63], v[204:207], v[92:95]
    ds_read_b128 v[24:27], v2 offset:4096
    v_mfma_f32_16x16x32_bf16 v[100:103], v[60:63], v[208:211], v[100:103]
    ds_read_b128 v[28:31], v2 offset:6144
    v_mfma_f32_16x16x32_bf16 v[108:111], v[60:63], v[212:215], v[108:111]
    ds_read_b64_tr_b16 v[36:37], v7 offset:0
    v_mfma_f32_16x16x32_bf16 v[112:115], v[64:67], v[200:203], v[112:115]
    ds_read_b64_tr_b16 v[38:39], v7 offset:1536
    v_mfma_f32_16x16x32_bf16 v[120:123], v[64:67], v[204:207], v[120:123]
    ds_read_b64_tr_b16 v[40:41], v6 offset:128
    v_mfma_f32_16x16x32_bf16 v[128:131], v[64:67], v[208:211], v[128:131]
    ds_read_b64_tr_b16 v[42:43], v6 offset:1664
    v_mfma_f32_16x16x32_bf16 v[136:139], v[64:67], v[212:215], v[136:139]
    ds_read_b64_tr_b16 v[44:45], v7 offset:128
    v_mfma_f32_16x16x32_bf16 v[116:119], v[68:71], v[200:203], v[116:119]
    ds_read_b64_tr_b16 v[46:47], v7 offset:1664
    v_mfma_f32_16x16x32_bf16 v[124:127], v[68:71], v[204:207], v[124:127]
    ds_read_b64_tr_b16 v[48:49], v6 offset:256
    v_mfma_f32_16x16x32_bf16 v[132:135], v[68:71], v[208:211], v[132:135]
    ds_read_b64_tr_b16 v[50:51], v6 offset:1792
    v_mfma_f32_16x16x32_bf16 v[140:143], v[68:71], v[212:215], v[140:143]
    ds_read_b64_tr_b16 v[52:53], v7 offset:256
    v_mfma_f32_16x16x32_bf16 v[144:147], v[200:203], v[72:75], v[144:147]
    ds_read_b64_tr_b16 v[54:55], v7 offset:1792
    v_mfma_f32_16x16x32_bf16 v[152:155], v[204:207], v[72:75], v[152:155]
    v_mfma_f32_16x16x32_bf16 v[160:163], v[208:211], v[72:75], v[160:163]
    v_mfma_f32_16x16x32_bf16 v[168:171], v[212:215], v[72:75], v[168:171]
    v_mfma_f32_16x16x32_bf16 v[148:151], v[200:203], v[76:79], v[148:151]
    v_mfma_f32_16x16x32_bf16 v[156:159], v[204:207], v[76:79], v[156:159]
    v_mfma_f32_16x16x32_bf16 v[164:167], v[208:211], v[76:79], v[164:167]
    v_mfma_f32_16x16x32_bf16 v[172:175], v[212:215], v[76:79], v[172:175]
    s_waitcnt lgkmcnt(6)
    v_mfma_f32_16x16x32_bf16 v[80:83], v[32:35], v[16:19], v[80:83]
    ds_read_b128 v[200:203], v3 offset:0
    v_mfma_f32_16x16x32_bf16 v[88:91], v[32:35], v[20:23], v[88:91]
    ds_read_b64_tr_b16 v[56:57], v6 offset:12288
    v_mfma_f32_16x16x32_bf16 v[96:99], v[32:35], v[24:27], v[96:99]
    ds_read_b64_tr_b16 v[58:59], v6 offset:13824
    v_mfma_f32_16x16x32_bf16 v[104:107], v[32:35], v[28:31], v[104:107]
    ds_read_b128 v[204:207], v3 offset:2048
    v_mfma_f32_16x16x32_bf16 v[84:87], v[36:39], v[16:19], v[84:87]
    ds_read_b128 v[208:211], v3 offset:4096
    v_mfma_f32_16x16x32_bf16 v[92:95], v[36:39], v[20:23], v[92:95]
    ds_read_b128 v[212:215], v3 offset:6144
    v_mfma_f32_16x16x32_bf16 v[100:103], v[36:39], v[24:27], v[100:103]
    ds_read_b64_tr_b16 v[60:61], v7 offset:12288
    v_mfma_f32_16x16x32_bf16 v[108:111], v[36:39], v[28:31], v[108:111]
    ds_read_b64_tr_b16 v[62:63], v7 offset:13824
    v_mfma_f32_16x16x32_bf16 v[112:115], v[40:43], v[16:19], v[112:115]
    ds_read_b64_tr_b16 v[64:65], v6 offset:12416
    v_mfma_f32_16x16x32_bf16 v[120:123], v[40:43], v[20:23], v[120:123]
    ds_read_b64_tr_b16 v[66:67], v6 offset:13952
    v_mfma_f32_16x16x32_bf16 v[128:131], v[40:43], v[24:27], v[128:131]
    ds_read_b64_tr_b16 v[68:69], v7 offset:12416
    v_mfma_f32_16x16x32_bf16 v[136:139], v[40:43], v[28:31], v[136:139]
    ds_read_b64_tr_b16 v[70:71], v7 offset:13952
    s_waitcnt lgkmcnt(12)
    v_mfma_f32_16x16x32_bf16 v[116:119], v[44:47], v[16:19], v[116:119]
    ds_read_b64_tr_b16 v[72:73], v6 offset:12544
    v_mfma_f32_16x16x32_bf16 v[124:127], v[44:47], v[20:23], v[124:127]
    ds_read_b64_tr_b16 v[74:75], v6 offset:14080
    v_mfma_f32_16x16x32_bf16 v[132:135], v[44:47], v[24:27], v[132:135]
    ds_read_b64_tr_b16 v[76:77], v7 offset:12544
    v_mfma_f32_16x16x32_bf16 v[140:143], v[44:47], v[28:31], v[140:143]
    ds_read_b64_tr_b16 v[78:79], v7 offset:14080
    v_mfma_f32_16x16x32_bf16 v[144:147], v[16:19], v[48:51], v[144:147]
    v_mfma_f32_16x16x32_bf16 v[152:155], v[20:23], v[48:51], v[152:155]
    v_mfma_f32_16x16x32_bf16 v[160:163], v[24:27], v[48:51], v[160:163]
    v_mfma_f32_16x16x32_bf16 v[168:171], v[28:31], v[48:51], v[168:171]
    v_mfma_f32_16x16x32_bf16 v[148:151], v[16:19], v[52:55], v[148:151]
    v_mfma_f32_16x16x32_bf16 v[156:159], v[20:23], v[52:55], v[156:159]
    v_mfma_f32_16x16x32_bf16 v[164:167], v[24:27], v[52:55], v[164:167]
    v_mfma_f32_16x16x32_bf16 v[172:175], v[28:31], v[52:55], v[172:175]
    s_waitcnt lgkmcnt(0)
    v_mfma_f32_16x16x32_bf16 v[80:83], v[56:59], v[200:203], v[80:83]
    v_mfma_f32_16x16x32_bf16 v[88:91], v[56:59], v[204:207], v[88:91]
    s_barrier
    ds_read_b128 v[16:19], v2 offset:40960
    v_mfma_f32_16x16x32_bf16 v[96:99], v[56:59], v[208:211], v[96:99]
    ds_read_b64_tr_b16 v[32:33], v6 offset:40960
    v_mfma_f32_16x16x32_bf16 v[104:107], v[56:59], v[212:215], v[104:107]
    ds_read_b64_tr_b16 v[34:35], v6 offset:42496
    v_mfma_f32_16x16x32_bf16 v[84:87], v[60:63], v[200:203], v[84:87]
    ds_read_b128 v[20:23], v2 offset:43008
    v_mfma_f32_16x16x32_bf16 v[92:95], v[60:63], v[204:207], v[92:95]
    ds_read_b128 v[24:27], v2 offset:45056
    v_mfma_f32_16x16x32_bf16 v[100:103], v[60:63], v[208:211], v[100:103]
    ds_read_b128 v[28:31], v2 offset:47104
    v_mfma_f32_16x16x32_bf16 v[108:111], v[60:63], v[212:215], v[108:111]
    ds_read_b64_tr_b16 v[36:37], v7 offset:40960
    v_mfma_f32_16x16x32_bf16 v[112:115], v[64:67], v[200:203], v[112:115]
    ds_read_b64_tr_b16 v[38:39], v7 offset:42496
    v_mfma_f32_16x16x32_bf16 v[120:123], v[64:67], v[204:207], v[120:123]
    ds_read_b64_tr_b16 v[40:41], v6 offset:41088
    v_mfma_f32_16x16x32_bf16 v[128:131], v[64:67], v[208:211], v[128:131]
    ds_read_b64_tr_b16 v[42:43], v6 offset:42624
    v_mfma_f32_16x16x32_bf16 v[136:139], v[64:67], v[212:215], v[136:139]
    ds_read_b64_tr_b16 v[44:45], v7 offset:41088
    v_mfma_f32_16x16x32_bf16 v[116:119], v[68:71], v[200:203], v[116:119]
    ds_read_b64_tr_b16 v[46:47], v7 offset:42624
    v_mfma_f32_16x16x32_bf16 v[124:127], v[68:71], v[204:207], v[124:127]
    ds_read_b64_tr_b16 v[48:49], v6 offset:41216
    v_mfma_f32_16x16x32_bf16 v[132:135], v[68:71], v[208:211], v[132:135]
    ds_read_b64_tr_b16 v[50:51], v6 offset:42752
    v_mfma_f32_16x16x32_bf16 v[140:143], v[68:71], v[212:215], v[140:143]
    ds_read_b64_tr_b16 v[52:53], v7 offset:41216
    v_mfma_f32_16x16x32_bf16 v[144:147], v[200:203], v[72:75], v[144:147]
    ds_read_b64_tr_b16 v[54:55], v7 offset:42752
    v_mfma_f32_16x16x32_bf16 v[152:155], v[204:207], v[72:75], v[152:155]
    v_mfma_f32_16x16x32_bf16 v[160:163], v[208:211], v[72:75], v[160:163]
    v_mfma_f32_16x16x32_bf16 v[168:171], v[212:215], v[72:75], v[168:171]
    v_mfma_f32_16x16x32_bf16 v[148:151], v[200:203], v[76:79], v[148:151]
    v_mfma_f32_16x16x32_bf16 v[156:159], v[204:207], v[76:79], v[156:159]
    v_mfma_f32_16x16x32_bf16 v[164:167], v[208:211], v[76:79], v[164:167]
    v_mfma_f32_16x16x32_bf16 v[172:175], v[212:215], v[76:79], v[172:175]
    s_waitcnt lgkmcnt(6)
    v_mfma_f32_16x16x32_bf16 v[80:83], v[32:35], v[16:19], v[80:83]
    ds_read_b128 v[200:203], v3 offset:40960
    v_mfma_f32_16x16x32_bf16 v[88:91], v[32:35], v[20:23], v[88:91]
    ds_read_b64_tr_b16 v[56:57], v6 offset:53248
    v_mfma_f32_16x16x32_bf16 v[96:99], v[32:35], v[24:27], v[96:99]
    ds_read_b64_tr_b16 v[58:59], v6 offset:54784
    v_mfma_f32_16x16x32_bf16 v[104:107], v[32:35], v[28:31], v[104:107]
    ds_read_b128 v[204:207], v3 offset:43008
    v_mfma_f32_16x16x32_bf16 v[84:87], v[36:39], v[16:19], v[84:87]
    ds_read_b128 v[208:211], v3 offset:45056
    v_mfma_f32_16x16x32_bf16 v[92:95], v[36:39], v[20:23], v[92:95]
    ds_read_b128 v[212:215], v3 offset:47104
    v_mfma_f32_16x16x32_bf16 v[100:103], v[36:39], v[24:27], v[100:103]
    ds_read_b64_tr_b16 v[60:61], v7 offset:53248
    v_mfma_f32_16x16x32_bf16 v[108:111], v[36:39], v[28:31], v[108:111]
    ds_read_b64_tr_b16 v[62:63], v7 offset:54784
    v_mfma_f32_16x16x32_bf16 v[112:115], v[40:43], v[16:19], v[112:115]
    ds_read_b64_tr_b16 v[64:65], v6 offset:53376
    v_mfma_f32_16x16x32_bf16 v[120:123], v[40:43], v[20:23], v[120:123]
    ds_read_b64_tr_b16 v[66:67], v6 offset:54912
    v_mfma_f32_16x16x32_bf16 v[128:131], v[40:43], v[24:27], v[128:131]
    ds_read_b64_tr_b16 v[68:69], v7 offset:53376
    v_mfma_f32_16x16x32_bf16 v[136:139], v[40:43], v[28:31], v[136:139]
    ds_read_b64_tr_b16 v[70:71], v7 offset:54912
    s_waitcnt lgkmcnt(12)
    v_mfma_f32_16x16x32_bf16 v[116:119], v[44:47], v[16:19], v[116:119]
    ds_read_b64_tr_b16 v[72:73], v6 offset:53504
    v_mfma_f32_16x16x32_bf16 v[124:127], v[44:47], v[20:23], v[124:127]
    ds_read_b64_tr_b16 v[74:75], v6 offset:55040
    v_mfma_f32_16x16x32_bf16 v[132:135], v[44:47], v[24:27], v[132:135]
    ds_read_b64_tr_b16 v[76:77], v7 offset:53504
    v_mfma_f32_16x16x32_bf16 v[140:143], v[44:47], v[28:31], v[140:143]
    ds_read_b64_tr_b16 v[78:79], v7 offset:55040
    v_mfma_f32_16x16x32_bf16 v[144:147], v[16:19], v[48:51], v[144:147]
    v_mfma_f32_16x16x32_bf16 v[152:155], v[20:23], v[48:51], v[152:155]
    v_mfma_f32_16x16x32_bf16 v[160:163], v[24:27], v[48:51], v[160:163]
    v_mfma_f32_16x16x32_bf16 v[168:171], v[28:31], v[48:51], v[168:171]
    v_mfma_f32_16x16x32_bf16 v[148:151], v[16:19], v[52:55], v[148:151]
    v_mfma_f32_16x16x32_bf16 v[156:159], v[20:23], v[52:55], v[156:159]
    v_mfma_f32_16x16x32_bf16 v[164:167], v[24:27], v[52:55], v[164:167]
    v_mfma_f32_16x16x32_bf16 v[172:175], v[28:31], v[52:55], v[172:175]
    s_waitcnt lgkmcnt(0)
    v_mfma_f32_16x16x32_bf16 v[80:83], v[56:59], v[200:203], v[80:83]
    v_mfma_f32_16x16x32_bf16 v[88:91], v[56:59], v[204:207], v[88:91]
    s_barrier
    ds_read_b128 v[16:19], v4 offset:40960
    v_mfma_f32_16x16x32_bf16 v[96:99], v[56:59], v[208:211], v[96:99]
    ds_read_b64_tr_b16 v[32:33], v8 offset:40960
    v_mfma_f32_16x16x32_bf16 v[104:107], v[56:59], v[212:215], v[104:107]
    ds_read_b64_tr_b16 v[34:35], v8 offset:42496
    v_mfma_f32_16x16x32_bf16 v[84:87], v[60:63], v[200:203], v[84:87]
    ds_read_b128 v[20:23], v4 offset:43008
    v_mfma_f32_16x16x32_bf16 v[92:95], v[60:63], v[204:207], v[92:95]
    ds_read_b128 v[24:27], v4 offset:45056
    v_mfma_f32_16x16x32_bf16 v[100:103], v[60:63], v[208:211], v[100:103]
    ds_read_b128 v[28:31], v4 offset:47104
    v_mfma_f32_16x16x32_bf16 v[108:111], v[60:63], v[212:215], v[108:111]
    ds_read_b64_tr_b16 v[36:37], v9 offset:40960
    v_mfma_f32_16x16x32_bf16 v[112:115], v[64:67], v[200:203], v[112:115]
    ds_read_b64_tr_b16 v[38:39], v9 offset:42496
    v_mfma_f32_16x16x32_bf16 v[120:123], v[64:67], v[204:207], v[120:123]
    ds_read_b64_tr_b16 v[40:41], v8 offset:41088
    v_mfma_f32_16x16x32_bf16 v[128:131], v[64:67], v[208:211], v[128:131]
    ds_read_b64_tr_b16 v[42:43], v8 offset:42624
    buffer_load_dword v195, v194, s[12:15], 0 offen
    v_mfma_f32_16x16x32_bf16 v[136:139], v[64:67], v[212:215], v[136:139]
    ds_read_b64_tr_b16 v[44:45], v9 offset:41088
    v_mfma_f32_16x16x32_bf16 v[116:119], v[68:71], v[200:203], v[116:119]
    ds_read_b64_tr_b16 v[46:47], v9 offset:42624
    v_mfma_f32_16x16x32_bf16 v[124:127], v[68:71], v[204:207], v[124:127]
    ds_read_b64_tr_b16 v[48:49], v8 offset:41216
    v_mfma_f32_16x16x32_bf16 v[132:135], v[68:71], v[208:211], v[132:135]
    ds_read_b64_tr_b16 v[50:51], v8 offset:42752
    v_mfma_f32_16x16x32_bf16 v[140:143], v[68:71], v[212:215], v[140:143]
    ds_read_b64_tr_b16 v[52:53], v9 offset:41216
    v_mfma_f32_16x16x32_bf16 v[144:147], v[200:203], v[72:75], v[144:147]
    ds_read_b64_tr_b16 v[54:55], v9 offset:42752
    v_mfma_f32_16x16x32_bf16 v[152:155], v[204:207], v[72:75], v[152:155]
    v_mfma_f32_16x16x32_bf16 v[160:163], v[208:211], v[72:75], v[160:163]
    v_mfma_f32_16x16x32_bf16 v[168:171], v[212:215], v[72:75], v[168:171]
    v_mfma_f32_16x16x32_bf16 v[148:151], v[200:203], v[76:79], v[148:151]
    v_mfma_f32_16x16x32_bf16 v[156:159], v[204:207], v[76:79], v[156:159]
    v_mfma_f32_16x16x32_bf16 v[164:167], v[208:211], v[76:79], v[164:167]
    v_mfma_f32_16x16x32_bf16 v[172:175], v[212:215], v[76:79], v[172:175]
    s_waitcnt lgkmcnt(6)
    v_mfma_f32_16x16x32_bf16 v[80:83], v[32:35], v[16:19], v[80:83]
    ds_read_b128 v[200:203], v5 offset:40960
    v_mfma_f32_16x16x32_bf16 v[88:91], v[32:35], v[20:23], v[88:91]
    ds_read_b64_tr_b16 v[56:57], v8 offset:53248
    v_mfma_f32_16x16x32_bf16 v[96:99], v[32:35], v[24:27], v[96:99]
    ds_read_b64_tr_b16 v[58:59], v8 offset:54784
    v_mfma_f32_16x16x32_bf16 v[104:107], v[32:35], v[28:31], v[104:107]
    ds_read_b128 v[204:207], v5 offset:43008
    v_mfma_f32_16x16x32_bf16 v[84:87], v[36:39], v[16:19], v[84:87]
    ds_read_b128 v[208:211], v5 offset:45056
    v_mfma_f32_16x16x32_bf16 v[92:95], v[36:39], v[20:23], v[92:95]
    ds_read_b128 v[212:215], v5 offset:47104
    v_mfma_f32_16x16x32_bf16 v[100:103], v[36:39], v[24:27], v[100:103]
    ds_read_b64_tr_b16 v[60:61], v9 offset:53248
    v_mfma_f32_16x16x32_bf16 v[108:111], v[36:39], v[28:31], v[108:111]
    ds_read_b64_tr_b16 v[62:63], v9 offset:54784
    v_mfma_f32_16x16x32_bf16 v[112:115], v[40:43], v[16:19], v[112:115]
    ds_read_b64_tr_b16 v[64:65], v8 offset:53376
    v_mfma_f32_16x16x32_bf16 v[120:123], v[40:43], v[20:23], v[120:123]
    ds_read_b64_tr_b16 v[66:67], v8 offset:54912
    v_mfma_f32_16x16x32_bf16 v[128:131], v[40:43], v[24:27], v[128:131]
    ds_read_b64_tr_b16 v[68:69], v9 offset:53376
    v_mfma_f32_16x16x32_bf16 v[136:139], v[40:43], v[28:31], v[136:139]
    ds_read_b64_tr_b16 v[70:71], v9 offset:54912
    s_waitcnt lgkmcnt(12)
    v_mfma_f32_16x16x32_bf16 v[116:119], v[44:47], v[16:19], v[116:119]
    ds_read_b64_tr_b16 v[72:73], v8 offset:53504
    v_mfma_f32_16x16x32_bf16 v[124:127], v[44:47], v[20:23], v[124:127]
    ds_read_b64_tr_b16 v[74:75], v8 offset:55040
    v_mfma_f32_16x16x32_bf16 v[132:135], v[44:47], v[24:27], v[132:135]
    ds_read_b64_tr_b16 v[76:77], v9 offset:53504
    v_mfma_f32_16x16x32_bf16 v[140:143], v[44:47], v[28:31], v[140:143]
    ds_read_b64_tr_b16 v[78:79], v9 offset:55040
    v_mfma_f32_16x16x32_bf16 v[144:147], v[16:19], v[48:51], v[144:147]
    v_mfma_f32_16x16x32_bf16 v[152:155], v[20:23], v[48:51], v[152:155]
    v_mfma_f32_16x16x32_bf16 v[160:163], v[24:27], v[48:51], v[160:163]
    v_mfma_f32_16x16x32_bf16 v[168:171], v[28:31], v[48:51], v[168:171]
    v_mfma_f32_16x16x32_bf16 v[148:151], v[16:19], v[52:55], v[148:151]
    v_mfma_f32_16x16x32_bf16 v[156:159], v[20:23], v[52:55], v[156:159]
    v_mfma_f32_16x16x32_bf16 v[164:167], v[24:27], v[52:55], v[164:167]
    v_mfma_f32_16x16x32_bf16 v[172:175], v[28:31], v[52:55], v[172:175]
    s_waitcnt lgkmcnt(0)
    v_mfma_f32_16x16x32_bf16 v[80:83], v[56:59], v[200:203], v[80:83]
    v_mfma_f32_16x16x32_bf16 v[88:91], v[56:59], v[204:207], v[88:91]
    s_barrier
    ds_read_b128 v[16:19], v4 offset:0
    v_mfma_f32_16x16x32_bf16 v[96:99], v[56:59], v[208:211], v[96:99]
    ds_read_b64_tr_b16 v[32:33], v8 offset:0
    v_mfma_f32_16x16x32_bf16 v[104:107], v[56:59], v[212:215], v[104:107]
    ds_read_b64_tr_b16 v[34:35], v8 offset:1536
    v_mfma_f32_16x16x32_bf16 v[84:87], v[60:63], v[200:203], v[84:87]
    ds_read_b128 v[20:23], v4 offset:2048
    v_mfma_f32_16x16x32_bf16 v[92:95], v[60:63], v[204:207], v[92:95]
    ds_read_b128 v[24:27], v4 offset:4096
    v_mfma_f32_16x16x32_bf16 v[100:103], v[60:63], v[208:211], v[100:103]
    ds_read_b128 v[28:31], v4 offset:6144
    v_mfma_f32_16x16x32_bf16 v[108:111], v[60:63], v[212:215], v[108:111]
    ds_read_b64_tr_b16 v[36:37], v9 offset:0
    v_mfma_f32_16x16x32_bf16 v[112:115], v[64:67], v[200:203], v[112:115]
    ds_read_b64_tr_b16 v[38:39], v9 offset:1536
    v_mfma_f32_16x16x32_bf16 v[120:123], v[64:67], v[204:207], v[120:123]
    ds_read_b64_tr_b16 v[40:41], v8 offset:128
    v_mfma_f32_16x16x32_bf16 v[128:131], v[64:67], v[208:211], v[128:131]
    ds_read_b64_tr_b16 v[42:43], v8 offset:1664
    v_mfma_f32_16x16x32_bf16 v[136:139], v[64:67], v[212:215], v[136:139]
    ds_read_b64_tr_b16 v[44:45], v9 offset:128
    v_mfma_f32_16x16x32_bf16 v[116:119], v[68:71], v[200:203], v[116:119]
    ds_read_b64_tr_b16 v[46:47], v9 offset:1664
    v_mfma_f32_16x16x32_bf16 v[124:127], v[68:71], v[204:207], v[124:127]
    ds_read_b64_tr_b16 v[48:49], v8 offset:256
    v_mfma_f32_16x16x32_bf16 v[132:135], v[68:71], v[208:211], v[132:135]
    ds_read_b64_tr_b16 v[50:51], v8 offset:1792
    v_mfma_f32_16x16x32_bf16 v[140:143], v[68:71], v[212:215], v[140:143]
    ds_read_b64_tr_b16 v[52:53], v9 offset:256
    v_mfma_f32_16x16x32_bf16 v[144:147], v[200:203], v[72:75], v[144:147]
    ds_read_b64_tr_b16 v[54:55], v9 offset:1792
    v_mfma_f32_16x16x32_bf16 v[152:155], v[204:207], v[72:75], v[152:155]
    v_mfma_f32_16x16x32_bf16 v[160:163], v[208:211], v[72:75], v[160:163]
    v_mfma_f32_16x16x32_bf16 v[168:171], v[212:215], v[72:75], v[168:171]
    v_mfma_f32_16x16x32_bf16 v[148:151], v[200:203], v[76:79], v[148:151]
    v_mfma_f32_16x16x32_bf16 v[156:159], v[204:207], v[76:79], v[156:159]
    v_mfma_f32_16x16x32_bf16 v[164:167], v[208:211], v[76:79], v[164:167]
    v_mfma_f32_16x16x32_bf16 v[172:175], v[212:215], v[76:79], v[172:175]
    s_waitcnt lgkmcnt(6)
    v_mfma_f32_16x16x32_bf16 v[80:83], v[32:35], v[16:19], v[80:83]
    ds_read_b128 v[200:203], v5 offset:0
    v_mfma_f32_16x16x32_bf16 v[88:91], v[32:35], v[20:23], v[88:91]
    ds_read_b64_tr_b16 v[56:57], v8 offset:12288
    v_mfma_f32_16x16x32_bf16 v[96:99], v[32:35], v[24:27], v[96:99]
    ds_read_b64_tr_b16 v[58:59], v8 offset:13824
    v_mfma_f32_16x16x32_bf16 v[104:107], v[32:35], v[28:31], v[104:107]
    ds_read_b128 v[204:207], v5 offset:2048
    v_mfma_f32_16x16x32_bf16 v[84:87], v[36:39], v[16:19], v[84:87]
    ds_read_b128 v[208:211], v5 offset:4096
    v_mfma_f32_16x16x32_bf16 v[92:95], v[36:39], v[20:23], v[92:95]
    ds_read_b128 v[212:215], v5 offset:6144
    v_mfma_f32_16x16x32_bf16 v[100:103], v[36:39], v[24:27], v[100:103]
    ds_read_b64_tr_b16 v[60:61], v9 offset:12288
    v_mfma_f32_16x16x32_bf16 v[108:111], v[36:39], v[28:31], v[108:111]
    ds_read_b64_tr_b16 v[62:63], v9 offset:13824
    v_mfma_f32_16x16x32_bf16 v[112:115], v[40:43], v[16:19], v[112:115]
    ds_read_b64_tr_b16 v[64:65], v8 offset:12416
    v_mfma_f32_16x16x32_bf16 v[120:123], v[40:43], v[20:23], v[120:123]
    ds_read_b64_tr_b16 v[66:67], v8 offset:13952
    v_mfma_f32_16x16x32_bf16 v[128:131], v[40:43], v[24:27], v[128:131]
    ds_read_b64_tr_b16 v[68:69], v9 offset:12416
    v_mfma_f32_16x16x32_bf16 v[136:139], v[40:43], v[28:31], v[136:139]
    ds_read_b64_tr_b16 v[70:71], v9 offset:13952
    s_waitcnt lgkmcnt(12)
    v_mfma_f32_16x16x32_bf16 v[116:119], v[44:47], v[16:19], v[116:119]
    ds_read_b64_tr_b16 v[72:73], v8 offset:12544
    v_mfma_f32_16x16x32_bf16 v[124:127], v[44:47], v[20:23], v[124:127]
    ds_read_b64_tr_b16 v[74:75], v8 offset:14080
    v_mfma_f32_16x16x32_bf16 v[132:135], v[44:47], v[24:27], v[132:135]
    ds_read_b64_tr_b16 v[76:77], v9 offset:12544
    v_mfma_f32_16x16x32_bf16 v[140:143], v[44:47], v[28:31], v[140:143]
    ds_read_b64_tr_b16 v[78:79], v9 offset:14080
    v_mfma_f32_16x16x32_bf16 v[144:147], v[16:19], v[48:51], v[144:147]
    v_mfma_f32_16x16x32_bf16 v[152:155], v[20:23], v[48:51], v[152:155]
    v_mfma_f32_16x16x32_bf16 v[160:163], v[24:27], v[48:51], v[160:163]
    v_mfma_f32_16x16x32_bf16 v[168:171], v[28:31], v[48:51], v[168:171]
    v_mfma_f32_16x16x32_bf16 v[148:151], v[16:19], v[52:55], v[148:151]
    v_mfma_f32_16x16x32_bf16 v[156:159], v[20:23], v[52:55], v[156:159]
    v_mfma_f32_16x16x32_bf16 v[164:167], v[24:27], v[52:55], v[164:167]
    v_mfma_f32_16x16x32_bf16 v[172:175], v[28:31], v[52:55], v[172:175]
    s_waitcnt lgkmcnt(0)
    v_mfma_f32_16x16x32_bf16 v[80:83], v[56:59], v[200:203], v[80:83]
    v_mfma_f32_16x16x32_bf16 v[88:91], v[56:59], v[204:207], v[88:91]
    s_barrier
    ds_read_b128 v[16:19], v2 offset:0
    v_mfma_f32_16x16x32_bf16 v[96:99], v[56:59], v[208:211], v[96:99]
    ds_read_b64_tr_b16 v[32:33], v6 offset:0
    v_mfma_f32_16x16x32_bf16 v[104:107], v[56:59], v[212:215], v[104:107]
    ds_read_b64_tr_b16 v[34:35], v6 offset:1536
    v_mfma_f32_16x16x32_bf16 v[84:87], v[60:63], v[200:203], v[84:87]
    ds_read_b128 v[20:23], v2 offset:2048
    v_mfma_f32_16x16x32_bf16 v[92:95], v[60:63], v[204:207], v[92:95]
    ds_read_b128 v[24:27], v2 offset:4096
    v_mfma_f32_16x16x32_bf16 v[100:103], v[60:63], v[208:211], v[100:103]
    ds_read_b128 v[28:31], v2 offset:6144
    v_mfma_f32_16x16x32_bf16 v[108:111], v[60:63], v[212:215], v[108:111]
    ds_read_b64_tr_b16 v[36:37], v7 offset:0
    v_mfma_f32_16x16x32_bf16 v[112:115], v[64:67], v[200:203], v[112:115]
    ds_read_b64_tr_b16 v[38:39], v7 offset:1536
    v_mfma_f32_16x16x32_bf16 v[120:123], v[64:67], v[204:207], v[120:123]
    ds_read_b64_tr_b16 v[40:41], v6 offset:128
    v_mfma_f32_16x16x32_bf16 v[128:131], v[64:67], v[208:211], v[128:131]
    ds_read_b64_tr_b16 v[42:43], v6 offset:1664
    v_mfma_f32_16x16x32_bf16 v[136:139], v[64:67], v[212:215], v[136:139]
    ds_read_b64_tr_b16 v[44:45], v7 offset:128
    v_mfma_f32_16x16x32_bf16 v[116:119], v[68:71], v[200:203], v[116:119]
    ds_read_b64_tr_b16 v[46:47], v7 offset:1664
    v_mfma_f32_16x16x32_bf16 v[124:127], v[68:71], v[204:207], v[124:127]
    ds_read_b64_tr_b16 v[48:49], v6 offset:256
    v_mfma_f32_16x16x32_bf16 v[132:135], v[68:71], v[208:211], v[132:135]
    ds_read_b64_tr_b16 v[50:51], v6 offset:1792
    v_mfma_f32_16x16x32_bf16 v[140:143], v[68:71], v[212:215], v[140:143]
    ds_read_b64_tr_b16 v[52:53], v7 offset:256
    v_mfma_f32_16x16x32_bf16 v[144:147], v[200:203], v[72:75], v[144:147]
    ds_read_b64_tr_b16 v[54:55], v7 offset:1792
    v_mfma_f32_16x16x32_bf16 v[152:155], v[204:207], v[72:75], v[152:155]
    v_mfma_f32_16x16x32_bf16 v[160:163], v[208:211], v[72:75], v[160:163]
    v_mfma_f32_16x16x32_bf16 v[168:171], v[212:215], v[72:75], v[168:171]
    v_mfma_f32_16x16x32_bf16 v[148:151], v[200:203], v[76:79], v[148:151]
    v_mfma_f32_16x16x32_bf16 v[156:159], v[204:207], v[76:79], v[156:159]
    v_mfma_f32_16x16x32_bf16 v[164:167], v[208:211], v[76:79], v[164:167]
    v_mfma_f32_16x16x32_bf16 v[172:175], v[212:215], v[76:79], v[172:175]
    s_waitcnt lgkmcnt(6)
    v_mfma_f32_16x16x32_bf16 v[80:83], v[32:35], v[16:19], v[80:83]
    ds_read_b128 v[200:203], v3 offset:0
    v_mfma_f32_16x16x32_bf16 v[88:91], v[32:35], v[20:23], v[88:91]
    ds_read_b64_tr_b16 v[56:57], v6 offset:12288
    v_mfma_f32_16x16x32_bf16 v[96:99], v[32:35], v[24:27], v[96:99]
    ds_read_b64_tr_b16 v[58:59], v6 offset:13824
    v_mfma_f32_16x16x32_bf16 v[104:107], v[32:35], v[28:31], v[104:107]
    ds_read_b128 v[204:207], v3 offset:2048
    v_mfma_f32_16x16x32_bf16 v[84:87], v[36:39], v[16:19], v[84:87]
    ds_read_b128 v[208:211], v3 offset:4096
    v_mfma_f32_16x16x32_bf16 v[92:95], v[36:39], v[20:23], v[92:95]
    ds_read_b128 v[212:215], v3 offset:6144
    v_mfma_f32_16x16x32_bf16 v[100:103], v[36:39], v[24:27], v[100:103]
    ds_read_b64_tr_b16 v[60:61], v7 offset:12288
    v_mfma_f32_16x16x32_bf16 v[108:111], v[36:39], v[28:31], v[108:111]
    ds_read_b64_tr_b16 v[62:63], v7 offset:13824
    v_mfma_f32_16x16x32_bf16 v[112:115], v[40:43], v[16:19], v[112:115]
    ds_read_b64_tr_b16 v[64:65], v6 offset:12416
    v_mfma_f32_16x16x32_bf16 v[120:123], v[40:43], v[20:23], v[120:123]
    ds_read_b64_tr_b16 v[66:67], v6 offset:13952
    v_mfma_f32_16x16x32_bf16 v[128:131], v[40:43], v[24:27], v[128:131]
    ds_read_b64_tr_b16 v[68:69], v7 offset:12416
    v_mfma_f32_16x16x32_bf16 v[136:139], v[40:43], v[28:31], v[136:139]
    ds_read_b64_tr_b16 v[70:71], v7 offset:13952
    s_waitcnt lgkmcnt(12)
    v_mfma_f32_16x16x32_bf16 v[116:119], v[44:47], v[16:19], v[116:119]
    ds_read_b64_tr_b16 v[72:73], v6 offset:12544
    v_mfma_f32_16x16x32_bf16 v[124:127], v[44:47], v[20:23], v[124:127]
    ds_read_b64_tr_b16 v[74:75], v6 offset:14080
    v_mfma_f32_16x16x32_bf16 v[132:135], v[44:47], v[24:27], v[132:135]
    ds_read_b64_tr_b16 v[76:77], v7 offset:12544
    v_mfma_f32_16x16x32_bf16 v[140:143], v[44:47], v[28:31], v[140:143]
    ds_read_b64_tr_b16 v[78:79], v7 offset:14080
    v_mfma_f32_16x16x32_bf16 v[144:147], v[16:19], v[48:51], v[144:147]
    v_mfma_f32_16x16x32_bf16 v[152:155], v[20:23], v[48:51], v[152:155]
    v_mfma_f32_16x16x32_bf16 v[160:163], v[24:27], v[48:51], v[160:163]
    v_mfma_f32_16x16x32_bf16 v[168:171], v[28:31], v[48:51], v[168:171]
    v_mfma_f32_16x16x32_bf16 v[148:151], v[16:19], v[52:55], v[148:151]
    v_mfma_f32_16x16x32_bf16 v[156:159], v[20:23], v[52:55], v[156:159]
    v_mfma_f32_16x16x32_bf16 v[164:167], v[24:27], v[52:55], v[164:167]
    buffer_load_dwordx2 v[186:187], v252, s[72:75], 0 offen sc1
    v_mfma_f32_16x16x32_bf16 v[172:175], v[28:31], v[52:55], v[172:175]
    s_waitcnt lgkmcnt(0)
    v_mfma_f32_16x16x32_bf16 v[80:83], v[56:59], v[200:203], v[80:83]
    v_mfma_f32_16x16x32_bf16 v[88:91], v[56:59], v[204:207], v[88:91]
    s_barrier
    ds_read_b128 v[16:19], v2 offset:40960
    v_mfma_f32_16x16x32_bf16 v[96:99], v[56:59], v[208:211], v[96:99]
    ds_read_b64_tr_b16 v[32:33], v6 offset:40960
    v_mfma_f32_16x16x32_bf16 v[104:107], v[56:59], v[212:215], v[104:107]
    ds_read_b64_tr_b16 v[34:35], v6 offset:42496
    v_mfma_f32_16x16x32_bf16 v[84:87], v[60:63], v[200:203], v[84:87]
    ds_read_b128 v[20:23], v2 offset:43008
    v_mfma_f32_16x16x32_bf16 v[92:95], v[60:63], v[204:207], v[92:95]
    ds_read_b128 v[24:27], v2 offset:45056
    v_mfma_f32_16x16x32_bf16 v[100:103], v[60:63], v[208:211], v[100:103]
    ds_read_b128 v[28:31], v2 offset:47104
    v_mfma_f32_16x16x32_bf16 v[108:111], v[60:63], v[212:215], v[108:111]
    ds_read_b64_tr_b16 v[36:37], v7 offset:40960
    v_mfma_f32_16x16x32_bf16 v[112:115], v[64:67], v[200:203], v[112:115]
    ds_read_b64_tr_b16 v[38:39], v7 offset:42496
    v_mfma_f32_16x16x32_bf16 v[120:123], v[64:67], v[204:207], v[120:123]
    ds_read_b64_tr_b16 v[40:41], v6 offset:41088
    v_mfma_f32_16x16x32_bf16 v[128:131], v[64:67], v[208:211], v[128:131]
    ds_read_b64_tr_b16 v[42:43], v6 offset:42624
    v_mfma_f32_16x16x32_bf16 v[136:139], v[64:67], v[212:215], v[136:139]
    ds_read_b64_tr_b16 v[44:45], v7 offset:41088
    v_mfma_f32_16x16x32_bf16 v[116:119], v[68:71], v[200:203], v[116:119]
    ds_read_b64_tr_b16 v[46:47], v7 offset:42624
    v_mfma_f32_16x16x32_bf16 v[124:127], v[68:71], v[204:207], v[124:127]
    ds_read_b64_tr_b16 v[48:49], v6 offset:41216
    v_mfma_f32_16x16x32_bf16 v[132:135], v[68:71], v[208:211], v[132:135]
    ds_read_b64_tr_b16 v[50:51], v6 offset:42752
    v_mfma_f32_16x16x32_bf16 v[140:143], v[68:71], v[212:215], v[140:143]
    ds_read_b64_tr_b16 v[52:53], v7 offset:41216
    v_mfma_f32_16x16x32_bf16 v[144:147], v[200:203], v[72:75], v[144:147]
    ds_read_b64_tr_b16 v[54:55], v7 offset:42752
    v_mfma_f32_16x16x32_bf16 v[152:155], v[204:207], v[72:75], v[152:155]
    v_mfma_f32_16x16x32_bf16 v[160:163], v[208:211], v[72:75], v[160:163]
    v_mfma_f32_16x16x32_bf16 v[168:171], v[212:215], v[72:75], v[168:171]
    v_mfma_f32_16x16x32_bf16 v[148:151], v[200:203], v[76:79], v[148:151]
    v_mfma_f32_16x16x32_bf16 v[156:159], v[204:207], v[76:79], v[156:159]
    v_mfma_f32_16x16x32_bf16 v[164:167], v[208:211], v[76:79], v[164:167]
    v_mfma_f32_16x16x32_bf16 v[172:175], v[212:215], v[76:79], v[172:175]
    s_waitcnt lgkmcnt(6)
    v_mfma_f32_16x16x32_bf16 v[80:83], v[32:35], v[16:19], v[80:83]
    ds_read_b128 v[200:203], v3 offset:40960
    v_mfma_f32_16x16x32_bf16 v[88:91], v[32:35], v[20:23], v[88:91]
    ds_read_b64_tr_b16 v[56:57], v6 offset:53248
    v_mfma_f32_16x16x32_bf16 v[96:99], v[32:35], v[24:27], v[96:99]
    ds_read_b64_tr_b16 v[58:59], v6 offset:54784
    v_mfma_f32_16x16x32_bf16 v[104:107], v[32:35], v[28:31], v[104:107]
    ds_read_b128 v[204:207], v3 offset:43008
    v_mfma_f32_16x16x32_bf16 v[84:87], v[36:39], v[16:19], v[84:87]
    ds_read_b128 v[208:211], v3 offset:45056
    v_mfma_f32_16x16x32_bf16 v[92:95], v[36:39], v[20:23], v[92:95]
    ds_read_b128 v[212:215], v3 offset:47104
    v_mfma_f32_16x16x32_bf16 v[100:103], v[36:39], v[24:27], v[100:103]
    ds_read_b64_tr_b16 v[60:61], v7 offset:53248
    v_mfma_f32_16x16x32_bf16 v[108:111], v[36:39], v[28:31], v[108:111]
    ds_read_b64_tr_b16 v[62:63], v7 offset:54784
    v_mfma_f32_16x16x32_bf16 v[112:115], v[40:43], v[16:19], v[112:115]
    ds_read_b64_tr_b16 v[64:65], v6 offset:53376
    v_mfma_f32_16x16x32_bf16 v[120:123], v[40:43], v[20:23], v[120:123]
    ds_read_b64_tr_b16 v[66:67], v6 offset:54912
    v_mfma_f32_16x16x32_bf16 v[128:131], v[40:43], v[24:27], v[128:131]
    ds_read_b64_tr_b16 v[68:69], v7 offset:53376
    v_mfma_f32_16x16x32_bf16 v[136:139], v[40:43], v[28:31], v[136:139]
    ds_read_b64_tr_b16 v[70:71], v7 offset:54912
    s_waitcnt lgkmcnt(12)
    v_mfma_f32_16x16x32_bf16 v[116:119], v[44:47], v[16:19], v[116:119]
    ds_read_b64_tr_b16 v[72:73], v6 offset:53504
    v_mfma_f32_16x16x32_bf16 v[124:127], v[44:47], v[20:23], v[124:127]
    ds_read_b64_tr_b16 v[74:75], v6 offset:55040
    v_mfma_f32_16x16x32_bf16 v[132:135], v[44:47], v[24:27], v[132:135]
    ds_read_b64_tr_b16 v[76:77], v7 offset:53504
    v_mfma_f32_16x16x32_bf16 v[140:143], v[44:47], v[28:31], v[140:143]
    ds_read_b64_tr_b16 v[78:79], v7 offset:55040
    v_mfma_f32_16x16x32_bf16 v[144:147], v[16:19], v[48:51], v[144:147]
    v_mfma_f32_16x16x32_bf16 v[152:155], v[20:23], v[48:51], v[152:155]
    v_mfma_f32_16x16x32_bf16 v[160:163], v[24:27], v[48:51], v[160:163]
    v_mfma_f32_16x16x32_bf16 v[168:171], v[28:31], v[48:51], v[168:171]
    v_mfma_f32_16x16x32_bf16 v[148:151], v[16:19], v[52:55], v[148:151]
    v_mfma_f32_16x16x32_bf16 v[156:159], v[20:23], v[52:55], v[156:159]
    v_mfma_f32_16x16x32_bf16 v[164:167], v[24:27], v[52:55], v[164:167]
    v_mfma_f32_16x16x32_bf16 v[172:175], v[28:31], v[52:55], v[172:175]
    s_waitcnt lgkmcnt(0)
    v_mfma_f32_16x16x32_bf16 v[80:83], v[56:59], v[200:203], v[80:83]
    v_mfma_f32_16x16x32_bf16 v[88:91], v[56:59], v[204:207], v[88:91]
    s_barrier
    ds_read_b128 v[16:19], v4 offset:40960
    v_mfma_f32_16x16x32_bf16 v[96:99], v[56:59], v[208:211], v[96:99]
    ds_read_b64_tr_b16 v[32:33], v8 offset:40960
    v_mfma_f32_16x16x32_bf16 v[104:107], v[56:59], v[212:215], v[104:107]
    ds_read_b64_tr_b16 v[34:35], v8 offset:42496
    v_mfma_f32_16x16x32_bf16 v[84:87], v[60:63], v[200:203], v[84:87]
    ds_read_b128 v[20:23], v4 offset:43008
    v_mfma_f32_16x16x32_bf16 v[92:95], v[60:63], v[204:207], v[92:95]
    ds_read_b128 v[24:27], v4 offset:45056
    v_mfma_f32_16x16x32_bf16 v[100:103], v[60:63], v[208:211], v[100:103]
    ds_read_b128 v[28:31], v4 offset:47104
    v_mfma_f32_16x16x32_bf16 v[108:111], v[60:63], v[212:215], v[108:111]
    ds_read_b64_tr_b16 v[36:37], v9 offset:40960
    v_mfma_f32_16x16x32_bf16 v[112:115], v[64:67], v[200:203], v[112:115]
    ds_read_b64_tr_b16 v[38:39], v9 offset:42496
    v_mfma_f32_16x16x32_bf16 v[120:123], v[64:67], v[204:207], v[120:123]
    ds_read_b64_tr_b16 v[40:41], v8 offset:41088
    v_mfma_f32_16x16x32_bf16 v[128:131], v[64:67], v[208:211], v[128:131]
    ds_read_b64_tr_b16 v[42:43], v8 offset:42624
    v_mfma_f32_16x16x32_bf16 v[136:139], v[64:67], v[212:215], v[136:139]
    ds_read_b64_tr_b16 v[44:45], v9 offset:41088
    v_mfma_f32_16x16x32_bf16 v[116:119], v[68:71], v[200:203], v[116:119]
    ds_read_b64_tr_b16 v[46:47], v9 offset:42624
    v_mfma_f32_16x16x32_bf16 v[124:127], v[68:71], v[204:207], v[124:127]
    ds_read_b64_tr_b16 v[48:49], v8 offset:41216
    v_mfma_f32_16x16x32_bf16 v[132:135], v[68:71], v[208:211], v[132:135]
    ds_read_b64_tr_b16 v[50:51], v8 offset:42752
    v_mfma_f32_16x16x32_bf16 v[140:143], v[68:71], v[212:215], v[140:143]
    ds_read_b64_tr_b16 v[52:53], v9 offset:41216
    v_mfma_f32_16x16x32_bf16 v[144:147], v[200:203], v[72:75], v[144:147]
    ds_read_b64_tr_b16 v[54:55], v9 offset:42752
    v_mfma_f32_16x16x32_bf16 v[152:155], v[204:207], v[72:75], v[152:155]
    v_mfma_f32_16x16x32_bf16 v[160:163], v[208:211], v[72:75], v[160:163]
    v_mfma_f32_16x16x32_bf16 v[168:171], v[212:215], v[72:75], v[168:171]
    v_mfma_f32_16x16x32_bf16 v[148:151], v[200:203], v[76:79], v[148:151]
    v_mfma_f32_16x16x32_bf16 v[156:159], v[204:207], v[76:79], v[156:159]
    v_mfma_f32_16x16x32_bf16 v[164:167], v[208:211], v[76:79], v[164:167]
    v_mfma_f32_16x16x32_bf16 v[172:175], v[212:215], v[76:79], v[172:175]
    s_waitcnt lgkmcnt(6)
    v_mfma_f32_16x16x32_bf16 v[80:83], v[32:35], v[16:19], v[80:83]
    ds_read_b128 v[200:203], v5 offset:40960
    v_mfma_f32_16x16x32_bf16 v[88:91], v[32:35], v[20:23], v[88:91]
    ds_read_b64_tr_b16 v[56:57], v8 offset:53248
    v_mfma_f32_16x16x32_bf16 v[96:99], v[32:35], v[24:27], v[96:99]
    ds_read_b64_tr_b16 v[58:59], v8 offset:54784
    v_mfma_f32_16x16x32_bf16 v[104:107], v[32:35], v[28:31], v[104:107]
    ds_read_b128 v[204:207], v5 offset:43008
    v_mfma_f32_16x16x32_bf16 v[84:87], v[36:39], v[16:19], v[84:87]
    ds_read_b128 v[208:211], v5 offset:45056
    v_mfma_f32_16x16x32_bf16 v[92:95], v[36:39], v[20:23], v[92:95]
    ds_read_b128 v[212:215], v5 offset:47104
    v_mfma_f32_16x16x32_bf16 v[100:103], v[36:39], v[24:27], v[100:103]
    ds_read_b64_tr_b16 v[60:61], v9 offset:53248
    v_mfma_f32_16x16x32_bf16 v[108:111], v[36:39], v[28:31], v[108:111]
    ds_read_b64_tr_b16 v[62:63], v9 offset:54784
    v_mfma_f32_16x16x32_bf16 v[112:115], v[40:43], v[16:19], v[112:115]
    ds_read_b64_tr_b16 v[64:65], v8 offset:53376
    v_mfma_f32_16x16x32_bf16 v[120:123], v[40:43], v[20:23], v[120:123]
    ds_read_b64_tr_b16 v[66:67], v8 offset:54912
    v_mfma_f32_16x16x32_bf16 v[128:131], v[40:43], v[24:27], v[128:131]
    ds_read_b64_tr_b16 v[68:69], v9 offset:53376
    v_mfma_f32_16x16x32_bf16 v[136:139], v[40:43], v[28:31], v[136:139]
    ds_read_b64_tr_b16 v[70:71], v9 offset:54912
    s_waitcnt lgkmcnt(12)
    v_mfma_f32_16x16x32_bf16 v[116:119], v[44:47], v[16:19], v[116:119]
    ds_read_b64_tr_b16 v[72:73], v8 offset:53504
    v_mfma_f32_16x16x32_bf16 v[124:127], v[44:47], v[20:23], v[124:127]
    ds_read_b64_tr_b16 v[74:75], v8 offset:55040
    v_mfma_f32_16x16x32_bf16 v[132:135], v[44:47], v[24:27], v[132:135]
    ds_read_b64_tr_b16 v[76:77], v9 offset:53504
    v_mfma_f32_16x16x32_bf16 v[140:143], v[44:47], v[28:31], v[140:143]
    ds_read_b64_tr_b16 v[78:79], v9 offset:55040
    v_mfma_f32_16x16x32_bf16 v[144:147], v[16:19], v[48:51], v[144:147]
    v_mfma_f32_16x16x32_bf16 v[152:155], v[20:23], v[48:51], v[152:155]
    v_mfma_f32_16x16x32_bf16 v[160:163], v[24:27], v[48:51], v[160:163]
    v_mfma_f32_16x16x32_bf16 v[168:171], v[28:31], v[48:51], v[168:171]
    v_mfma_f32_16x16x32_bf16 v[148:151], v[16:19], v[52:55], v[148:151]
    v_mfma_f32_16x16x32_bf16 v[156:159], v[20:23], v[52:55], v[156:159]
    v_mfma_f32_16x16x32_bf16 v[164:167], v[24:27], v[52:55], v[164:167]
    v_mfma_f32_16x16x32_bf16 v[172:175], v[28:31], v[52:55], v[172:175]
    s_waitcnt lgkmcnt(0)
    v_mfma_f32_16x16x32_bf16 v[80:83], v[56:59], v[200:203], v[80:83]
    v_mfma_f32_16x16x32_bf16 v[88:91], v[56:59], v[204:207], v[88:91]
    s_barrier
    ds_read_b128 v[16:19], v4 offset:0
    v_mfma_f32_16x16x32_bf16 v[96:99], v[56:59], v[208:211], v[96:99]
    ds_read_b64_tr_b16 v[32:33], v8 offset:0
    v_mfma_f32_16x16x32_bf16 v[104:107], v[56:59], v[212:215], v[104:107]
    ds_read_b64_tr_b16 v[34:35], v8 offset:1536
    v_mfma_f32_16x16x32_bf16 v[84:87], v[60:63], v[200:203], v[84:87]
    ds_read_b128 v[20:23], v4 offset:2048
    v_mfma_f32_16x16x32_bf16 v[92:95], v[60:63], v[204:207], v[92:95]
    ds_read_b128 v[24:27], v4 offset:4096
    v_mfma_f32_16x16x32_bf16 v[100:103], v[60:63], v[208:211], v[100:103]
    ds_read_b128 v[28:31], v4 offset:6144
    v_mfma_f32_16x16x32_bf16 v[108:111], v[60:63], v[212:215], v[108:111]
    ds_read_b64_tr_b16 v[36:37], v9 offset:0
    v_mfma_f32_16x16x32_bf16 v[112:115], v[64:67], v[200:203], v[112:115]
    ds_read_b64_tr_b16 v[38:39], v9 offset:1536
    v_mfma_f32_16x16x32_bf16 v[120:123], v[64:67], v[204:207], v[120:123]
    ds_read_b64_tr_b16 v[40:41], v8 offset:128
    v_mfma_f32_16x16x32_bf16 v[128:131], v[64:67], v[208:211], v[128:131]
    ds_read_b64_tr_b16 v[42:43], v8 offset:1664
    v_mfma_f32_16x16x32_bf16 v[136:139], v[64:67], v[212:215], v[136:139]
    ds_read_b64_tr_b16 v[44:45], v9 offset:128
    v_mfma_f32_16x16x32_bf16 v[116:119], v[68:71], v[200:203], v[116:119]
    ds_read_b64_tr_b16 v[46:47], v9 offset:1664
    v_mfma_f32_16x16x32_bf16 v[124:127], v[68:71], v[204:207], v[124:127]
    ds_read_b64_tr_b16 v[48:49], v8 offset:256
    v_mfma_f32_16x16x32_bf16 v[132:135], v[68:71], v[208:211], v[132:135]
    ds_read_b64_tr_b16 v[50:51], v8 offset:1792
    v_mfma_f32_16x16x32_bf16 v[140:143], v[68:71], v[212:215], v[140:143]
    ds_read_b64_tr_b16 v[52:53], v9 offset:256
    v_mfma_f32_16x16x32_bf16 v[144:147], v[200:203], v[72:75], v[144:147]
    ds_read_b64_tr_b16 v[54:55], v9 offset:1792
    v_mfma_f32_16x16x32_bf16 v[152:155], v[204:207], v[72:75], v[152:155]
    v_mfma_f32_16x16x32_bf16 v[160:163], v[208:211], v[72:75], v[160:163]
    v_mfma_f32_16x16x32_bf16 v[168:171], v[212:215], v[72:75], v[168:171]
    v_mfma_f32_16x16x32_bf16 v[148:151], v[200:203], v[76:79], v[148:151]
    v_mfma_f32_16x16x32_bf16 v[156:159], v[204:207], v[76:79], v[156:159]
    v_mfma_f32_16x16x32_bf16 v[164:167], v[208:211], v[76:79], v[164:167]
    v_mfma_f32_16x16x32_bf16 v[172:175], v[212:215], v[76:79], v[172:175]
    s_waitcnt lgkmcnt(6)
    v_mfma_f32_16x16x32_bf16 v[80:83], v[32:35], v[16:19], v[80:83]
    ds_read_b128 v[200:203], v5 offset:0
    v_mfma_f32_16x16x32_bf16 v[88:91], v[32:35], v[20:23], v[88:91]
    ds_read_b64_tr_b16 v[56:57], v8 offset:12288
    v_mfma_f32_16x16x32_bf16 v[96:99], v[32:35], v[24:27], v[96:99]
    ds_read_b64_tr_b16 v[58:59], v8 offset:13824
    v_mfma_f32_16x16x32_bf16 v[104:107], v[32:35], v[28:31], v[104:107]
    ds_read_b128 v[204:207], v5 offset:2048
    v_mfma_f32_16x16x32_bf16 v[84:87], v[36:39], v[16:19], v[84:87]
    ds_read_b128 v[208:211], v5 offset:4096
    v_mfma_f32_16x16x32_bf16 v[92:95], v[36:39], v[20:23], v[92:95]
    ds_read_b128 v[212:215], v5 offset:6144
    v_mfma_f32_16x16x32_bf16 v[100:103], v[36:39], v[24:27], v[100:103]
    ds_read_b64_tr_b16 v[60:61], v9 offset:12288
    v_mfma_f32_16x16x32_bf16 v[108:111], v[36:39], v[28:31], v[108:111]
    ds_read_b64_tr_b16 v[62:63], v9 offset:13824
    v_mfma_f32_16x16x32_bf16 v[112:115], v[40:43], v[16:19], v[112:115]
    ds_read_b64_tr_b16 v[64:65], v8 offset:12416
    v_mfma_f32_16x16x32_bf16 v[120:123], v[40:43], v[20:23], v[120:123]
    ds_read_b64_tr_b16 v[66:67], v8 offset:13952
    v_mfma_f32_16x16x32_bf16 v[128:131], v[40:43], v[24:27], v[128:131]
    ds_read_b64_tr_b16 v[68:69], v9 offset:12416
    v_mfma_f32_16x16x32_bf16 v[136:139], v[40:43], v[28:31], v[136:139]
    ds_read_b64_tr_b16 v[70:71], v9 offset:13952
    s_waitcnt lgkmcnt(12)
    v_mfma_f32_16x16x32_bf16 v[116:119], v[44:47], v[16:19], v[116:119]
    ds_read_b64_tr_b16 v[72:73], v8 offset:12544
    v_mfma_f32_16x16x32_bf16 v[124:127], v[44:47], v[20:23], v[124:127]
    ds_read_b64_tr_b16 v[74:75], v8 offset:14080
    v_mfma_f32_16x16x32_bf16 v[132:135], v[44:47], v[24:27], v[132:135]
    ds_read_b64_tr_b16 v[76:77], v9 offset:12544
    v_mfma_f32_16x16x32_bf16 v[140:143], v[44:47], v[28:31], v[140:143]
    ds_read_b64_tr_b16 v[78:79], v9 offset:14080
    v_mfma_f32_16x16x32_bf16 v[144:147], v[16:19], v[48:51], v[144:147]
    v_mfma_f32_16x16x32_bf16 v[152:155], v[20:23], v[48:51], v[152:155]
    v_mfma_f32_16x16x32_bf16 v[160:163], v[24:27], v[48:51], v[160:163]
    v_mfma_f32_16x16x32_bf16 v[168:171], v[28:31], v[48:51], v[168:171]
    v_mfma_f32_16x16x32_bf16 v[148:151], v[16:19], v[52:55], v[148:151]
    v_mfma_f32_16x16x32_bf16 v[156:159], v[20:23], v[52:55], v[156:159]
    v_mfma_f32_16x16x32_bf16 v[164:167], v[24:27], v[52:55], v[164:167]
    v_mfma_f32_16x16x32_bf16 v[172:175], v[28:31], v[52:55], v[172:175]
    s_waitcnt lgkmcnt(6)
    v_mfma_f32_16x16x32_bf16 v[80:83], v[56:59], v[200:203], v[80:83]
    ds_read_b128 v[16:19], v2 offset:0
    v_mfma_f32_16x16x32_bf16 v[88:91], v[56:59], v[204:207], v[88:91]
    ds_read_b64_tr_b16 v[32:33], v6 offset:0
    v_mfma_f32_16x16x32_bf16 v[96:99], v[56:59], v[208:211], v[96:99]
    ds_read_b64_tr_b16 v[34:35], v6 offset:1536
    v_mfma_f32_16x16x32_bf16 v[104:107], v[56:59], v[212:215], v[104:107]
    ds_read_b128 v[20:23], v2 offset:2048
    v_mfma_f32_16x16x32_bf16 v[84:87], v[60:63], v[200:203], v[84:87]
    ds_read_b128 v[24:27], v2 offset:4096
    v_mfma_f32_16x16x32_bf16 v[92:95], v[60:63], v[204:207], v[92:95]
    ds_read_b128 v[28:31], v2 offset:6144
    v_mfma_f32_16x16x32_bf16 v[100:103], v[60:63], v[208:211], v[100:103]
    ds_read_b64_tr_b16 v[36:37], v7 offset:0
    v_mfma_f32_16x16x32_bf16 v[108:111], v[60:63], v[212:215], v[108:111]
    ds_read_b64_tr_b16 v[38:39], v7 offset:1536
    v_mfma_f32_16x16x32_bf16 v[112:115], v[64:67], v[200:203], v[112:115]
    ds_read_b64_tr_b16 v[40:41], v6 offset:128
    v_mfma_f32_16x16x32_bf16 v[120:123], v[64:67], v[204:207], v[120:123]
    ds_read_b64_tr_b16 v[42:43], v6 offset:1664
    v_mfma_f32_16x16x32_bf16 v[128:131], v[64:67], v[208:211], v[128:131]
    ds_read_b64_tr_b16 v[44:45], v7 offset:128
    s_cmp_lg_u32 s32, 1
    s_cbranch_scc1 L_nocp_1031
    s_mov_b32 exec_hi, 0
    buffer_load_dword v188, v189, s[52:55], s56 offen
    s_mov_b32 exec_hi, -1
L_nocp_1031:
    v_mfma_f32_16x16x32_bf16 v[136:139], v[64:67], v[212:215], v[136:139]
    ds_read_b64_tr_b16 v[46:47], v7 offset:1664
    s_waitcnt lgkmcnt(12)
    v_mfma_f32_16x16x32_bf16 v[116:119], v[68:71], v[200:203], v[116:119]
    ds_read_b64_tr_b16 v[48:49], v6 offset:256
    v_mfma_f32_16x16x32_bf16 v[124:127], v[68:71], v[204:207], v[124:127]
    ds_read_b64_tr_b16 v[50:51], v6 offset:1792
    v_mfma_f32_16x16x32_bf16 v[132:135], v[68:71], v[208:211], v[132:135]
    ds_read_b64_tr_b16 v[52:53], v7 offset:256
    v_mfma_f32_16x16x32_bf16 v[140:143], v[68:71], v[212:215], v[140:143]
    ds_read_b64_tr_b16 v[54:55], v7 offset:1792
    v_mfma_f32_16x16x32_bf16 v[144:147], v[200:203], v[72:75], v[144:147]
    v_mfma_f32_16x16x32_bf16 v[152:155], v[204:207], v[72:75], v[152:155]
    v_mfma_f32_16x16x32_bf16 v[160:163], v[208:211], v[72:75], v[160:163]
    v_mfma_f32_16x16x32_bf16 v[168:171], v[212:215], v[72:75], v[168:171]
    v_mfma_f32_16x16x32_bf16 v[148:151], v[200:203], v[76:79], v[148:151]
    v_mfma_f32_16x16x32_bf16 v[156:159], v[204:207], v[76:79], v[156:159]
    v_mfma_f32_16x16x32_bf16 v[164:167], v[208:211], v[76:79], v[164:167]
    v_mfma_f32_16x16x32_bf16 v[172:175], v[212:215], v[76:79], v[172:175]
    s_waitcnt lgkmcnt(6)
    v_mfma_f32_16x16x32_bf16 v[80:83], v[32:35], v[16:19], v[80:83]
    ds_read_b128 v[200:203], v3 offset:0
    v_mfma_f32_16x16x32_bf16 v[88:91], v[32:35], v[20:23], v[88:91]
    ds_read_b64_tr_b16 v[56:57], v6 offset:12288
    v_mfma_f32_16x16x32_bf16 v[96:99], v[32:35], v[24:27], v[96:99]
    ds_read_b64_tr_b16 v[58:59], v6 offset:13824
    v_mfma_f32_16x16x32_bf16 v[104:107], v[32:35], v[28:31], v[104:107]
    ds_read_b128 v[204:207], v3 offset:2048
    v_mfma_f32_16x16x32_bf16 v[84:87], v[36:39], v[16:19], v[84:87]
    ds_read_b128 v[208:211], v3 offset:4096
    v_mfma_f32_16x16x32_bf16 v[92:95], v[36:39], v[20:23], v[92:95]
    ds_read_b128 v[212:215], v3 offset:6144
    v_mfma_f32_16x16x32_bf16 v[100:103], v[36:39], v[24:27], v[100:103]
    ds_read_b64_tr_b16 v[60:61], v7 offset:12288
    v_mfma_f32_16x16x32_bf16 v[108:111], v[36:39], v[28:31], v[108:111]
    ds_read_b64_tr_b16 v[62:63], v7 offset:13824
    v_mfma_f32_16x16x32_bf16 v[112:115], v[40:43], v[16:19], v[112:115]
    ds_read_b64_tr_b16 v[64:65], v6 offset:12416
    v_mfma_f32_16x16x32_bf16 v[120:123], v[40:43], v[20:23], v[120:123]
    ds_read_b64_tr_b16 v[66:67], v6 offset:13952
    v_mfma_f32_16x16x32_bf16 v[128:131], v[40:43], v[24:27], v[128:131]
    ds_read_b64_tr_b16 v[68:69], v7 offset:12416
    v_mfma_f32_16x16x32_bf16 v[136:139], v[40:43], v[28:31], v[136:139]
    ds_read_b64_tr_b16 v[70:71], v7 offset:13952
    s_waitcnt lgkmcnt(12)
    v_mfma_f32_16x16x32_bf16 v[116:119], v[44:47], v[16:19], v[116:119]
    ds_read_b64_tr_b16 v[72:73], v6 offset:12544
    v_mfma_f32_16x16x32_bf16 v[124:127], v[44:47], v[20:23], v[124:127]
    ds_read_b64_tr_b16 v[74:75], v6 offset:14080
    v_mfma_f32_16x16x32_bf16 v[132:135], v[44:47], v[24:27], v[132:135]
    ds_read_b64_tr_b16 v[76:77], v7 offset:12544
    v_mfma_f32_16x16x32_bf16 v[140:143], v[44:47], v[28:31], v[140:143]
    ds_read_b64_tr_b16 v[78:79], v7 offset:14080
    v_mfma_f32_16x16x32_bf16 v[144:147], v[16:19], v[48:51], v[144:147]
    v_mfma_f32_16x16x32_bf16 v[152:155], v[20:23], v[48:51], v[152:155]
    v_mfma_f32_16x16x32_bf16 v[160:163], v[24:27], v[48:51], v[160:163]
    v_mfma_f32_16x16x32_bf16 v[168:171], v[28:31], v[48:51], v[168:171]
    v_mfma_f32_16x16x32_bf16 v[148:151], v[16:19], v[52:55], v[148:151]
    v_mfma_f32_16x16x32_bf16 v[156:159], v[20:23], v[52:55], v[156:159]
    v_mfma_f32_16x16x32_bf16 v[164:167], v[24:27], v[52:55], v[164:167]
    v_mfma_f32_16x16x32_bf16 v[172:175], v[28:31], v[52:55], v[172:175]
    s_waitcnt lgkmcnt(0)
    v_mfma_f32_16x16x32_bf16 v[80:83], v[56:59], v[200:203], v[80:83]
    v_mfma_f32_16x16x32_bf16 v[88:91], v[56:59], v[204:207], v[88:91]
    s_barrier
    ds_read_b128 v[16:19], v2 offset:40960
    v_mfma_f32_16x16x32_bf16 v[96:99], v[56:59], v[208:211], v[96:99]
    ds_read_b64_tr_b16 v[40:41], v6 offset:41088
    v_mfma_f32_16x16x32_bf16 v[104:107], v[56:59], v[212:215], v[104:107]
    ds_read_b64_tr_b16 v[42:43], v6 offset:42624
    v_mfma_f32_16x16x32_bf16 v[84:87], v[60:63], v[200:203], v[84:87]
    ds_read_b128 v[20:23], v2 offset:43008
    v_mfma_f32_16x16x32_bf16 v[92:95], v[60:63], v[204:207], v[92:95]
    ds_read_b128 v[24:27], v2 offset:45056
    v_mfma_f32_16x16x32_bf16 v[100:103], v[60:63], v[208:211], v[100:103]
    ds_read_b128 v[28:31], v2 offset:47104
    v_mfma_f32_16x16x32_bf16 v[108:111], v[60:63], v[212:215], v[108:111]
    ds_read_b64_tr_b16 v[44:45], v7 offset:41088
    v_mfma_f32_16x16x32_bf16 v[112:115], v[64:67], v[200:203], v[112:115]
    ds_read_b64_tr_b16 v[46:47], v7 offset:42624
    v_mfma_f32_16x16x32_bf16 v[120:123], v[64:67], v[204:207], v[120:123]
    ds_read_b64_tr_b16 v[48:49], v6 offset:41216
    v_mfma_f32_16x16x32_bf16 v[128:131], v[64:67], v[208:211], v[128:131]
    ds_read_b64_tr_b16 v[50:51], v6 offset:42752
    v_mfma_f32_16x16x32_bf16 v[136:139], v[64:67], v[212:215], v[136:139]
    ds_read_b64_tr_b16 v[52:53], v7 offset:41216
    v_mfma_f32_16x16x32_bf16 v[116:119], v[68:71], v[200:203], v[116:119]
    ds_read_b64_tr_b16 v[54:55], v7 offset:42752
    v_mfma_f32_16x16x32_bf16 v[124:127], v[68:71], v[204:207], v[124:127]
    ds_read_b64_tr_b16 v[32:33], v6 offset:40960
    v_mfma_f32_16x16x32_bf16 v[132:135], v[68:71], v[208:211], v[132:135]
    ds_read_b64_tr_b16 v[34:35], v6 offset:42496
    v_mfma_f32_16x16x32_bf16 v[140:143], v[68:71], v[212:215], v[140:143]
    ds_read_b64_tr_b16 v[36:37], v7 offset:40960
    v_mfma_f32_16x16x32_bf16 v[144:147], v[200:203], v[72:75], v[144:147]
    ds_read_b64_tr_b16 v[38:39], v7 offset:42496
    v_mfma_f32_16x16x32_bf16 v[152:155], v[204:207], v[72:75], v[152:155]
    v_mfma_f32_16x16x32_bf16 v[160:163], v[208:211], v[72:75], v[160:163]
    v_mfma_f32_16x16x32_bf16 v[168:171], v[212:215], v[72:75], v[168:171]
    v_mfma_f32_16x16x32_bf16 v[148:151], v[200:203], v[76:79], v[148:151]
    v_mfma_f32_16x16x32_bf16 v[156:159], v[204:207], v[76:79], v[156:159]
    v_mfma_f32_16x16x32_bf16 v[164:167], v[208:211], v[76:79], v[164:167]
    v_mfma_f32_16x16x32_bf16 v[172:175], v[212:215], v[76:79], v[172:175]
    s_waitcnt lgkmcnt(6)
    v_mfma_f32_16x16x32_bf16 v[112:115], v[40:43], v[16:19], v[112:115]
    ds_read_b128 v[200:203], v3 offset:40960
    v_mfma_f32_16x16x32_bf16 v[120:123], v[40:43], v[20:23], v[120:123]
    ds_read_b64_tr_b16 v[64:65], v6 offset:53376
    v_mfma_f32_16x16x32_bf16 v[128:131], v[40:43], v[24:27], v[128:131]
    ds_read_b64_tr_b16 v[66:67], v6 offset:54912
    v_mfma_f32_16x16x32_bf16 v[136:139], v[40:43], v[28:31], v[136:139]
    ds_read_b128 v[204:207], v3 offset:43008
    v_mfma_f32_16x16x32_bf16 v[116:119], v[44:47], v[16:19], v[116:119]
    ds_read_b128 v[208:211], v3 offset:45056
    v_mfma_f32_16x16x32_bf16 v[124:127], v[44:47], v[20:23], v[124:127]
    ds_read_b128 v[212:215], v3 offset:47104
    v_mfma_f32_16x16x32_bf16 v[132:135], v[44:47], v[24:27], v[132:135]
    ds_read_b64_tr_b16 v[68:69], v7 offset:53376
    v_mfma_f32_16x16x32_bf16 v[140:143], v[44:47], v[28:31], v[140:143]
    ds_read_b64_tr_b16 v[70:71], v7 offset:54912
    v_mfma_f32_16x16x32_bf16 v[144:147], v[16:19], v[48:51], v[144:147]
    ds_read_b64_tr_b16 v[72:73], v6 offset:53504
    v_mfma_f32_16x16x32_bf16 v[152:155], v[20:23], v[48:51], v[152:155]
    ds_read_b64_tr_b16 v[74:75], v6 offset:55040
    v_mfma_f32_16x16x32_bf16 v[160:163], v[24:27], v[48:51], v[160:163]
    ds_read_b64_tr_b16 v[76:77], v7 offset:53504
    v_mfma_f32_16x16x32_bf16 v[168:171], v[28:31], v[48:51], v[168:171]
    ds_read_b64_tr_b16 v[78:79], v7 offset:55040
    s_waitcnt lgkmcnt(12)
    v_mfma_f32_16x16x32_bf16 v[148:151], v[16:19], v[52:55], v[148:151]
    ds_read_b64_tr_b16 v[56:57], v6 offset:53248
    v_mfma_f32_16x16x32_bf16 v[156:159], v[20:23], v[52:55], v[156:159]
    ds_read_b64_tr_b16 v[58:59], v6 offset:54784
    v_mfma_f32_16x16x32_bf16 v[164:167], v[24:27], v[52:55], v[164:167]
    ds_read_b64_tr_b16 v[60:61], v7 offset:53248
    v_mfma_f32_16x16x32_bf16 v[172:175], v[28:31], v[52:55], v[172:175]
    ds_read_b64_tr_b16 v[62:63], v7 offset:54784
    v_mfma_f32_16x16x32_bf16 v[80:83], v[32:35], v[16:19], v[80:83]
    v_mfma_f32_16x16x32_bf16 v[88:91], v[32:35], v[20:23], v[88:91]
    v_mfma_f32_16x16x32_bf16 v[96:99], v[32:35], v[24:27], v[96:99]
    v_mfma_f32_16x16x32_bf16 v[104:107], v[32:35], v[28:31], v[104:107]
    s_waitcnt lgkmcnt(0)
    v_mfma_f32_16x16x32_bf16 v[112:115], v[64:67], v[200:203], v[112:115]
    v_mfma_f32_16x16x32_bf16 v[120:123], v[64:67], v[204:207], v[120:123]
    s_barrier
    s_setprio 3
    v_mfma_f32_16x16x32_bf16 v[116:119], v[68:71], v[200:203], v[116:119]
    v_mfma_f32_16x16x32_bf16 v[124:127], v[68:71], v[204:207], v[124:127]
    v_mfma_f32_16x16x32_bf16 v[128:131], v[64:67], v[208:211], v[128:131]
    v_mfma_f32_16x16x32_bf16 v[136:139], v[64:67], v[212:215], v[136:139]
    v_mfma_f32_16x16x32_bf16 v[132:135], v[68:71], v[208:211], v[132:135]
    s_nop 5
    v_mfma_f32_16x16x32_bf16 v[140:143], v[68:71], v[212:215], v[140:143]
    v_cvt_pk_bf16_f32 v112, v112, v113
    v_cvt_pk_bf16_f32 v113, v114, v115
    v_mfma_f32_16x16x32_bf16 v[144:147], v[200:203], v[72:75], v[144:147]
    v_cvt_pk_bf16_f32 v114, v116, v117
    v_cvt_pk_bf16_f32 v115, v118, v119
    v_mfma_f32_16x16x32_bf16 v[152:155], v[204:207], v[72:75], v[152:155]
    v_cvt_pk_bf16_f32 v116, v120, v121
    v_cvt_pk_bf16_f32 v117, v122, v123
    v_mfma_f32_16x16x32_bf16 v[148:151], v[200:203], v[76:79], v[148:151]
    v_cvt_pk_bf16_f32 v118, v124, v125
    v_cvt_pk_bf16_f32 v119, v126, v127
    s_nop 1
    v_mfma_f32_16x16x32_bf16 v[156:159], v[204:207], v[76:79], v[156:159]
    v_permlane16_swap_b32 v112, v116
    v_mfma_f32_16x16x32_bf16 v[160:163], v[208:211], v[72:75], v[160:163]
    v_permlane16_swap_b32 v113, v117
    v_mfma_f32_16x16x32_bf16 v[168:171], v[212:215], v[72:75], v[168:171]
    v_permlane16_swap_b32 v114, v118
    v_mfma_f32_16x16x32_bf16 v[164:167], v[208:211], v[76:79], v[164:167]
    v_permlane16_swap_b32 v115, v119
    buffer_store_dwordx4 v[112:115], v1, s[12:15], s48 offen offset:0 sc1
    buffer_store_dwordx4 v[116:119], v1, s[12:15], s48 offen offset:1024 sc1
    v_mfma_f32_16x16x32_bf16 v[172:175], v[212:215], v[76:79], v[172:175]
    v_cvt_pk_bf16_f32 v128, v128, v129
    v_cvt_pk_bf16_f32 v129, v130, v131
    v_mfma_f32_16x16x32_bf16 v[84:87], v[36:39], v[16:19], v[84:87]
    v_cvt_pk_bf16_f32 v130, v132, v133
    v_cvt_pk_bf16_f32 v131, v134, v135
    v_mfma_f32_16x16x32_bf16 v[92:95], v[36:39], v[20:23], v[92:95]
    v_cvt_pk_bf16_f32 v132, v136, v137
    v_cvt_pk_bf16_f32 v133, v138, v139
    v_mfma_f32_16x16x32_bf16 v[100:103], v[36:39], v[24:27], v[100:103]
    v_cvt_pk_bf16_f32 v134, v140, v141
    v_cvt_pk_bf16_f32 v135, v142, v143
    s_nop 1
    v_mfma_f32_16x16x32_bf16 v[108:111], v[36:39], v[28:31], v[108:111]
    v_permlane16_swap_b32 v128, v132
    v_mfma_f32_16x16x32_bf16 v[80:83], v[56:59], v[200:203], v[80:83]
    v_permlane16_swap_b32 v129, v133
    v_mfma_f32_16x16x32_bf16 v[88:91], v[56:59], v[204:207], v[88:91]
    v_permlane16_swap_b32 v130, v134
    v_mfma_f32_16x16x32_bf16 v[96:99], v[56:59], v[208:211], v[96:99]
    v_permlane16_swap_b32 v131, v135
    buffer_store_dwordx4 v[128:131], v1, s[12:15], s48 offen offset:2048 sc1
    buffer_store_dwordx4 v[132:135], v1, s[12:15], s48 offen offset:3072 sc1
    v_mfma_f32_16x16x32_bf16 v[104:107], v[56:59], v[212:215], v[104:107]
    v_cvt_pk_bf16_f32 v144, v144, v145
    v_cvt_pk_bf16_f32 v145, v146, v147
    v_mfma_f32_16x16x32_bf16 v[84:87], v[60:63], v[200:203], v[84:87]
    v_cvt_pk_bf16_f32 v146, v148, v149
    v_cvt_pk_bf16_f32 v147, v150, v151
    v_mfma_f32_16x16x32_bf16 v[92:95], v[60:63], v[204:207], v[92:95]
    v_cvt_pk_bf16_f32 v148, v152, v153
    v_cvt_pk_bf16_f32 v149, v154, v155
    v_mfma_f32_16x16x32_bf16 v[100:103], v[60:63], v[208:211], v[100:103]
    v_cvt_pk_bf16_f32 v150, v156, v157
    v_cvt_pk_bf16_f32 v151, v158, v159
    s_nop 1
    v_mfma_f32_16x16x32_bf16 v[108:111], v[60:63], v[212:215], v[108:111]
    v_permlane16_swap_b32 v144, v146
    v_permlane16_swap_b32 v145, v147
    v_permlane16_swap_b32 v148, v150
    v_permlane16_swap_b32 v149, v151
    v_permlane32_swap_b32 v144, v146
    v_permlane32_swap_b32 v145, v147
    v_permlane32_swap_b32 v148, v150
    v_permlane32_swap_b32 v149, v151
    buffer_store_dwordx4 v[144:147], v1, s[12:15], s49 offen offset:0 sc1
    buffer_store_dwordx4 v[148:151], v1, s[12:15], s49 offen offset:1024 sc1
    v_cvt_pk_bf16_f32 v160, v160, v161
    v_cvt_pk_bf16_f32 v161, v162, v163
    v_cvt_pk_bf16_f32 v162, v164, v165
    v_cvt_pk_bf16_f32 v163, v166, v167
    v_cvt_pk_bf16_f32 v164, v168, v169
    v_cvt_pk_bf16_f32 v165, v170, v171
    v_cvt_pk_bf16_f32 v166, v172, v173
    v_cvt_pk_bf16_f32 v167, v174, v175
    s_nop 1
    v_permlane16_swap_b32 v160, v162
    v_permlane16_swap_b32 v161, v163
    v_permlane16_swap_b32 v164, v166
    v_permlane16_swap_b32 v165, v167
    v_permlane32_swap_b32 v160, v162
    v_permlane32_swap_b32 v161, v163
    v_permlane32_swap_b32 v164, v166
    v_permlane32_swap_b32 v165, v167
    buffer_store_dwordx4 v[160:163], v1, s[12:15], s49 offen offset:2048 sc1
    buffer_store_dwordx4 v[164:167], v1, s[12:15], s49 offen offset:3072 sc1
    s_setprio 3
    ds_write_b128 v182, v[112:115] offset:16384
    ds_write_b128 v182, v[116:119] offset:17408
    ds_write_b128 v182, v[128:131] offset:18432
    ds_write_b128 v182, v[132:135] offset:19456
    ds_write_b128 v182, v[144:147] offset:40960
    ds_write_b128 v182, v[148:151] offset:41984
    ds_write_b128 v182, v[160:163] offset:43008
    ds_write_b128 v182, v[164:167] offset:44032
    v_mul_f32 v96, 0x3e8293ee, v96
    v_mul_f32 v97, 0x3e8293ee, v97
    v_mul_f32 v98, 0x3e8293ee, v98
    v_mul_f32 v99, 0x3e8293ee, v99
    v_mul_f32 v100, 0x3e8293ee, v100
    v_mul_f32 v101, 0x3e8293ee, v101
    v_mul_f32 v102, 0x3e8293ee, v102
    v_mul_f32 v103, 0x3e8293ee, v103
    v_mul_f32 v104, 0x3e8293ee, v104
    v_mul_f32 v105, 0x3e8293ee, v105
    v_mul_f32 v106, 0x3e8293ee, v106
    v_mul_f32 v107, 0x3e8293ee, v107
    v_mul_f32 v108, 0x3e8293ee, v108
    v_mul_f32 v109, 0x3e8293ee, v109
    v_mul_f32 v110, 0x3e8293ee, v110
    v_mul_f32 v111, 0x3e8293ee, v111
    v_cvt_pk_bf16_f32 v96, v96, v97
    v_cvt_pk_bf16_f32 v97, v98, v99
    v_cvt_pk_bf16_f32 v98, v100, v101
    v_cvt_pk_bf16_f32 v99, v102, v103
    v_cvt_pk_bf16_f32 v100, v104, v105
    v_cvt_pk_bf16_f32 v101, v106, v107
    v_cvt_pk_bf16_f32 v102, v108, v109
    v_cvt_pk_bf16_f32 v103, v110, v111
    s_nop 1
    v_permlane16_swap_b32 v96, v100
    v_permlane16_swap_b32 v97, v101
    v_permlane16_swap_b32 v98, v102
    v_permlane16_swap_b32 v99, v103
    ds_write_b128 v183, v[96:99] offset:0
    ds_write_b128 v183, v[100:103] offset:1024
    v_mul_f32 v80, 0x3e8293ee, v80
    v_mul_f32 v81, 0x3e8293ee, v81
    v_mul_f32 v82, 0x3e8293ee, v82
    v_mul_f32 v83, 0x3e8293ee, v83
    v_mul_f32 v84, 0x3e8293ee, v84
    v_mul_f32 v85, 0x3e8293ee, v85
    v_mul_f32 v86, 0x3e8293ee, v86
    v_mul_f32 v87, 0x3e8293ee, v87
    v_mul_f32 v88, 0x3e8293ee, v88
    v_mul_f32 v89, 0x3e8293ee, v89
    v_mul_f32 v90, 0x3e8293ee, v90
    v_mul_f32 v91, 0x3e8293ee, v91
    v_mul_f32 v92, 0x3e8293ee, v92
    v_mul_f32 v93, 0x3e8293ee, v93
    v_mul_f32 v94, 0x3e8293ee, v94
    v_mul_f32 v95, 0x3e8293ee, v95
    v_cvt_pk_bf16_f32 v224, v80, v81
    v_cvt_pk_bf16_f32 v225, v82, v83
    v_cvt_pk_bf16_f32 v226, v84, v85
    v_cvt_pk_bf16_f32 v227, v86, v87
    v_cvt_pk_bf16_f32 v228, v88, v89
    v_cvt_pk_bf16_f32 v229, v90, v91
    v_cvt_pk_bf16_f32 v230, v92, v93
    v_cvt_pk_bf16_f32 v231, v94, v95
    s_nop 1
    v_permlane16_swap_b32 v224, v228
    v_permlane16_swap_b32 v225, v229
    v_permlane16_swap_b32 v226, v230
    v_permlane16_swap_b32 v227, v231
    s_cmp_lg_u32 s32, 0
    s_cbranch_scc1 L_nozero_1032
    v_lshl_add_u32 v20, v0, 2, v251
    ds_write_b32 v20, v252
L_nozero_1032:
    s_waitcnt vmcnt(0)
    s_mov_b32 s85, 0
L_tok_1033:
    v_readfirstlane_b32 s78, v186
    v_readfirstlane_b32 s79, v187
    s_add_u32 s85, s85, 1
    s_cmp_lg_u64 s[78:79], 0
    s_cbranch_scc1 L_tokd_1034
    buffer_load_dwordx2 v[186:187], v252, s[72:75], 0 offen sc1
    s_waitcnt vmcnt(0)
    s_cmp_lt_u32 s85, 0x40000
    s_cbranch_scc1 L_tok_1033
L_tokd_1034:
    s_add_u32 s80, s89, 0x1808000
    v_mov_b32 v220, s78
    v_mov_b32 v221, s79
    s_mov_b64 exec, 1
    buffer_store_dwordx2 v[220:221], v252, s[12:15], s80 offen sc1
    s_mov_b64 exec, -1
    s_cmp_lt_u32 s38, 2
    s_cbranch_scc1 L_noprev_1035
    s_mov_b32 s80, 0x3
    s_mov_b32 s81, 0x0
    s_mov_b32 s85, 0
L_poll_1036:
    buffer_load_dwordx2 v[196:197], v190, s[12:15], 0 offen sc1
    s_waitcnt vmcnt(0)
    v_cmp_eq_u64 vcc, s[78:79], v[196:197]
    s_add_u32 s85, s85, 1
    s_and_b64 s[82:83], vcc, s[80:81]
    s_cmp_eq_u64 s[82:83], s[80:81]
    s_cbranch_scc1 L_polld_1038
    s_sleep 1
    s_cmp_lt_u32 s85, 0x40000
    s_cbranch_scc1 L_poll_1036
L_polld_1038:
    s_add_u32 m0, s37, 0
    s_add_u32 s80, s36, 0
    buffer_load_dwordx4 v1, s[12:15], s80 offen offset:0  lds
    buffer_load_dwordx4 v1, s[12:15], s80 offen offset:1024  lds
    buffer_load_dwordx4 v1, s[12:15], s80 offen offset:2048  lds
    buffer_load_dwordx4 v1, s[12:15], s80 offen offset:3072  lds
    s_add_u32 m0, s37, 4096
    s_add_u32 s80, s36, 4096
    buffer_load_dwordx4 v1, s[12:15], s80 offen offset:0  lds
    buffer_load_dwordx4 v1, s[12:15], s80 offen offset:1024  lds
    buffer_load_dwordx4 v1, s[12:15], s80 offen offset:2048  lds
    buffer_load_dwordx4 v1, s[12:15], s80 offen offset:3072  lds
    s_add_u32 m0, s37, 24576
    s_add_u32 s80, s36, 4194304
    buffer_load_dwordx4 v1, s[12:15], s80 offen offset:0  lds
    buffer_load_dwordx4 v1, s[12:15], s80 offen offset:1024  lds
    buffer_load_dwordx4 v1, s[12:15], s80 offen offset:2048  lds
    buffer_load_dwordx4 v1, s[12:15], s80 offen offset:3072  lds
    s_add_u32 m0, s37, 28672
    s_add_u32 s80, s36, 4198400
    buffer_load_dwordx4 v1, s[12:15], s80 offen offset:0  lds
    buffer_load_dwordx4 v1, s[12:15], s80 offen offset:1024  lds
    buffer_load_dwordx4 v1, s[12:15], s80 offen offset:2048  lds
    buffer_load_dwordx4 v1, s[12:15], s80 offen offset:3072  lds
L_noprev_1035:
    s_setprio 0
    v_and_b32 v8, 15, v0
    v_lshrrev_b32 v9, 4, v0
    v_lshrrev_b32 v10, 5, v0
    v_lshrrev_b32 v11, 2, v8
    v_lshl_add_u32 v11, v10, 2, v11
    v_lshlrev_b32 v11, 7, v11
    v_and_b32 v12, 1, v9
    v_lshl_add_u32 v11, v12, 5, v11
    v_and_b32 v12, 3, v8
    v_lshl_add_u32 v11, v12, 3, v11
    v_lshrrev_b32 v12, 3, v8
    v_lshl_add_u32 v2, v12, 6, v11
    v_xor_b32 v12, 1, v12
    v_lshl_add_u32 v3, v12, 6, v11
    v_add_u32 v4, 0x10000, v2
    v_add_u32 v5, 0x10000, v3
    v_add_u32 v6, 106496, v2
    v_add_u32 v7, 106496, v3
    v_lshrrev_b32 v11, 2, v8
    v_and_b32 v12, 1, v9
    v_lshl_add_u32 v11, v12, 2, v11
    v_lshl_add_u32 v11, v10, 4, v11
    v_lshlrev_b32 v11, 7, v11
    v_lshl_add_u32 v11, v12, 5, v11
    v_and_b32 v13, 3, v8
    v_lshl_add_u32 v11, v13, 3, v11
    v_lshrrev_b32 v13, 3, v8
    v_lshl_add_u32 v2, v13, 6, v11
    v_lshlrev_b32 v3, 4, v8
    v_lshl_add_u32 v3, v9, 9, v3
    v_mov_b32 v12, s86
    v_bfe_u32 v13, v0, 1, 4
    v_lshrrev_b32 v191, 3, v12
    v_lshrrev_b32 v15, 2, v13
    v_lshl_add_u32 v191, v15, 1, v191
    v_and_b32 v15, 7, v12
    v_lshl_add_u32 v191, v15, 3, v191
    v_and_b32 v15, 3, v13
    v_lshl_add_u32 v191, v15, 6, v191
    v_lshlrev_b32 v191, 7, v191
    v_and_b32 v12, 1, v0
    v_lshl_add_u32 v191, v12, 4, v191
    s_lshr_b32 s80, s32, 1
    s_and_b32 s81, s32, 1
    s_lshl_b32 s81, s81, 2
    s_add_u32 s80, s80, s81
    s_lshl_b32 s80, s80, 3
    s_add_u32 s80, s80, 0x1818000
    v_add_u32 v191, s80, v191
    s_lshl_b32 s82, s86, 2
    s_add_u32 s82, s82, s32
    v_and_b32 v8, 31, v0
    s_lshl_b32 s80, s82, 5
    v_add_u32 v8, s80, v8
    v_lshlrev_b32 v8, 12, v8
    v_lshl_add_u32 v192, v10, 4, v8
    s_lshl_b32 s81, s32, 12
    s_add_u32 s81, s81, 24576
    s_cmp_eq_u32 s32, 3
    s_cselect_b32 s81, 73728, s81
    v_and_b32 v8, 31, v0
    v_and_b32 v9, 7, v0
    v_xor_b32 v11, v9, v10
    v_lshlrev_b32 v8, 7, v8
    v_lshl_add_u32 v193, v11, 4, v8
    v_and_b32 v193, 0x7ff, v193
    v_bfe_u32 v11, v0, 4, 1
    v_lshl_add_u32 v193, v11, 3, v193
    v_add_u32 v193, s81, v193
    v_lshrrev_b32 v8, 3, v0
    v_xor_b32 v11, v9, v8
    v_lshlrev_b32 v11, 4, v11
    v_lshl_add_u32 v194, v8, 7, v11
    v_add_u32 v194, s81, v194
    v_add_u32 v8, s80, v8
    v_lshlrev_b32 v8, 12, v8
    v_lshl_add_u32 v192, v9, 4, v8
    s_lshl_b32 s56, s42, 7
    s_add_u32 s56, s56, 2048
    s_lshl_b32 s82, s82, 16
    s_add_u32 s82, s82, 0x1000000
    s_add_u32 s81, s43, 0
    s_and_b32 s81, s81, 7
    s_lshl_b32 s81, s81, 13
    s_add_u32 s48, s82, s81
    s_add_u32 s81, s43, 1
    s_and_b32 s81, s81, 7
    s_lshl_b32 s81, s81, 13
    s_add_u32 s49, s82, s81
    s_add_u32 s81, s43, 2
    s_and_b32 s81, s81, 7
    s_lshl_b32 s81, s81, 13
    s_add_u32 s50, s82, s81
    s_add_u32 s81, s43, 3
    s_and_b32 s81, s81, 7
    s_lshl_b32 s81, s81, 13
    s_add_u32 s51, s82, s81
    s_add_u32 s81, s43, 4
    s_and_b32 s81, s81, 7
    s_lshl_b32 s81, s81, 13
    s_add_u32 s52, s82, s81
    s_add_u32 s81, s43, 5
    s_and_b32 s81, s81, 7
    s_lshl_b32 s81, s81, 13
    s_add_u32 s53, s82, s81
    s_add_u32 s81, s43, 6
    s_and_b32 s81, s81, 7
    s_lshl_b32 s81, s81, 13
    s_add_u32 s54, s82, s81
    s_add_u32 s81, s43, 7
    s_and_b32 s81, s81, 7
    s_lshl_b32 s81, s81, 13
    s_add_u32 s55, s82, s81
    s_waitcnt vmcnt(0)
    s_waitcnt lgkmcnt(0)
    s_barrier
    s_setprio 3
    ds_read_b128 v[56:59], v245 offset:16384
    ds_read_b128 v[60:63], v245 offset:17408
    ds_read_b128 v[64:67], v245 offset:0
    ds_read_b128 v[68:71], v245 offset:1024
    ds_read_b128 v[72:75], v245 offset:14336
    ds_read_b128 v[76:79], v245 offset:15360
    ds_read_b128 v[80:83], v245 offset:40960
    ds_read_b128 v[84:87], v245 offset:41984
    ds_read_b128 v[88:91], v246 offset:24576
    ds_read_b128 v[92:95], v246 offset:25600
    s_waitcnt lgkmcnt(8)
    v_mfma_f32_32x32x16_bf16 v[8:23], v[56:59], v[224:227], 0
    v_mfma_f32_32x32x16_bf16 v[8:23], v[60:63], v[228:231], v[8:23]
    s_waitcnt lgkmcnt(6)
    v_mfma_f32_32x32x16_bf16 v[24:39], v[64:67], v[224:227], 0
    v_mfma_f32_32x32x16_bf16 v[24:39], v[68:71], v[228:231], v[24:39]
    s_waitcnt lgkmcnt(4)
    v_mfma_f32_32x32x16_bf16 v[40:55], v[72:75], v[224:227], 0
    v_mfma_f32_32x32x16_bf16 v[40:55], v[76:79], v[228:231], v[40:55]
    ds_read_b128 v[56:59], v245 offset:12288
    ds_read_b128 v[60:63], v245 offset:13312
    s_cmp_gt_u32 s46, 0
    s_cbranch_scc1 L_mneg_1040
    v_cndmask_b32 v24, v24, v8, s[4:5]
    v_cndmask_b32 v25, v25, v9, s[6:7]
    v_cndmask_b32 v26, v26, v10, s[16:17]
    v_cndmask_b32 v27, v27, v11, s[18:19]
    v_cndmask_b32 v28, v28, v12, s[20:21]
    v_cndmask_b32 v29, v29, v13, s[22:23]
    v_cndmask_b32 v30, v30, v14, s[24:25]
    v_cndmask_b32 v31, v31, v15, s[26:27]
    v_cndmask_b32 v32, v32, v16, s[28:29]
    v_cndmask_b32 v33, v33, v17, s[30:31]
    v_cndmask_b32 v34, v34, v18, s[58:59]
    v_cndmask_b32 v35, v35, v19, s[76:77]
    v_cndmask_b32 v36, v36, v20, s[92:93]
    v_cndmask_b32 v37, v37, v21, s[94:95]
    v_cndmask_b32 v38, v38, v22, s[96:97]
    v_cndmask_b32 v39, v39, v23, s[98:99]
L_mback_1041:
    v_exp_f32 v24, v24
    v_exp_f32 v25, v25
    v_exp_f32 v26, v26
    v_exp_f32 v27, v27
    v_exp_f32 v28, v28
    v_exp_f32 v29, v29
    v_exp_f32 v30, v30
    v_exp_f32 v31, v31
    v_exp_f32 v32, v32
    v_exp_f32 v33, v33
    v_exp_f32 v34, v34
    v_exp_f32 v35, v35
    v_exp_f32 v36, v36
    v_exp_f32 v37, v37
    v_exp_f32 v38, v38
    v_exp_f32 v39, v39
    v_cvt_pk_bf16_f32 v24, v24, v25
    v_cvt_pk_bf16_f32 v25, v26, v27
    v_cvt_pk_bf16_f32 v26, v28, v29
    v_cvt_pk_bf16_f32 v27, v30, v31
    v_cvt_pk_bf16_f32 v28, v32, v33
    v_cvt_pk_bf16_f32 v29, v34, v35
    v_cvt_pk_bf16_f32 v30, v36, v37
    v_cvt_pk_bf16_f32 v31, v38, v39
    v_and_b32 v32, v24, v232
    v_and_b32 v33, v25, v233
    v_and_b32 v34, v26, v234
    v_and_b32 v35, v27, v235
    v_and_b32 v36, v28, v236
    v_and_b32 v37, v29, v237
    v_and_b32 v38, v30, v238
    v_and_b32 v39, v31, v239
    v_xor_b32 v144, v24, v32
    v_xor_b32 v145, v25, v33
    v_xor_b32 v146, v26, v34
    v_xor_b32 v147, v27, v35
    v_xor_b32 v148, v28, v36
    v_xor_b32 v149, v29, v37
    v_xor_b32 v150, v30, v38
    v_xor_b32 v151, v31, v39
    s_waitcnt lgkmcnt(0)
    s_cmp_gt_u32 s46, 7
    s_cbranch_scc1 L_aexit_1042
    s_setprio 2
    buffer_load_dword v157, v199, s[64:67], 0 offen
    ds_read_b128 v[160:163], v245 offset:38912
    ds_read_b128 v[164:167], v245 offset:39936
    ds_read_b128 v[64:67], v245 offset:10240
    ds_read_b128 v[68:71], v245 offset:11264
    v_mfma_f32_32x32x16_bf16 v[8:23], v[56:59], v[224:227], 0
    v_exp_f32 v40, v40
    v_exp_f32 v41, v41
    v_exp_f32 v42, v42
    v_mfma_f32_32x32x16_bf16 v[8:23], v[60:63], v[228:231], v[8:23]
    v_exp_f32 v43, v43
    v_exp_f32 v44, v44
    v_exp_f32 v45, v45
    v_mfma_f32_32x32x16_bf16 v[96:111], v[80:83], v[32:35], 0
    v_exp_f32 v46, v46
    v_exp_f32 v47, v47
    v_exp_f32 v48, v48
    v_mfma_f32_16x16x32_bf16 v[128:131], v[240:243], v[24:27], 0
    v_exp_f32 v49, v49
    v_mfma_f32_32x32x16_bf16 v[96:111], v[84:87], v[36:39], v[96:111]
    v_exp_f32 v50, v50
    v_exp_f32 v51, v51
    v_exp_f32 v52, v52
    v_mfma_f32_16x16x32_bf16 v[128:131], v[240:243], v[28:31], v[128:131]
    v_exp_f32 v53, v53
    v_mfma_f32_32x32x16_bf16 v[96:111], v[88:91], v[144:147], v[96:111]
    v_exp_f32 v54, v54
    v_exp_f32 v55, v55
    v_cvt_pk_bf16_f32 v40, v40, v41
    v_cvt_pk_bf16_f32 v41, v42, v43
    v_mfma_f32_32x32x16_bf16 v[96:111], v[92:95], v[148:151], v[96:111]
    v_cvt_pk_bf16_f32 v42, v44, v45
    v_cvt_pk_bf16_f32 v43, v46, v47
    v_cvt_pk_bf16_f32 v44, v48, v49
    v_cvt_pk_bf16_f32 v45, v50, v51
    v_cvt_pk_bf16_f32 v46, v52, v53
    v_cvt_pk_bf16_f32 v47, v54, v55
    s_waitcnt lgkmcnt(0)
    s_cmp_gt_u32 s46, 6
    s_cbranch_scc1 L_aexit_1043
    s_add_u32 m0, s84, 106496
    s_add_u32 s81, s43, 0
    s_and_b32 s81, s81, 7
    s_lshl_b32 s81, s81, 18
    s_add_u32 s81, s81, s88
    buffer_load_dwordx4 v250, s[60:63], s81 offen lds
    s_add_u32 s81, s81, 15360
    buffer_load_dwordx4 v250, s[60:63], s81 offen offset:1024 lds
    ds_read_b128 v[80:83], v245 offset:36864
    ds_read_b128 v[84:87], v245 offset:37888
    ds_read_b128 v[72:75], v245 offset:8192
    ds_read_b128 v[76:79], v245 offset:9216
    v_mfma_f32_32x32x16_bf16 v[24:39], v[64:67], v[224:227], 0
    v_exp_f32 v8, v8
    v_exp_f32 v9, v9
    v_exp_f32 v10, v10
    v_mfma_f32_32x32x16_bf16 v[24:39], v[68:71], v[228:231], v[24:39]
    v_exp_f32 v11, v11
    v_exp_f32 v12, v12
    v_exp_f32 v13, v13
    v_mfma_f32_32x32x16_bf16 v[96:111], v[160:163], v[40:43], v[96:111]
    v_exp_f32 v14, v14
    v_exp_f32 v15, v15
    v_exp_f32 v16, v16
    v_mfma_f32_16x16x32_bf16 v[128:131], v[240:243], v[40:43], v[128:131]
    v_exp_f32 v17, v17
    v_mfma_f32_32x32x16_bf16 v[96:111], v[164:167], v[44:47], v[96:111]
    v_exp_f32 v18, v18
    v_exp_f32 v19, v19
    v_exp_f32 v20, v20
    v_mfma_f32_16x16x32_bf16 v[128:131], v[240:243], v[44:47], v[128:131]
    v_exp_f32 v21, v21
    v_exp_f32 v22, v22
    v_exp_f32 v23, v23
    v_cvt_pk_bf16_f32 v8, v8, v9
    v_cvt_pk_bf16_f32 v9, v10, v11
    v_cvt_pk_bf16_f32 v10, v12, v13
    v_cvt_pk_bf16_f32 v11, v14, v15
    v_cvt_pk_bf16_f32 v12, v16, v17
    v_cvt_pk_bf16_f32 v13, v18, v19
    v_cvt_pk_bf16_f32 v14, v20, v21
    v_cvt_pk_bf16_f32 v15, v22, v23
    s_waitcnt lgkmcnt(0)
    s_cmp_gt_u32 s46, 5
    s_cbranch_scc1 L_aexit_1044
    s_setprio 1
    s_add_u32 m0, s84, 122880
    s_add_u32 s81, s43, 1
    s_and_b32 s81, s81, 7
    s_lshl_b32 s81, s81, 18
    s_add_u32 s81, s81, s88
    buffer_load_dwordx4 v250, s[60:63], s81 offen lds
    s_add_u32 s81, s81, 15360
    buffer_load_dwordx4 v250, s[60:63], s81 offen offset:1024 lds
    ds_read_b128 v[88:91], v245 offset:34816
    ds_read_b128 v[92:95], v245 offset:35840
    ds_read_b128 v[56:59], v245 offset:6144
    ds_read_b128 v[60:63], v245 offset:7168
    v_mfma_f32_32x32x16_bf16 v[40:55], v[72:75], v[224:227], 0
    v_exp_f32 v24, v24
    v_exp_f32 v25, v25
    v_exp_f32 v26, v26
    v_mfma_f32_32x32x16_bf16 v[40:55], v[76:79], v[228:231], v[40:55]
    v_exp_f32 v27, v27
    v_exp_f32 v28, v28
    v_exp_f32 v29, v29
    v_mfma_f32_32x32x16_bf16 v[96:111], v[80:83], v[8:11], v[96:111]
    v_exp_f32 v30, v30
    v_exp_f32 v31, v31
    v_exp_f32 v32, v32
    v_mfma_f32_16x16x32_bf16 v[128:131], v[240:243], v[8:11], v[128:131]
    v_exp_f32 v33, v33
    v_mfma_f32_32x32x16_bf16 v[96:111], v[84:87], v[12:15], v[96:111]
    v_exp_f32 v34, v34
    v_exp_f32 v35, v35
    v_exp_f32 v36, v36
    v_mfma_f32_16x16x32_bf16 v[128:131], v[240:243], v[12:15], v[128:131]
    v_exp_f32 v37, v37
    v_exp_f32 v38, v38
    v_exp_f32 v39, v39
    v_cvt_pk_bf16_f32 v24, v24, v25
    v_cvt_pk_bf16_f32 v25, v26, v27
    v_cvt_pk_bf16_f32 v26, v28, v29
    v_cvt_pk_bf16_f32 v27, v30, v31
    v_cvt_pk_bf16_f32 v28, v32, v33
    v_cvt_pk_bf16_f32 v29, v34, v35
    v_cvt_pk_bf16_f32 v30, v36, v37
    v_cvt_pk_bf16_f32 v31, v38, v39
    s_waitcnt lgkmcnt(0)
    s_cmp_gt_u32 s46, 4
    s_cbranch_scc1 L_aexit_1045
    s_add_u32 m0, s84, 139264
    s_add_u32 s81, s43, 2
    s_and_b32 s81, s81, 7
    s_lshl_b32 s81, s81, 18
    s_add_u32 s81, s81, s88
    buffer_load_dwordx4 v250, s[60:63], s81 offen lds
    s_add_u32 s81, s81, 15360
    buffer_load_dwordx4 v250, s[60:63], s81 offen offset:1024 lds
    ds_read_b128 v[160:163], v245 offset:32768
    ds_read_b128 v[164:167], v245 offset:33792
    ds_read_b128 v[64:67], v245 offset:4096
    ds_read_b128 v[68:71], v245 offset:5120
    v_mfma_f32_32x32x16_bf16 v[8:23], v[56:59], v[224:227], 0
    v_exp_f32 v40, v40
    v_exp_f32 v41, v41
    v_exp_f32 v42, v42
    v_mfma_f32_32x32x16_bf16 v[8:23], v[60:63], v[228:231], v[8:23]
    v_exp_f32 v43, v43
    v_exp_f32 v44, v44
    v_exp_f32 v45, v45
    v_mfma_f32_32x32x16_bf16 v[96:111], v[88:91], v[24:27], v[96:111]
    v_exp_f32 v46, v46
    v_exp_f32 v47, v47
    v_exp_f32 v48, v48
    v_mfma_f32_16x16x32_bf16 v[128:131], v[240:243], v[24:27], v[128:131]
    v_exp_f32 v49, v49
    v_mfma_f32_32x32x16_bf16 v[96:111], v[92:95], v[28:31], v[96:111]
    v_exp_f32 v50, v50
    v_exp_f32 v51, v51
    v_exp_f32 v52, v52
    v_mfma_f32_16x16x32_bf16 v[128:131], v[240:243], v[28:31], v[128:131]
    v_exp_f32 v53, v53
    v_exp_f32 v54, v54
    v_exp_f32 v55, v55
    v_cvt_pk_bf16_f32 v40, v40, v41
    v_cvt_pk_bf16_f32 v41, v42, v43
    v_cvt_pk_bf16_f32 v42, v44, v45
    v_cvt_pk_bf16_f32 v43, v46, v47
    v_cvt_pk_bf16_f32 v44, v48, v49
    v_cvt_pk_bf16_f32 v45, v50, v51
    v_cvt_pk_bf16_f32 v46, v52, v53
    v_cvt_pk_bf16_f32 v47, v54, v55
    s_waitcnt lgkmcnt(0)
    s_cmp_gt_u32 s46, 3
    s_cbranch_scc1 L_aexit_1046
    s_setprio 0
    ds_read_b128 v[80:83], v245 offset:30720
    ds_read_b128 v[84:87], v245 offset:31744
    ds_read_b128 v[72:75], v245 offset:2048
    ds_read_b128 v[76:79], v245 offset:3072
    v_mfma_f32_32x32x16_bf16 v[24:39], v[64:67], v[224:227], 0
    v_exp_f32 v8, v8
    v_exp_f32 v9, v9
    v_exp_f32 v10, v10
    v_mfma_f32_32x32x16_bf16 v[24:39], v[68:71], v[228:231], v[24:39]
    v_exp_f32 v11, v11
    v_exp_f32 v12, v12
    v_exp_f32 v13, v13
    v_mfma_f32_32x32x16_bf16 v[96:111], v[160:163], v[40:43], v[96:111]
    v_exp_f32 v14, v14
    v_exp_f32 v15, v15
    v_exp_f32 v16, v16
    v_mfma_f32_16x16x32_bf16 v[128:131], v[240:243], v[40:43], v[128:131]
    v_exp_f32 v17, v17
    v_mfma_f32_32x32x16_bf16 v[96:111], v[164:167], v[44:47], v[96:111]
    v_exp_f32 v18, v18
    v_exp_f32 v19, v19
    v_exp_f32 v20, v20
    v_mfma_f32_16x16x32_bf16 v[128:131], v[240:243], v[44:47], v[128:131]
    v_exp_f32 v21, v21
    v_exp_f32 v22, v22
    v_exp_f32 v23, v23
    v_cvt_pk_bf16_f32 v8, v8, v9
    v_cvt_pk_bf16_f32 v9, v10, v11
    v_cvt_pk_bf16_f32 v10, v12, v13
    v_cvt_pk_bf16_f32 v11, v14, v15
    v_cvt_pk_bf16_f32 v12, v16, v17
    v_cvt_pk_bf16_f32 v13, v18, v19
    v_cvt_pk_bf16_f32 v14, v20, v21
    v_cvt_pk_bf16_f32 v15, v22, v23
    s_waitcnt lgkmcnt(0)
    s_cmp_gt_u32 s46, 2
    s_cbranch_scc1 L_aexit_1047
    s_lshl_b32 s80, s32, 2
    v_add_u32 v158, s80, v251
    v_mov_b32 v159, 1
    ds_write_b32 v158, v159 offset:64
    ds_read_b128 v[88:91], v245 offset:28672
    ds_read_b128 v[92:95], v245 offset:29696
    v_mfma_f32_32x32x16_bf16 v[40:55], v[72:75], v[224:227], 0
    v_exp_f32 v24, v24
    v_exp_f32 v25, v25
    v_exp_f32 v26, v26
    v_mfma_f32_32x32x16_bf16 v[40:55], v[76:79], v[228:231], v[40:55]
    v_exp_f32 v27, v27
    v_exp_f32 v28, v28
    v_exp_f32 v29, v29
    v_mfma_f32_32x32x16_bf16 v[96:111], v[80:83], v[8:11], v[96:111]
    v_exp_f32 v30, v30
    v_exp_f32 v31, v31
    v_exp_f32 v32, v32
    v_mfma_f32_16x16x32_bf16 v[128:131], v[240:243], v[8:11], v[128:131]
    v_exp_f32 v33, v33
    v_mfma_f32_32x32x16_bf16 v[96:111], v[84:87], v[12:15], v[96:111]
    v_exp_f32 v34, v34
    v_exp_f32 v35, v35
    v_exp_f32 v36, v36
    v_mfma_f32_16x16x32_bf16 v[128:131], v[240:243], v[12:15], v[128:131]
    v_exp_f32 v37, v37
    v_exp_f32 v38, v38
    v_exp_f32 v39, v39
    v_cvt_pk_bf16_f32 v24, v24, v25
    v_cvt_pk_bf16_f32 v25, v26, v27
    v_cvt_pk_bf16_f32 v26, v28, v29
    v_cvt_pk_bf16_f32 v27, v30, v31
    v_cvt_pk_bf16_f32 v28, v32, v33
    v_cvt_pk_bf16_f32 v29, v34, v35
    v_cvt_pk_bf16_f32 v30, v36, v37
    v_cvt_pk_bf16_f32 v31, v38, v39
    s_waitcnt lgkmcnt(0)
    s_cmp_gt_u32 s46, 1
    s_cbranch_scc1 L_aexit_1048
    ds_read_b128 v[160:163], v245 offset:26624
    ds_read_b128 v[164:167], v245 offset:27648
    v_mfma_f32_32x32x16_bf16 v[96:111], v[88:91], v[24:27], v[96:111]
    v_exp_f32 v40, v40
    v_exp_f32 v41, v41
    v_exp_f32 v42, v42
    v_mfma_f32_16x16x32_bf16 v[128:131], v[240:243], v[24:27], v[128:131]
    v_exp_f32 v43, v43
    v_mfma_f32_32x32x16_bf16 v[96:111], v[92:95], v[28:31], v[96:111]
    v_exp_f32 v44, v44
    v_exp_f32 v45, v45
    v_exp_f32 v46, v46
    v_mfma_f32_16x16x32_bf16 v[128:131], v[240:243], v[28:31], v[128:131]
    v_exp_f32 v47, v47
    v_exp_f32 v48, v48
    v_exp_f32 v49, v49
    v_exp_f32 v50, v50
    v_exp_f32 v51, v51
    v_exp_f32 v52, v52
    v_exp_f32 v53, v53
    v_exp_f32 v54, v54
    v_exp_f32 v55, v55
    v_cvt_pk_bf16_f32 v40, v40, v41
    v_cvt_pk_bf16_f32 v41, v42, v43
    v_cvt_pk_bf16_f32 v42, v44, v45
    v_cvt_pk_bf16_f32 v43, v46, v47
    v_cvt_pk_bf16_f32 v44, v48, v49
    v_cvt_pk_bf16_f32 v45, v50, v51
    v_cvt_pk_bf16_f32 v46, v52, v53
    v_cvt_pk_bf16_f32 v47, v54, v55
    s_waitcnt lgkmcnt(0)
    v_mfma_f32_32x32x16_bf16 v[96:111], v[160:163], v[40:43], v[96:111]
    v_mfma_f32_16x16x32_bf16 v[128:131], v[240:243], v[40:43], v[128:131]
    v_mfma_f32_32x32x16_bf16 v[96:111], v[164:167], v[44:47], v[96:111]
    v_mfma_f32_16x16x32_bf16 v[128:131], v[240:243], v[44:47], v[128:131]
L_afin_1039:
    s_setprio 0
    s_nop 7
    s_nop 3
    v_rcp_f32 v154, v128
    v_mul_f32 v153, 0, v96
    v_fmac_f32 v128, 0, v97
    v_fmac_f32 v153, 0, v98
    v_fmac_f32 v128, 0, v99
    v_fmac_f32 v153, 0, v100
    v_fmac_f32 v128, 0, v101
    v_fmac_f32 v153, 0, v102
    v_fmac_f32 v128, 0, v103
    v_fmac_f32 v153, 0, v104
    v_fmac_f32 v128, 0, v105
    v_fmac_f32 v153, 0, v106
    v_fmac_f32 v128, 0, v107
    v_fmac_f32 v153, 0, v108
    v_fmac_f32 v128, 0, v109
    v_fmac_f32 v153, 0, v110
    v_fmac_f32 v128, 0, v111
    v_add_f32 v153, v153, v128
    v_add_f32 v153, v153, v154
    v_cmp_gt_f32 vcc, 0x4e800000, v153
    s_mov_b32 s101, 1
    s_nop 0
    s_cmp_eq_u64 vcc, -1
    s_cbranch_scc0 L_exact
L_normM:
    v_mul_f32 v96, v96, v154
    v_mul_f32 v97, v97, v154
    v_mul_f32 v98, v98, v154
    v_mul_f32 v99, v99, v154
    v_mul_f32 v100, v100, v154
    v_mul_f32 v101, v101, v154
    v_mul_f32 v102, v102, v154
    v_mul_f32 v103, v103, v154
    v_mul_f32 v104, v104, v154
    v_mul_f32 v105, v105, v154
    v_mul_f32 v106, v106, v154
    v_mul_f32 v107, v107, v154
    v_mul_f32 v108, v108, v154
    v_mul_f32 v109, v109, v154
    v_mul_f32 v110, v110, v154
    v_mul_f32 v111, v111, v154
    v_cvt_pk_bf16_f32 v96, v96, v97
    v_cvt_pk_bf16_f32 v97, v98, v99
    v_cvt_pk_bf16_f32 v98, v100, v101
    v_cvt_pk_bf16_f32 v99, v102, v103
    v_cvt_pk_bf16_f32 v100, v104, v105
    v_cvt_pk_bf16_f32 v101, v106, v107
    v_cvt_pk_bf16_f32 v102, v108, v109
    v_cvt_pk_bf16_f32 v103, v110, v111
    buffer_store_dwordx4 v[96:99], v1, s[12:15], s47 offen sc1
    buffer_store_dwordx4 v[100:103], v1, s[12:15], s47 offen offset:1024 sc1
    s_waitcnt vmcnt(0)
    s_add_u32 s80, s89, 0x1818000
    v_mov_b32 v220, s78
    v_mov_b32 v221, s79
    s_mov_b64 exec, 1
    buffer_store_dwordx2 v[220:221], v252, s[12:15], s80 offen sc1
    s_mov_b64 exec, -1
    s_lshl_b32 s80, s32, 2
    v_add_u32 v222, s80, v251
    v_mov_b32 v223, 1
    ds_write_b32 v222, v223 offset:32
    s_mov_b32 s85, 0
L_lw_1049:
    ds_read_b128 v[8:11], v251 offset:32
    s_waitcnt lgkmcnt(0)
    v_and_b32 v8, v8, v9
    v_and_b32 v10, v10, v11
    v_and_b32 v8, v8, v10
    s_add_u32 s85, s85, 1
    v_readfirstlane_b32 s80, v8
    s_nop 1
    s_cmp_lg_u32 s80, 0
    s_cbranch_scc1 L_lwd_1050
    s_cmp_lt_u32 s85, 0x40000
    s_cbranch_scc1 L_lw_1049
L_lwd_1050:
    s_mov_b32 s85, 0
L_lw_1051:
    ds_read_b128 v[8:11], v251 offset:48
    s_waitcnt lgkmcnt(0)
    v_and_b32 v8, v8, v9
    v_and_b32 v10, v10, v11
    v_and_b32 v8, v8, v10
    s_add_u32 s85, s85, 1
    v_readfirstlane_b32 s80, v8
    s_nop 1
    s_cmp_lg_u32 s80, 0
    s_cbranch_scc1 L_lwd_1052
    s_cmp_lt_u32 s85, 0x40000
    s_cbranch_scc1 L_lw_1051
L_lwd_1052:
    s_and_b32 s83, s32, 3
    s_lshl_b32 s82, s83, 10
    s_lshl_b32 s81, s43, 4
    s_add_u32 s83, s83, s81
    s_add_u32 m0, s82, 0
    s_add_u32 s81, s83, 48
    s_and_b32 s81, s81, 127
    s_lshl_b32 s81, s81, 14
    buffer_load_dwordx4 v250, s[60:63], s81 offen lds
    s_add_u32 m0, s82, 8192
    s_add_u32 s81, s83, 56
    s_and_b32 s81, s81, 127
    s_lshl_b32 s81, s81, 14
    buffer_load_dwordx4 v250, s[60:63], s81 offen lds
    s_add_u32 m0, s82, 16384
    s_add_u32 s81, s83, 64
    s_and_b32 s81, s81, 127
    s_lshl_b32 s81, s81, 14
    buffer_load_dwordx4 v250, s[60:63], s81 offen lds
    s_add_u32 m0, s82, 36864
    s_add_u32 s81, s83, 72
    s_and_b32 s81, s81, 127
    s_lshl_b32 s81, s81, 14
    buffer_load_dwordx4 v250, s[60:63], s81 offen lds
    s_add_u32 m0, s82, 45056
    s_add_u32 s81, s83, 80
    s_and_b32 s81, s81, 127
    s_lshl_b32 s81, s81, 14
    buffer_load_dwordx4 v250, s[60:63], s81 offen lds
    s_add_u32 m0, s82, 53248
    s_add_u32 s81, s83, 88
    s_and_b32 s81, s81, 127
    s_lshl_b32 s81, s81, 14
    buffer_load_dwordx4 v250, s[60:63], s81 offen lds
    s_add_u32 m0, s82, 61440
    s_add_u32 s81, s83, 96
    s_and_b32 s81, s81, 127
    s_lshl_b32 s81, s81, 14
    buffer_load_dwordx4 v250, s[60:63], s81 offen lds
    s_add_u32 m0, s82, 69632
    s_add_u32 s81, s83, 104
    s_and_b32 s81, s81, 127
    s_lshl_b32 s81, s81, 14
    buffer_load_dwordx4 v250, s[60:63], s81 offen lds
    s_add_u32 m0, s82, 90112
    s_add_u32 s81, s83, 112
    s_and_b32 s81, s81, 127
    s_lshl_b32 s81, s81, 14
    buffer_load_dwordx4 v250, s[60:63], s81 offen lds
    s_add_u32 m0, s82, 98304
    s_add_u32 s81, s83, 120
    s_and_b32 s81, s81, 127
    s_lshl_b32 s81, s81, 14
    buffer_load_dwordx4 v250, s[60:63], s81 offen lds
    s_sleep 8
    buffer_load_dwordx2 v[12:13], v191, s[12:15], 0 offen sc1
    s_waitcnt vmcnt(1)
    s_lshl_b32 s80, s32, 2
    v_add_u32 v16, s80, v251
    v_mov_b32 v17, 1
    ds_write_b32 v16, v17 offset:0
    s_mov_b32 s80, 0xffffffff
    s_mov_b32 s81, 0x0
    s_mov_b32 s85, 0
L_pollc_1054:
    s_waitcnt vmcnt(0)
    v_cmp_eq_u64 vcc, s[78:79], v[12:13]
    s_add_u32 s85, s85, 1
    s_and_b64 s[82:83], vcc, s[80:81]
    s_cmp_eq_u64 s[82:83], s[80:81]
    s_cbranch_scc1 L_polld_1055
    buffer_load_dwordx2 v[12:13], v191, s[12:15], 0 offen sc1
    s_cmp_lt_u32 s85, 0x40000
    s_cbranch_scc1 L_pollc_1054
    s_waitcnt vmcnt(0)
L_polld_1055:
    buffer_load_dwordx4 v[72:75], v3, s[12:15], s48 offen offset:0
    buffer_load_dwordx4 v[76:79], v3, s[12:15], s48 offen offset:256
    buffer_load_dwordx4 v[80:83], v3, s[12:15], s48 offen offset:2048
    buffer_load_dwordx4 v[84:87], v3, s[12:15], s48 offen offset:2304
    s_add_u32 s48, s48, 4096
    buffer_load_dwordx4 v[88:91], v3, s[12:15], s48 offen offset:0
    buffer_load_dwordx4 v[92:95], v3, s[12:15], s48 offen offset:256
    buffer_load_dwordx4 v[96:99], v3, s[12:15], s48 offen offset:2048
    buffer_load_dwordx4 v[100:103], v3, s[12:15], s48 offen offset:2304
    buffer_load_dwordx4 v[104:107], v3, s[12:15], s49 offen offset:0
    buffer_load_dwordx4 v[108:111], v3, s[12:15], s49 offen offset:256
    buffer_load_dwordx4 v[112:115], v3, s[12:15], s49 offen offset:2048
    buffer_load_dwordx4 v[116:119], v3, s[12:15], s49 offen offset:2304
    s_add_u32 s49, s49, 4096
    buffer_load_dwordx4 v[120:123], v3, s[12:15], s49 offen offset:0
    buffer_load_dwordx4 v[124:127], v3, s[12:15], s49 offen offset:256
    buffer_load_dwordx4 v[128:131], v3, s[12:15], s49 offen offset:2048
    buffer_load_dwordx4 v[132:135], v3, s[12:15], s49 offen offset:2304
    v_xor_b32 v200, 0, v2
    v_xor_b32 v201, 32, v2
    v_xor_b32 v202, 64, v2
    v_xor_b32 v203, 96, v2
    v_xor_b32 v204, 0, v2
    v_add_u32 v204, 65536, v204
    v_xor_b32 v205, 32, v2
    v_add_u32 v205, 65536, v205
    v_xor_b32 v206, 64, v2
    v_add_u32 v206, 65536, v206
    v_xor_b32 v207, 96, v2
    v_add_u32 v207, 65536, v207
    v_xor_b32 v208, 0, v2
    v_add_u32 v208, 106496, v208
    v_xor_b32 v209, 32, v2
    v_add_u32 v209, 106496, v209
    v_xor_b32 v210, 64, v2
    v_add_u32 v210, 106496, v210
    v_xor_b32 v211, 96, v2
    v_add_u32 v211, 106496, v211
    s_mov_b32 s85, 0
L_lw_1056:
    ds_read_b128 v[16:19], v251 offset:0
    s_waitcnt lgkmcnt(0)
    v_and_b32 v16, v16, v17
    v_and_b32 v18, v18, v19
    v_and_b32 v16, v16, v18
    s_add_u32 s85, s85, 1
    v_readfirstlane_b32 s80, v16
    s_nop 1
    s_cmp_lg_u32 s80, 0
    s_cbranch_scc1 L_lwd_1057
    s_cmp_lt_u32 s85, 0x40000
    s_cbranch_scc1 L_lw_1056
L_lwd_1057:
    s_mov_b32 s85, 0
L_lw_1058:
    ds_read_b128 v[16:19], v251 offset:16
    s_waitcnt lgkmcnt(0)
    v_and_b32 v16, v16, v17
    v_and_b32 v18, v18, v19
    v_and_b32 v16, v16, v18
    s_add_u32 s85, s85, 1
    v_readfirstlane_b32 s80, v16
    s_nop 1
    s_cmp_lg_u32 s80, 0
    s_cbranch_scc1 L_lwd_1059
    s_cmp_lt_u32 s85, 0x40000
    s_cbranch_scc1 L_lw_1058
L_lwd_1059:
    ds_read_b64_tr_b16 v[16:17], v208 offset:0
    ds_read_b64_tr_b16 v[18:19], v208 offset:1024
    ds_read_b64_tr_b16 v[20:21], v209 offset:0
    ds_read_b64_tr_b16 v[22:23], v209 offset:1024
    ds_read_b64_tr_b16 v[24:25], v210 offset:0
    ds_read_b64_tr_b16 v[26:27], v210 offset:1024
    ds_read_b64_tr_b16 v[28:29], v211 offset:0
    ds_read_b64_tr_b16 v[30:31], v211 offset:1024
    ds_read_b64_tr_b16 v[212:213], v208 offset:4096
    ds_read_b64_tr_b16 v[214:215], v208 offset:5120
    ds_read_b64_tr_b16 v[216:217], v209 offset:4096
    ds_read_b64_tr_b16 v[218:219], v209 offset:5120
    ds_read_b64_tr_b16 v[220:221], v210 offset:4096
    ds_read_b64_tr_b16 v[222:223], v210 offset:5120
    ds_read_b64_tr_b16 v[224:225], v211 offset:4096
    ds_read_b64_tr_b16 v[226:227], v211 offset:5120
    s_waitcnt vmcnt(15) lgkmcnt(8)
    v_mfma_f32_16x16x32_bf16 v[40:43], v[16:19], v[72:75], 0
    ds_read_b64_tr_b16 v[228:229], v208 offset:8192
    v_mfma_f32_16x16x32_bf16 v[48:51], v[20:23], v[72:75], 0
    ds_read_b64_tr_b16 v[230:231], v208 offset:9216
    v_mfma_f32_16x16x32_bf16 v[56:59], v[24:27], v[72:75], 0
    ds_read_b64_tr_b16 v[232:233], v209 offset:8192
    v_mfma_f32_16x16x32_bf16 v[64:67], v[28:31], v[72:75], 0
    ds_read_b64_tr_b16 v[234:235], v209 offset:9216
    buffer_load_dwordx4 v[72:75], v3, s[12:15], s50 offen offset:0
    s_waitcnt vmcnt(15)
    v_mfma_f32_16x16x32_bf16 v[44:47], v[16:19], v[76:79], 0
    ds_read_b64_tr_b16 v[236:237], v210 offset:8192
    v_mfma_f32_16x16x32_bf16 v[52:55], v[20:23], v[76:79], 0
    ds_read_b64_tr_b16 v[238:239], v210 offset:9216
    v_mfma_f32_16x16x32_bf16 v[60:63], v[24:27], v[76:79], 0
    ds_read_b64_tr_b16 v[240:241], v211 offset:8192
    v_mfma_f32_16x16x32_bf16 v[68:71], v[28:31], v[76:79], 0
    ds_read_b64_tr_b16 v[242:243], v211 offset:9216
    buffer_load_dwordx4 v[76:79], v3, s[12:15], s50 offen offset:256
    s_waitcnt vmcnt(15) lgkmcnt(8)
    v_mfma_f32_16x16x32_bf16 v[40:43], v[212:215], v[80:83], v[40:43]
    ds_read_b64_tr_b16 v[16:17], v208 offset:12288
    v_mfma_f32_16x16x32_bf16 v[48:51], v[216:219], v[80:83], v[48:51]
    ds_read_b64_tr_b16 v[18:19], v208 offset:13312
    v_mfma_f32_16x16x32_bf16 v[56:59], v[220:223], v[80:83], v[56:59]
    ds_read_b64_tr_b16 v[20:21], v209 offset:12288
    v_mfma_f32_16x16x32_bf16 v[64:67], v[224:227], v[80:83], v[64:67]
    ds_read_b64_tr_b16 v[22:23], v209 offset:13312
    buffer_load_dwordx4 v[80:83], v3, s[12:15], s50 offen offset:2048
    s_waitcnt vmcnt(15)
    v_mfma_f32_16x16x32_bf16 v[44:47], v[212:215], v[84:87], v[44:47]
    ds_read_b64_tr_b16 v[24:25], v210 offset:12288
    v_mfma_f32_16x16x32_bf16 v[52:55], v[216:219], v[84:87], v[52:55]
    ds_read_b64_tr_b16 v[26:27], v210 offset:13312
    v_mfma_f32_16x16x32_bf16 v[60:63], v[220:223], v[84:87], v[60:63]
    ds_read_b64_tr_b16 v[28:29], v211 offset:12288
    v_mfma_f32_16x16x32_bf16 v[68:71], v[224:227], v[84:87], v[68:71]
    ds_read_b64_tr_b16 v[30:31], v211 offset:13312
    buffer_load_dwordx4 v[84:87], v3, s[12:15], s50 offen offset:2304
    s_waitcnt vmcnt(15) lgkmcnt(8)
    v_mfma_f32_16x16x32_bf16 v[40:43], v[228:231], v[88:91], v[40:43]
    ds_read_b64_tr_b16 v[212:213], v208 offset:16384
    v_mfma_f32_16x16x32_bf16 v[48:51], v[232:235], v[88:91], v[48:51]
    ds_read_b64_tr_b16 v[214:215], v208 offset:17408
    v_mfma_f32_16x16x32_bf16 v[56:59], v[236:239], v[88:91], v[56:59]
    ds_read_b64_tr_b16 v[216:217], v209 offset:16384
    v_mfma_f32_16x16x32_bf16 v[64:67], v[240:243], v[88:91], v[64:67]
    ds_read_b64_tr_b16 v[218:219], v209 offset:17408
    s_add_u32 s50, s50, 4096
    buffer_load_dwordx4 v[88:91], v3, s[12:15], s50 offen offset:0
    s_waitcnt vmcnt(15)
    v_mfma_f32_16x16x32_bf16 v[44:47], v[228:231], v[92:95], v[44:47]
    ds_read_b64_tr_b16 v[220:221], v210 offset:16384
    v_mfma_f32_16x16x32_bf16 v[52:55], v[232:235], v[92:95], v[52:55]
    ds_read_b64_tr_b16 v[222:223], v210 offset:17408
    v_mfma_f32_16x16x32_bf16 v[60:63], v[236:239], v[92:95], v[60:63]
    ds_read_b64_tr_b16 v[224:225], v211 offset:16384
    v_mfma_f32_16x16x32_bf16 v[68:71], v[240:243], v[92:95], v[68:71]
    ds_read_b64_tr_b16 v[226:227], v211 offset:17408
    buffer_load_dwordx4 v[92:95], v3, s[12:15], s50 offen offset:256
    s_waitcnt vmcnt(15) lgkmcnt(8)
    v_mfma_f32_16x16x32_bf16 v[40:43], v[16:19], v[96:99], v[40:43]
    ds_read_b64_tr_b16 v[228:229], v208 offset:20480
    v_mfma_f32_16x16x32_bf16 v[48:51], v[20:23], v[96:99], v[48:51]
    ds_read_b64_tr_b16 v[230:231], v208 offset:21504
    v_mfma_f32_16x16x32_bf16 v[56:59], v[24:27], v[96:99], v[56:59]
    ds_read_b64_tr_b16 v[232:233], v209 offset:20480
    v_mfma_f32_16x16x32_bf16 v[64:67], v[28:31], v[96:99], v[64:67]
    ds_read_b64_tr_b16 v[234:235], v209 offset:21504
    buffer_load_dwordx4 v[96:99], v3, s[12:15], s50 offen offset:2048
    s_waitcnt vmcnt(15)
    v_mfma_f32_16x16x32_bf16 v[44:47], v[16:19], v[100:103], v[44:47]
    ds_read_b64_tr_b16 v[236:237], v210 offset:20480
    v_mfma_f32_16x16x32_bf16 v[52:55], v[20:23], v[100:103], v[52:55]
    ds_read_b64_tr_b16 v[238:239], v210 offset:21504
    v_mfma_f32_16x16x32_bf16 v[60:63], v[24:27], v[100:103], v[60:63]
    ds_read_b64_tr_b16 v[240:241], v211 offset:20480
    v_mfma_f32_16x16x32_bf16 v[68:71], v[28:31], v[100:103], v[68:71]
    ds_read_b64_tr_b16 v[242:243], v211 offset:21504
    buffer_load_dwordx4 v[100:103], v3, s[12:15], s50 offen offset:2304
    s_waitcnt vmcnt(15) lgkmcnt(8)
    v_mfma_f32_16x16x32_bf16 v[40:43], v[212:215], v[104:107], v[40:43]
    ds_read_b64_tr_b16 v[16:17], v208 offset:24576
    v_mfma_f32_16x16x32_bf16 v[48:51], v[216:219], v[104:107], v[48:51]
    ds_read_b64_tr_b16 v[18:19], v208 offset:25600
    v_mfma_f32_16x16x32_bf16 v[56:59], v[220:223], v[104:107], v[56:59]
    ds_read_b64_tr_b16 v[20:21], v209 offset:24576
    v_mfma_f32_16x16x32_bf16 v[64:67], v[224:227], v[104:107], v[64:67]
    ds_read_b64_tr_b16 v[22:23], v209 offset:25600
    buffer_load_dwordx4 v[104:107], v3, s[12:15], s51 offen offset:0
    s_waitcnt vmcnt(15)
    v_mfma_f32_16x16x32_bf16 v[44:47], v[212:215], v[108:111], v[44:47]
    ds_read_b64_tr_b16 v[24:25], v210 offset:24576
    v_mfma_f32_16x16x32_bf16 v[52:55], v[216:219], v[108:111], v[52:55]
    ds_read_b64_tr_b16 v[26:27], v210 offset:25600
    v_mfma_f32_16x16x32_bf16 v[60:63], v[220:223], v[108:111], v[60:63]
    ds_read_b64_tr_b16 v[28:29], v211 offset:24576
    v_mfma_f32_16x16x32_bf16 v[68:71], v[224:227], v[108:111], v[68:71]
    ds_read_b64_tr_b16 v[30:31], v211 offset:25600
    buffer_load_dwordx4 v[108:111], v3, s[12:15], s51 offen offset:256
    s_waitcnt vmcnt(15) lgkmcnt(8)
    v_mfma_f32_16x16x32_bf16 v[40:43], v[228:231], v[112:115], v[40:43]
    ds_read_b64_tr_b16 v[212:213], v208 offset:28672
    v_mfma_f32_16x16x32_bf16 v[48:51], v[232:235], v[112:115], v[48:51]
    ds_read_b64_tr_b16 v[214:215], v208 offset:29696
    v_mfma_f32_16x16x32_bf16 v[56:59], v[236:239], v[112:115], v[56:59]
    ds_read_b64_tr_b16 v[216:217], v209 offset:28672
    v_mfma_f32_16x16x32_bf16 v[64:67], v[240:243], v[112:115], v[64:67]
    ds_read_b64_tr_b16 v[218:219], v209 offset:29696
    buffer_load_dwordx4 v[112:115], v3, s[12:15], s51 offen offset:2048
    s_waitcnt vmcnt(15)
    v_mfma_f32_16x16x32_bf16 v[44:47], v[228:231], v[116:119], v[44:47]
    ds_read_b64_tr_b16 v[220:221], v210 offset:28672
    v_mfma_f32_16x16x32_bf16 v[52:55], v[232:235], v[116:119], v[52:55]
    ds_read_b64_tr_b16 v[222:223], v210 offset:29696
    v_mfma_f32_16x16x32_bf16 v[60:63], v[236:239], v[116:119], v[60:63]
    ds_read_b64_tr_b16 v[224:225], v211 offset:28672
    v_mfma_f32_16x16x32_bf16 v[68:71], v[240:243], v[116:119], v[68:71]
    ds_read_b64_tr_b16 v[226:227], v211 offset:29696
    buffer_load_dwordx4 v[116:119], v3, s[12:15], s51 offen offset:2304
    s_waitcnt vmcnt(15) lgkmcnt(8)
    v_mfma_f32_16x16x32_bf16 v[40:43], v[16:19], v[120:123], v[40:43]
    ds_read_b64_tr_b16 v[228:229], v208 offset:32768
    v_mfma_f32_16x16x32_bf16 v[48:51], v[20:23], v[120:123], v[48:51]
    ds_read_b64_tr_b16 v[230:231], v208 offset:33792
    v_mfma_f32_16x16x32_bf16 v[56:59], v[24:27], v[120:123], v[56:59]
    ds_read_b64_tr_b16 v[232:233], v209 offset:32768
    v_mfma_f32_16x16x32_bf16 v[64:67], v[28:31], v[120:123], v[64:67]
    ds_read_b64_tr_b16 v[234:235], v209 offset:33792
    s_add_u32 s51, s51, 4096
    buffer_load_dwordx4 v[120:123], v3, s[12:15], s51 offen offset:0
    s_waitcnt vmcnt(15)
    v_mfma_f32_16x16x32_bf16 v[44:47], v[16:19], v[124:127], v[44:47]
    ds_read_b64_tr_b16 v[236:237], v210 offset:32768
    v_mfma_f32_16x16x32_bf16 v[52:55], v[20:23], v[124:127], v[52:55]
    ds_read_b64_tr_b16 v[238:239], v210 offset:33792
    v_mfma_f32_16x16x32_bf16 v[60:63], v[24:27], v[124:127], v[60:63]
    ds_read_b64_tr_b16 v[240:241], v211 offset:32768
    v_mfma_f32_16x16x32_bf16 v[68:71], v[28:31], v[124:127], v[68:71]
    ds_read_b64_tr_b16 v[242:243], v211 offset:33792
    buffer_load_dwordx4 v[124:127], v3, s[12:15], s51 offen offset:256
    s_waitcnt vmcnt(15) lgkmcnt(8)
    v_mfma_f32_16x16x32_bf16 v[40:43], v[212:215], v[128:131], v[40:43]
    ds_read_b64_tr_b16 v[16:17], v208 offset:36864
    v_mfma_f32_16x16x32_bf16 v[48:51], v[216:219], v[128:131], v[48:51]
    ds_read_b64_tr_b16 v[18:19], v208 offset:37888
    v_mfma_f32_16x16x32_bf16 v[56:59], v[220:223], v[128:131], v[56:59]
    ds_read_b64_tr_b16 v[20:21], v209 offset:36864
    v_mfma_f32_16x16x32_bf16 v[64:67], v[224:227], v[128:131], v[64:67]
    ds_read_b64_tr_b16 v[22:23], v209 offset:37888
    buffer_load_dwordx4 v[128:131], v3, s[12:15], s51 offen offset:2048
    s_waitcnt vmcnt(15)
    v_mfma_f32_16x16x32_bf16 v[44:47], v[212:215], v[132:135], v[44:47]
    ds_read_b64_tr_b16 v[24:25], v210 offset:36864
    v_mfma_f32_16x16x32_bf16 v[52:55], v[216:219], v[132:135], v[52:55]
    ds_read_b64_tr_b16 v[26:27], v210 offset:37888
    v_mfma_f32_16x16x32_bf16 v[60:63], v[220:223], v[132:135], v[60:63]
    ds_read_b64_tr_b16 v[28:29], v211 offset:36864
    v_mfma_f32_16x16x32_bf16 v[68:71], v[224:227], v[132:135], v[68:71]
    ds_read_b64_tr_b16 v[30:31], v211 offset:37888
    buffer_load_dwordx4 v[132:135], v3, s[12:15], s51 offen offset:2304
    s_waitcnt vmcnt(15) lgkmcnt(8)
    v_mfma_f32_16x16x32_bf16 v[40:43], v[228:231], v[72:75], v[40:43]
    ds_read_b64_tr_b16 v[212:213], v208 offset:40960
    v_mfma_f32_16x16x32_bf16 v[48:51], v[232:235], v[72:75], v[48:51]
    ds_read_b64_tr_b16 v[214:215], v208 offset:41984
    v_mfma_f32_16x16x32_bf16 v[56:59], v[236:239], v[72:75], v[56:59]
    ds_read_b64_tr_b16 v[216:217], v209 offset:40960
    v_mfma_f32_16x16x32_bf16 v[64:67], v[240:243], v[72:75], v[64:67]
    ds_read_b64_tr_b16 v[218:219], v209 offset:41984
    buffer_load_dwordx4 v[72:75], v3, s[12:15], s52 offen offset:0
    s_waitcnt vmcnt(15)
    v_mfma_f32_16x16x32_bf16 v[44:47], v[228:231], v[76:79], v[44:47]
    ds_read_b64_tr_b16 v[220:221], v210 offset:40960
    v_mfma_f32_16x16x32_bf16 v[52:55], v[232:235], v[76:79], v[52:55]
    ds_read_b64_tr_b16 v[222:223], v210 offset:41984
    v_mfma_f32_16x16x32_bf16 v[60:63], v[236:239], v[76:79], v[60:63]
    ds_read_b64_tr_b16 v[224:225], v211 offset:40960
    v_mfma_f32_16x16x32_bf16 v[68:71], v[240:243], v[76:79], v[68:71]
    ds_read_b64_tr_b16 v[226:227], v211 offset:41984
    buffer_load_dwordx4 v[76:79], v3, s[12:15], s52 offen offset:256
    s_waitcnt vmcnt(15) lgkmcnt(8)
    v_mfma_f32_16x16x32_bf16 v[40:43], v[16:19], v[80:83], v[40:43]
    ds_read_b64_tr_b16 v[228:229], v208 offset:45056
    v_mfma_f32_16x16x32_bf16 v[48:51], v[20:23], v[80:83], v[48:51]
    ds_read_b64_tr_b16 v[230:231], v208 offset:46080
    v_mfma_f32_16x16x32_bf16 v[56:59], v[24:27], v[80:83], v[56:59]
    ds_read_b64_tr_b16 v[232:233], v209 offset:45056
    v_mfma_f32_16x16x32_bf16 v[64:67], v[28:31], v[80:83], v[64:67]
    ds_read_b64_tr_b16 v[234:235], v209 offset:46080
    buffer_load_dwordx4 v[80:83], v3, s[12:15], s52 offen offset:2048
    s_waitcnt vmcnt(15)
    v_mfma_f32_16x16x32_bf16 v[44:47], v[16:19], v[84:87], v[44:47]
    ds_read_b64_tr_b16 v[236:237], v210 offset:45056
    v_mfma_f32_16x16x32_bf16 v[52:55], v[20:23], v[84:87], v[52:55]
    ds_read_b64_tr_b16 v[238:239], v210 offset:46080
    v_mfma_f32_16x16x32_bf16 v[60:63], v[24:27], v[84:87], v[60:63]
    ds_read_b64_tr_b16 v[240:241], v211 offset:45056
    v_mfma_f32_16x16x32_bf16 v[68:71], v[28:31], v[84:87], v[68:71]
    ds_read_b64_tr_b16 v[242:243], v211 offset:46080
    buffer_load_dwordx4 v[84:87], v3, s[12:15], s52 offen offset:2304
    s_waitcnt vmcnt(15) lgkmcnt(8)
    v_mfma_f32_16x16x32_bf16 v[40:43], v[212:215], v[88:91], v[40:43]
    ds_read_b64_tr_b16 v[16:17], v200 offset:0
    v_mfma_f32_16x16x32_bf16 v[48:51], v[216:219], v[88:91], v[48:51]
    ds_read_b64_tr_b16 v[18:19], v200 offset:1024
    v_mfma_f32_16x16x32_bf16 v[56:59], v[220:223], v[88:91], v[56:59]
    ds_read_b64_tr_b16 v[20:21], v201 offset:0
    v_mfma_f32_16x16x32_bf16 v[64:67], v[224:227], v[88:91], v[64:67]
    ds_read_b64_tr_b16 v[22:23], v201 offset:1024
    s_add_u32 s52, s52, 4096
    buffer_load_dwordx4 v[88:91], v3, s[12:15], s52 offen offset:0
    s_waitcnt vmcnt(15)
    v_mfma_f32_16x16x32_bf16 v[44:47], v[212:215], v[92:95], v[44:47]
    ds_read_b64_tr_b16 v[24:25], v202 offset:0
    v_mfma_f32_16x16x32_bf16 v[52:55], v[216:219], v[92:95], v[52:55]
    ds_read_b64_tr_b16 v[26:27], v202 offset:1024
    v_mfma_f32_16x16x32_bf16 v[60:63], v[220:223], v[92:95], v[60:63]
    ds_read_b64_tr_b16 v[28:29], v203 offset:0
    v_mfma_f32_16x16x32_bf16 v[68:71], v[224:227], v[92:95], v[68:71]
    ds_read_b64_tr_b16 v[30:31], v203 offset:1024
    buffer_load_dwordx4 v[92:95], v3, s[12:15], s52 offen offset:256
    s_waitcnt vmcnt(15) lgkmcnt(8)
    v_mfma_f32_16x16x32_bf16 v[40:43], v[228:231], v[96:99], v[40:43]
    ds_read_b64_tr_b16 v[212:213], v200 offset:4096
    v_mfma_f32_16x16x32_bf16 v[48:51], v[232:235], v[96:99], v[48:51]
    ds_read_b64_tr_b16 v[214:215], v200 offset:5120
    v_mfma_f32_16x16x32_bf16 v[56:59], v[236:239], v[96:99], v[56:59]
    ds_read_b64_tr_b16 v[216:217], v201 offset:4096
    v_mfma_f32_16x16x32_bf16 v[64:67], v[240:243], v[96:99], v[64:67]
    ds_read_b64_tr_b16 v[218:219], v201 offset:5120
    buffer_load_dwordx4 v[96:99], v3, s[12:15], s52 offen offset:2048
    s_waitcnt vmcnt(15)
    v_mfma_f32_16x16x32_bf16 v[44:47], v[228:231], v[100:103], v[44:47]
    ds_read_b64_tr_b16 v[220:221], v202 offset:4096
    v_mfma_f32_16x16x32_bf16 v[52:55], v[232:235], v[100:103], v[52:55]
    ds_read_b64_tr_b16 v[222:223], v202 offset:5120
    v_mfma_f32_16x16x32_bf16 v[60:63], v[236:239], v[100:103], v[60:63]
    ds_read_b64_tr_b16 v[224:225], v203 offset:4096
    v_mfma_f32_16x16x32_bf16 v[68:71], v[240:243], v[100:103], v[68:71]
    ds_read_b64_tr_b16 v[226:227], v203 offset:5120
    buffer_load_dwordx4 v[100:103], v3, s[12:15], s52 offen offset:2304
    s_waitcnt vmcnt(15) lgkmcnt(8)
    v_mfma_f32_16x16x32_bf16 v[40:43], v[16:19], v[104:107], v[40:43]
    ds_read_b64_tr_b16 v[228:229], v200 offset:8192
    v_mfma_f32_16x16x32_bf16 v[48:51], v[20:23], v[104:107], v[48:51]
    ds_read_b64_tr_b16 v[230:231], v200 offset:9216
    v_mfma_f32_16x16x32_bf16 v[56:59], v[24:27], v[104:107], v[56:59]
    ds_read_b64_tr_b16 v[232:233], v201 offset:8192
    v_mfma_f32_16x16x32_bf16 v[64:67], v[28:31], v[104:107], v[64:67]
    ds_read_b64_tr_b16 v[234:235], v201 offset:9216
    buffer_load_dwordx4 v[104:107], v3, s[12:15], s53 offen offset:0
    s_waitcnt vmcnt(15)
    v_mfma_f32_16x16x32_bf16 v[44:47], v[16:19], v[108:111], v[44:47]
    ds_read_b64_tr_b16 v[236:237], v202 offset:8192
    v_mfma_f32_16x16x32_bf16 v[52:55], v[20:23], v[108:111], v[52:55]
    ds_read_b64_tr_b16 v[238:239], v202 offset:9216
    v_mfma_f32_16x16x32_bf16 v[60:63], v[24:27], v[108:111], v[60:63]
    ds_read_b64_tr_b16 v[240:241], v203 offset:8192
    v_mfma_f32_16x16x32_bf16 v[68:71], v[28:31], v[108:111], v[68:71]
    ds_read_b64_tr_b16 v[242:243], v203 offset:9216
    buffer_load_dwordx4 v[108:111], v3, s[12:15], s53 offen offset:256
    s_waitcnt vmcnt(15) lgkmcnt(8)
    v_mfma_f32_16x16x32_bf16 v[40:43], v[212:215], v[112:115], v[40:43]
    ds_read_b64_tr_b16 v[16:17], v200 offset:12288
    v_mfma_f32_16x16x32_bf16 v[48:51], v[216:219], v[112:115], v[48:51]
    ds_read_b64_tr_b16 v[18:19], v200 offset:13312
    v_mfma_f32_16x16x32_bf16 v[56:59], v[220:223], v[112:115], v[56:59]
    ds_read_b64_tr_b16 v[20:21], v201 offset:12288
    v_mfma_f32_16x16x32_bf16 v[64:67], v[224:227], v[112:115], v[64:67]
    ds_read_b64_tr_b16 v[22:23], v201 offset:13312
    buffer_load_dwordx4 v[112:115], v3, s[12:15], s53 offen offset:2048
    s_waitcnt vmcnt(15)
    v_mfma_f32_16x16x32_bf16 v[44:47], v[212:215], v[116:119], v[44:47]
    ds_read_b64_tr_b16 v[24:25], v202 offset:12288
    v_mfma_f32_16x16x32_bf16 v[52:55], v[216:219], v[116:119], v[52:55]
    ds_read_b64_tr_b16 v[26:27], v202 offset:13312
    v_mfma_f32_16x16x32_bf16 v[60:63], v[220:223], v[116:119], v[60:63]
    ds_read_b64_tr_b16 v[28:29], v203 offset:12288
    v_mfma_f32_16x16x32_bf16 v[68:71], v[224:227], v[116:119], v[68:71]
    ds_read_b64_tr_b16 v[30:31], v203 offset:13312
    buffer_load_dwordx4 v[116:119], v3, s[12:15], s53 offen offset:2304
    s_waitcnt vmcnt(15) lgkmcnt(8)
    v_mfma_f32_16x16x32_bf16 v[40:43], v[228:231], v[120:123], v[40:43]
    ds_read_b64_tr_b16 v[212:213], v200 offset:16384
    v_mfma_f32_16x16x32_bf16 v[48:51], v[232:235], v[120:123], v[48:51]
    ds_read_b64_tr_b16 v[214:215], v200 offset:17408
    v_mfma_f32_16x16x32_bf16 v[56:59], v[236:239], v[120:123], v[56:59]
    ds_read_b64_tr_b16 v[216:217], v201 offset:16384
    v_mfma_f32_16x16x32_bf16 v[64:67], v[240:243], v[120:123], v[64:67]
    ds_read_b64_tr_b16 v[218:219], v201 offset:17408
    s_add_u32 s53, s53, 4096
    buffer_load_dwordx4 v[120:123], v3, s[12:15], s53 offen offset:0
    s_waitcnt vmcnt(15)
    v_mfma_f32_16x16x32_bf16 v[44:47], v[228:231], v[124:127], v[44:47]
    ds_read_b64_tr_b16 v[220:221], v202 offset:16384
    v_mfma_f32_16x16x32_bf16 v[52:55], v[232:235], v[124:127], v[52:55]
    ds_read_b64_tr_b16 v[222:223], v202 offset:17408
    v_mfma_f32_16x16x32_bf16 v[60:63], v[236:239], v[124:127], v[60:63]
    ds_read_b64_tr_b16 v[224:225], v203 offset:16384
    v_mfma_f32_16x16x32_bf16 v[68:71], v[240:243], v[124:127], v[68:71]
    ds_read_b64_tr_b16 v[226:227], v203 offset:17408
    buffer_load_dwordx4 v[124:127], v3, s[12:15], s53 offen offset:256
    s_waitcnt vmcnt(15) lgkmcnt(8)
    v_mfma_f32_16x16x32_bf16 v[40:43], v[16:19], v[128:131], v[40:43]
    ds_read_b64_tr_b16 v[228:229], v200 offset:20480
    v_mfma_f32_16x16x32_bf16 v[48:51], v[20:23], v[128:131], v[48:51]
    ds_read_b64_tr_b16 v[230:231], v200 offset:21504
    v_mfma_f32_16x16x32_bf16 v[56:59], v[24:27], v[128:131], v[56:59]
    ds_read_b64_tr_b16 v[232:233], v201 offset:20480
    v_mfma_f32_16x16x32_bf16 v[64:67], v[28:31], v[128:131], v[64:67]
    ds_read_b64_tr_b16 v[234:235], v201 offset:21504
    buffer_load_dwordx4 v[128:131], v3, s[12:15], s53 offen offset:2048
    s_waitcnt vmcnt(15)
    v_mfma_f32_16x16x32_bf16 v[44:47], v[16:19], v[132:135], v[44:47]
    ds_read_b64_tr_b16 v[236:237], v202 offset:20480
    v_mfma_f32_16x16x32_bf16 v[52:55], v[20:23], v[132:135], v[52:55]
    ds_read_b64_tr_b16 v[238:239], v202 offset:21504
    v_mfma_f32_16x16x32_bf16 v[60:63], v[24:27], v[132:135], v[60:63]
    ds_read_b64_tr_b16 v[240:241], v203 offset:20480
    v_mfma_f32_16x16x32_bf16 v[68:71], v[28:31], v[132:135], v[68:71]
    ds_read_b64_tr_b16 v[242:243], v203 offset:21504
    buffer_load_dwordx4 v[132:135], v3, s[12:15], s53 offen offset:2304
    s_waitcnt vmcnt(15) lgkmcnt(8)
    v_mfma_f32_16x16x32_bf16 v[40:43], v[212:215], v[72:75], v[40:43]
    ds_read_b64_tr_b16 v[16:17], v200 offset:36864
    v_mfma_f32_16x16x32_bf16 v[48:51], v[216:219], v[72:75], v[48:51]
    ds_read_b64_tr_b16 v[18:19], v200 offset:37888
    v_mfma_f32_16x16x32_bf16 v[56:59], v[220:223], v[72:75], v[56:59]
    ds_read_b64_tr_b16 v[20:21], v201 offset:36864
    v_mfma_f32_16x16x32_bf16 v[64:67], v[224:227], v[72:75], v[64:67]
    ds_read_b64_tr_b16 v[22:23], v201 offset:37888
    buffer_load_dwordx4 v[72:75], v3, s[12:15], s54 offen offset:0
    s_waitcnt vmcnt(15)
    v_mfma_f32_16x16x32_bf16 v[44:47], v[212:215], v[76:79], v[44:47]
    ds_read_b64_tr_b16 v[24:25], v202 offset:36864
    v_mfma_f32_16x16x32_bf16 v[52:55], v[216:219], v[76:79], v[52:55]
    ds_read_b64_tr_b16 v[26:27], v202 offset:37888
    v_mfma_f32_16x16x32_bf16 v[60:63], v[220:223], v[76:79], v[60:63]
    ds_read_b64_tr_b16 v[28:29], v203 offset:36864
    v_mfma_f32_16x16x32_bf16 v[68:71], v[224:227], v[76:79], v[68:71]
    ds_read_b64_tr_b16 v[30:31], v203 offset:37888
    buffer_load_dwordx4 v[76:79], v3, s[12:15], s54 offen offset:256
    s_waitcnt vmcnt(15) lgkmcnt(8)
    v_mfma_f32_16x16x32_bf16 v[40:43], v[228:231], v[80:83], v[40:43]
    ds_read_b64_tr_b16 v[212:213], v200 offset:40960
    v_mfma_f32_16x16x32_bf16 v[48:51], v[232:235], v[80:83], v[48:51]
    ds_read_b64_tr_b16 v[214:215], v200 offset:41984
    v_mfma_f32_16x16x32_bf16 v[56:59], v[236:239], v[80:83], v[56:59]
    ds_read_b64_tr_b16 v[216:217], v201 offset:40960
    v_mfma_f32_16x16x32_bf16 v[64:67], v[240:243], v[80:83], v[64:67]
    ds_read_b64_tr_b16 v[218:219], v201 offset:41984
    buffer_load_dwordx4 v[80:83], v3, s[12:15], s54 offen offset:2048
    s_waitcnt vmcnt(15)
    v_mfma_f32_16x16x32_bf16 v[44:47], v[228:231], v[84:87], v[44:47]
    ds_read_b64_tr_b16 v[220:221], v202 offset:40960
    v_mfma_f32_16x16x32_bf16 v[52:55], v[232:235], v[84:87], v[52:55]
    ds_read_b64_tr_b16 v[222:223], v202 offset:41984
    v_mfma_f32_16x16x32_bf16 v[60:63], v[236:239], v[84:87], v[60:63]
    ds_read_b64_tr_b16 v[224:225], v203 offset:40960
    v_mfma_f32_16x16x32_bf16 v[68:71], v[240:243], v[84:87], v[68:71]
    ds_read_b64_tr_b16 v[226:227], v203 offset:41984
    buffer_load_dwordx4 v[84:87], v3, s[12:15], s54 offen offset:2304
    s_waitcnt vmcnt(15) lgkmcnt(8)
    v_mfma_f32_16x16x32_bf16 v[40:43], v[16:19], v[88:91], v[40:43]
    ds_read_b64_tr_b16 v[228:229], v200 offset:45056
    v_mfma_f32_16x16x32_bf16 v[48:51], v[20:23], v[88:91], v[48:51]
    ds_read_b64_tr_b16 v[230:231], v200 offset:46080
    v_mfma_f32_16x16x32_bf16 v[56:59], v[24:27], v[88:91], v[56:59]
    ds_read_b64_tr_b16 v[232:233], v201 offset:45056
    v_mfma_f32_16x16x32_bf16 v[64:67], v[28:31], v[88:91], v[64:67]
    ds_read_b64_tr_b16 v[234:235], v201 offset:46080
    s_add_u32 s54, s54, 4096
    buffer_load_dwordx4 v[88:91], v3, s[12:15], s54 offen offset:0
    s_waitcnt vmcnt(15)
    v_mfma_f32_16x16x32_bf16 v[44:47], v[16:19], v[92:95], v[44:47]
    ds_read_b64_tr_b16 v[236:237], v202 offset:45056
    v_mfma_f32_16x16x32_bf16 v[52:55], v[20:23], v[92:95], v[52:55]
    ds_read_b64_tr_b16 v[238:239], v202 offset:46080
    v_mfma_f32_16x16x32_bf16 v[60:63], v[24:27], v[92:95], v[60:63]
    ds_read_b64_tr_b16 v[240:241], v203 offset:45056
    v_mfma_f32_16x16x32_bf16 v[68:71], v[28:31], v[92:95], v[68:71]
    ds_read_b64_tr_b16 v[242:243], v203 offset:46080
    buffer_load_dwordx4 v[92:95], v3, s[12:15], s54 offen offset:256
    s_waitcnt vmcnt(15) lgkmcnt(8)
    v_mfma_f32_16x16x32_bf16 v[40:43], v[212:215], v[96:99], v[40:43]
    ds_read_b64_tr_b16 v[16:17], v200 offset:49152
    v_mfma_f32_16x16x32_bf16 v[48:51], v[216:219], v[96:99], v[48:51]
    ds_read_b64_tr_b16 v[18:19], v200 offset:50176
    v_mfma_f32_16x16x32_bf16 v[56:59], v[220:223], v[96:99], v[56:59]
    ds_read_b64_tr_b16 v[20:21], v201 offset:49152
    v_mfma_f32_16x16x32_bf16 v[64:67], v[224:227], v[96:99], v[64:67]
    ds_read_b64_tr_b16 v[22:23], v201 offset:50176
    buffer_load_dwordx4 v[96:99], v3, s[12:15], s54 offen offset:2048
    s_waitcnt vmcnt(15)
    v_mfma_f32_16x16x32_bf16 v[44:47], v[212:215], v[100:103], v[44:47]
    ds_read_b64_tr_b16 v[24:25], v202 offset:49152
    v_mfma_f32_16x16x32_bf16 v[52:55], v[216:219], v[100:103], v[52:55]
    ds_read_b64_tr_b16 v[26:27], v202 offset:50176
    v_mfma_f32_16x16x32_bf16 v[60:63], v[220:223], v[100:103], v[60:63]
    ds_read_b64_tr_b16 v[28:29], v203 offset:49152
    v_mfma_f32_16x16x32_bf16 v[68:71], v[224:227], v[100:103], v[68:71]
    ds_read_b64_tr_b16 v[30:31], v203 offset:50176
    buffer_load_dwordx4 v[100:103], v3, s[12:15], s54 offen offset:2304
    s_waitcnt vmcnt(15) lgkmcnt(8)
    v_mfma_f32_16x16x32_bf16 v[40:43], v[228:231], v[104:107], v[40:43]
    ds_read_b64_tr_b16 v[212:213], v200 offset:53248
    v_mfma_f32_16x16x32_bf16 v[48:51], v[232:235], v[104:107], v[48:51]
    ds_read_b64_tr_b16 v[214:215], v200 offset:54272
    v_mfma_f32_16x16x32_bf16 v[56:59], v[236:239], v[104:107], v[56:59]
    ds_read_b64_tr_b16 v[216:217], v201 offset:53248
    v_mfma_f32_16x16x32_bf16 v[64:67], v[240:243], v[104:107], v[64:67]
    ds_read_b64_tr_b16 v[218:219], v201 offset:54272
    buffer_load_dwordx4 v[104:107], v3, s[12:15], s55 offen offset:0
    s_waitcnt vmcnt(15)
    v_mfma_f32_16x16x32_bf16 v[44:47], v[228:231], v[108:111], v[44:47]
    ds_read_b64_tr_b16 v[220:221], v202 offset:53248
    v_mfma_f32_16x16x32_bf16 v[52:55], v[232:235], v[108:111], v[52:55]
    ds_read_b64_tr_b16 v[222:223], v202 offset:54272
    v_mfma_f32_16x16x32_bf16 v[60:63], v[236:239], v[108:111], v[60:63]
    ds_read_b64_tr_b16 v[224:225], v203 offset:53248
    v_mfma_f32_16x16x32_bf16 v[68:71], v[240:243], v[108:111], v[68:71]
    ds_read_b64_tr_b16 v[226:227], v203 offset:54272
    buffer_load_dwordx4 v[108:111], v3, s[12:15], s55 offen offset:256
    s_waitcnt vmcnt(15) lgkmcnt(8)
    v_mfma_f32_16x16x32_bf16 v[40:43], v[16:19], v[112:115], v[40:43]
    ds_read_b64_tr_b16 v[228:229], v200 offset:57344
    v_mfma_f32_16x16x32_bf16 v[48:51], v[20:23], v[112:115], v[48:51]
    ds_read_b64_tr_b16 v[230:231], v200 offset:58368
    v_mfma_f32_16x16x32_bf16 v[56:59], v[24:27], v[112:115], v[56:59]
    ds_read_b64_tr_b16 v[232:233], v201 offset:57344
    v_mfma_f32_16x16x32_bf16 v[64:67], v[28:31], v[112:115], v[64:67]
    ds_read_b64_tr_b16 v[234:235], v201 offset:58368
    buffer_load_dwordx4 v[112:115], v3, s[12:15], s55 offen offset:2048
    s_waitcnt vmcnt(15)
    v_mfma_f32_16x16x32_bf16 v[44:47], v[16:19], v[116:119], v[44:47]
    ds_read_b64_tr_b16 v[236:237], v202 offset:57344
    v_mfma_f32_16x16x32_bf16 v[52:55], v[20:23], v[116:119], v[52:55]
    ds_read_b64_tr_b16 v[238:239], v202 offset:58368
    v_mfma_f32_16x16x32_bf16 v[60:63], v[24:27], v[116:119], v[60:63]
    ds_read_b64_tr_b16 v[240:241], v203 offset:57344
    v_mfma_f32_16x16x32_bf16 v[68:71], v[28:31], v[116:119], v[68:71]
    ds_read_b64_tr_b16 v[242:243], v203 offset:58368
    buffer_load_dwordx4 v[116:119], v3, s[12:15], s55 offen offset:2304
    s_waitcnt vmcnt(15) lgkmcnt(8)
    v_mfma_f32_16x16x32_bf16 v[40:43], v[212:215], v[120:123], v[40:43]
    ds_read_b64_tr_b16 v[16:17], v200 offset:61440
    v_mfma_f32_16x16x32_bf16 v[48:51], v[216:219], v[120:123], v[48:51]
    ds_read_b64_tr_b16 v[18:19], v200 offset:62464
    v_mfma_f32_16x16x32_bf16 v[56:59], v[220:223], v[120:123], v[56:59]
    ds_read_b64_tr_b16 v[20:21], v201 offset:61440
    v_mfma_f32_16x16x32_bf16 v[64:67], v[224:227], v[120:123], v[64:67]
    ds_read_b64_tr_b16 v[22:23], v201 offset:62464
    s_add_u32 s55, s55, 4096
    buffer_load_dwordx4 v[120:123], v3, s[12:15], s55 offen offset:0
    s_waitcnt vmcnt(15)
    v_mfma_f32_16x16x32_bf16 v[44:47], v[212:215], v[124:127], v[44:47]
    ds_read_b64_tr_b16 v[24:25], v202 offset:61440
    v_mfma_f32_16x16x32_bf16 v[52:55], v[216:219], v[124:127], v[52:55]
    ds_read_b64_tr_b16 v[26:27], v202 offset:62464
    v_mfma_f32_16x16x32_bf16 v[60:63], v[220:223], v[124:127], v[60:63]
    ds_read_b64_tr_b16 v[28:29], v203 offset:61440
    v_mfma_f32_16x16x32_bf16 v[68:71], v[224:227], v[124:127], v[68:71]
    ds_read_b64_tr_b16 v[30:31], v203 offset:62464
    buffer_load_dwordx4 v[124:127], v3, s[12:15], s55 offen offset:256
    s_waitcnt vmcnt(15) lgkmcnt(8)
    v_mfma_f32_16x16x32_bf16 v[40:43], v[228:231], v[128:131], v[40:43]
    s_lshl_b32 s80, s32, 2
    v_add_u32 v196, s80, v251
    v_mov_b32 v197, 1
    ds_write_b32 v196, v197 offset:96
    ds_read_b64_tr_b16 v[212:213], v204 offset:0
    v_mfma_f32_16x16x32_bf16 v[48:51], v[232:235], v[128:131], v[48:51]
    ds_read_b64_tr_b16 v[214:215], v204 offset:1024
    v_mfma_f32_16x16x32_bf16 v[56:59], v[236:239], v[128:131], v[56:59]
    ds_read_b64_tr_b16 v[216:217], v205 offset:0
    v_mfma_f32_16x16x32_bf16 v[64:67], v[240:243], v[128:131], v[64:67]
    ds_read_b64_tr_b16 v[218:219], v205 offset:1024
    buffer_load_dwordx4 v[128:131], v3, s[12:15], s55 offen offset:2048
    s_waitcnt vmcnt(15)
    v_mfma_f32_16x16x32_bf16 v[44:47], v[228:231], v[132:135], v[44:47]
    ds_read_b64_tr_b16 v[220:221], v206 offset:0
    v_mfma_f32_16x16x32_bf16 v[52:55], v[232:235], v[132:135], v[52:55]
    ds_read_b64_tr_b16 v[222:223], v206 offset:1024
    v_mfma_f32_16x16x32_bf16 v[60:63], v[236:239], v[132:135], v[60:63]
    ds_read_b64_tr_b16 v[224:225], v207 offset:0
    v_mfma_f32_16x16x32_bf16 v[68:71], v[240:243], v[132:135], v[68:71]
    ds_read_b64_tr_b16 v[226:227], v207 offset:1024
    buffer_load_dwordx4 v[132:135], v3, s[12:15], s55 offen offset:2304
    s_waitcnt vmcnt(15) lgkmcnt(8)
    v_mfma_f32_16x16x32_bf16 v[40:43], v[16:19], v[72:75], v[40:43]
    ds_read_b64_tr_b16 v[228:229], v204 offset:4096
    v_mfma_f32_16x16x32_bf16 v[48:51], v[20:23], v[72:75], v[48:51]
    ds_read_b64_tr_b16 v[230:231], v204 offset:5120
    v_mfma_f32_16x16x32_bf16 v[56:59], v[24:27], v[72:75], v[56:59]
    ds_read_b64_tr_b16 v[232:233], v205 offset:4096
    v_mfma_f32_16x16x32_bf16 v[64:67], v[28:31], v[72:75], v[64:67]
    ds_read_b64_tr_b16 v[234:235], v205 offset:5120
    s_waitcnt vmcnt(14)
    v_mfma_f32_16x16x32_bf16 v[44:47], v[16:19], v[76:79], v[44:47]
    ds_read_b64_tr_b16 v[236:237], v206 offset:4096
    v_mfma_f32_16x16x32_bf16 v[52:55], v[20:23], v[76:79], v[52:55]
    ds_read_b64_tr_b16 v[238:239], v206 offset:5120
    v_mfma_f32_16x16x32_bf16 v[60:63], v[24:27], v[76:79], v[60:63]
    ds_read_b64_tr_b16 v[240:241], v207 offset:4096
    v_mfma_f32_16x16x32_bf16 v[68:71], v[28:31], v[76:79], v[68:71]
    ds_read_b64_tr_b16 v[242:243], v207 offset:5120
    s_waitcnt vmcnt(13) lgkmcnt(8)
    v_mfma_f32_16x16x32_bf16 v[40:43], v[212:215], v[80:83], v[40:43]
    ds_read_b64_tr_b16 v[16:17], v204 offset:20480
    v_mfma_f32_16x16x32_bf16 v[48:51], v[216:219], v[80:83], v[48:51]
    ds_read_b64_tr_b16 v[18:19], v204 offset:21504
    v_mfma_f32_16x16x32_bf16 v[56:59], v[220:223], v[80:83], v[56:59]
    ds_read_b64_tr_b16 v[20:21], v205 offset:20480
    v_mfma_f32_16x16x32_bf16 v[64:67], v[224:227], v[80:83], v[64:67]
    ds_read_b64_tr_b16 v[22:23], v205 offset:21504
    s_waitcnt vmcnt(12)
    v_mfma_f32_16x16x32_bf16 v[44:47], v[212:215], v[84:87], v[44:47]
    ds_read_b64_tr_b16 v[24:25], v206 offset:20480
    v_mfma_f32_16x16x32_bf16 v[52:55], v[216:219], v[84:87], v[52:55]
    ds_read_b64_tr_b16 v[26:27], v206 offset:21504
    v_mfma_f32_16x16x32_bf16 v[60:63], v[220:223], v[84:87], v[60:63]
    ds_read_b64_tr_b16 v[28:29], v207 offset:20480
    v_mfma_f32_16x16x32_bf16 v[68:71], v[224:227], v[84:87], v[68:71]
    ds_read_b64_tr_b16 v[30:31], v207 offset:21504
    s_waitcnt vmcnt(11) lgkmcnt(8)
    v_mfma_f32_16x16x32_bf16 v[40:43], v[228:231], v[88:91], v[40:43]
    ds_read_b64_tr_b16 v[212:213], v204 offset:24576
    v_mfma_f32_16x16x32_bf16 v[48:51], v[232:235], v[88:91], v[48:51]
    ds_read_b64_tr_b16 v[214:215], v204 offset:25600
    v_mfma_f32_16x16x32_bf16 v[56:59], v[236:239], v[88:91], v[56:59]
    ds_read_b64_tr_b16 v[216:217], v205 offset:24576
    v_mfma_f32_16x16x32_bf16 v[64:67], v[240:243], v[88:91], v[64:67]
    ds_read_b64_tr_b16 v[218:219], v205 offset:25600
    s_waitcnt vmcnt(10)
    v_mfma_f32_16x16x32_bf16 v[44:47], v[228:231], v[92:95], v[44:47]
    ds_read_b64_tr_b16 v[220:221], v206 offset:24576
    v_mfma_f32_16x16x32_bf16 v[52:55], v[232:235], v[92:95], v[52:55]
    ds_read_b64_tr_b16 v[222:223], v206 offset:25600
    v_mfma_f32_16x16x32_bf16 v[60:63], v[236:239], v[92:95], v[60:63]
    ds_read_b64_tr_b16 v[224:225], v207 offset:24576
    v_mfma_f32_16x16x32_bf16 v[68:71], v[240:243], v[92:95], v[68:71]
    ds_read_b64_tr_b16 v[226:227], v207 offset:25600
    s_waitcnt vmcnt(9) lgkmcnt(8)
    v_mfma_f32_16x16x32_bf16 v[40:43], v[16:19], v[96:99], v[40:43]
    ds_read_b64_tr_b16 v[228:229], v204 offset:28672
    v_mfma_f32_16x16x32_bf16 v[48:51], v[20:23], v[96:99], v[48:51]
    ds_read_b64_tr_b16 v[230:231], v204 offset:29696
    v_mfma_f32_16x16x32_bf16 v[56:59], v[24:27], v[96:99], v[56:59]
    ds_read_b64_tr_b16 v[232:233], v205 offset:28672
    v_mfma_f32_16x16x32_bf16 v[64:67], v[28:31], v[96:99], v[64:67]
    ds_read_b64_tr_b16 v[234:235], v205 offset:29696
    s_waitcnt vmcnt(8)
    v_mfma_f32_16x16x32_bf16 v[44:47], v[16:19], v[100:103], v[44:47]
    ds_read_b64_tr_b16 v[236:237], v206 offset:28672
    v_mfma_f32_16x16x32_bf16 v[52:55], v[20:23], v[100:103], v[52:55]
    ds_read_b64_tr_b16 v[238:239], v206 offset:29696
    v_mfma_f32_16x16x32_bf16 v[60:63], v[24:27], v[100:103], v[60:63]
    ds_read_b64_tr_b16 v[240:241], v207 offset:28672
    v_mfma_f32_16x16x32_bf16 v[68:71], v[28:31], v[100:103], v[68:71]
    ds_read_b64_tr_b16 v[242:243], v207 offset:29696
    s_waitcnt vmcnt(7) lgkmcnt(8)
    v_mfma_f32_16x16x32_bf16 v[40:43], v[212:215], v[104:107], v[40:43]
    ds_read_b64_tr_b16 v[16:17], v204 offset:32768
    v_mfma_f32_16x16x32_bf16 v[48:51], v[216:219], v[104:107], v[48:51]
    ds_read_b64_tr_b16 v[18:19], v204 offset:33792
    v_mfma_f32_16x16x32_bf16 v[56:59], v[220:223], v[104:107], v[56:59]
    ds_read_b64_tr_b16 v[20:21], v205 offset:32768
    v_mfma_f32_16x16x32_bf16 v[64:67], v[224:227], v[104:107], v[64:67]
    ds_read_b64_tr_b16 v[22:23], v205 offset:33792
    s_waitcnt vmcnt(6)
    v_mfma_f32_16x16x32_bf16 v[44:47], v[212:215], v[108:111], v[44:47]
    ds_read_b64_tr_b16 v[24:25], v206 offset:32768
    v_mfma_f32_16x16x32_bf16 v[52:55], v[216:219], v[108:111], v[52:55]
    ds_read_b64_tr_b16 v[26:27], v206 offset:33792
    v_mfma_f32_16x16x32_bf16 v[60:63], v[220:223], v[108:111], v[60:63]
    ds_read_b64_tr_b16 v[28:29], v207 offset:32768
    v_mfma_f32_16x16x32_bf16 v[68:71], v[224:227], v[108:111], v[68:71]
    ds_read_b64_tr_b16 v[30:31], v207 offset:33792
    s_waitcnt vmcnt(5) lgkmcnt(8)
    v_mfma_f32_16x16x32_bf16 v[40:43], v[228:231], v[112:115], v[40:43]
    ds_read_b64_tr_b16 v[212:213], v204 offset:36864
    v_mfma_f32_16x16x32_bf16 v[48:51], v[232:235], v[112:115], v[48:51]
    ds_read_b64_tr_b16 v[214:215], v204 offset:37888
    v_mfma_f32_16x16x32_bf16 v[56:59], v[236:239], v[112:115], v[56:59]
    ds_read_b64_tr_b16 v[216:217], v205 offset:36864
    v_mfma_f32_16x16x32_bf16 v[64:67], v[240:243], v[112:115], v[64:67]
    ds_read_b64_tr_b16 v[218:219], v205 offset:37888
    s_waitcnt vmcnt(4)
    v_mfma_f32_16x16x32_bf16 v[44:47], v[228:231], v[116:119], v[44:47]
    ds_read_b64_tr_b16 v[220:221], v206 offset:36864
    v_mfma_f32_16x16x32_bf16 v[52:55], v[232:235], v[116:119], v[52:55]
    ds_read_b64_tr_b16 v[222:223], v206 offset:37888
    v_mfma_f32_16x16x32_bf16 v[60:63], v[236:239], v[116:119], v[60:63]
    ds_read_b64_tr_b16 v[224:225], v207 offset:36864
    v_mfma_f32_16x16x32_bf16 v[68:71], v[240:243], v[116:119], v[68:71]
    ds_read_b64_tr_b16 v[226:227], v207 offset:37888
    s_waitcnt vmcnt(3) lgkmcnt(8)
    v_mfma_f32_16x16x32_bf16 v[40:43], v[16:19], v[120:123], v[40:43]
    v_mfma_f32_16x16x32_bf16 v[48:51], v[20:23], v[120:123], v[48:51]
    v_mfma_f32_16x16x32_bf16 v[56:59], v[24:27], v[120:123], v[56:59]
    v_mfma_f32_16x16x32_bf16 v[64:67], v[28:31], v[120:123], v[64:67]
    s_waitcnt vmcnt(2)
    v_mfma_f32_16x16x32_bf16 v[44:47], v[16:19], v[124:127], v[44:47]
    v_mfma_f32_16x16x32_bf16 v[52:55], v[20:23], v[124:127], v[52:55]
    v_mfma_f32_16x16x32_bf16 v[60:63], v[24:27], v[124:127], v[60:63]
    v_mfma_f32_16x16x32_bf16 v[68:71], v[28:31], v[124:127], v[68:71]
    s_waitcnt vmcnt(1) lgkmcnt(0)
    v_mfma_f32_16x16x32_bf16 v[40:43], v[212:215], v[128:131], v[40:43]
    v_mfma_f32_16x16x32_bf16 v[48:51], v[216:219], v[128:131], v[48:51]
    v_mfma_f32_16x16x32_bf16 v[56:59], v[220:223], v[128:131], v[56:59]
    v_mfma_f32_16x16x32_bf16 v[64:67], v[224:227], v[128:131], v[64:67]
    s_waitcnt vmcnt(0)
    v_mfma_f32_16x16x32_bf16 v[44:47], v[212:215], v[132:135], v[44:47]
    v_mfma_f32_16x16x32_bf16 v[52:55], v[216:219], v[132:135], v[52:55]
    v_mfma_f32_16x16x32_bf16 v[60:63], v[220:223], v[132:135], v[60:63]
    v_mfma_f32_16x16x32_bf16 v[68:71], v[224:227], v[132:135], v[68:71]
    v_xor_b32 v8, 0, v193
    v_xor_b32 v9, 32, v193
    v_xor_b32 v10, 64, v193
    v_xor_b32 v11, 96, v193
    s_nop 3
    v_cvt_pk_bf16_f32 v40, v40, v41
    v_cvt_pk_bf16_f32 v41, v42, v43
    ds_write_b64 v8, v[40:41] offset:0
    v_cvt_pk_bf16_f32 v48, v48, v49
    v_cvt_pk_bf16_f32 v49, v50, v51
    ds_write_b64 v9, v[48:49] offset:0
    v_cvt_pk_bf16_f32 v56, v56, v57
    v_cvt_pk_bf16_f32 v57, v58, v59
    ds_write_b64 v10, v[56:57] offset:0
    v_cvt_pk_bf16_f32 v64, v64, v65
    v_cvt_pk_bf16_f32 v65, v66, v67
    ds_write_b64 v11, v[64:65] offset:0
    ds_read_b128 v[72:75], v194 offset:0
    ds_read_b128 v[76:79], v194 offset:1024
    v_cvt_pk_bf16_f32 v44, v44, v45
    v_cvt_pk_bf16_f32 v45, v46, v47
    ds_write_b64 v8, v[44:45] offset:2048
    v_cvt_pk_bf16_f32 v52, v52, v53
    v_cvt_pk_bf16_f32 v53, v54, v55
    ds_write_b64 v9, v[52:53] offset:2048
    v_cvt_pk_bf16_f32 v60, v60, v61
    v_cvt_pk_bf16_f32 v61, v62, v63
    ds_write_b64 v10, v[60:61] offset:2048
    v_cvt_pk_bf16_f32 v68, v68, v69
    v_cvt_pk_bf16_f32 v69, v70, v71
    ds_write_b64 v11, v[68:69] offset:2048
    ds_read_b128 v[80:83], v194 offset:2048
    ds_read_b128 v[84:87], v194 offset:3072
    s_waitcnt lgkmcnt(7)
    buffer_store_dwordx4 v[72:75], v192, s[68:71], s56 offen sc1
    s_add_u32 s56, s56, 32768
    s_waitcnt lgkmcnt(6)
    buffer_store_dwordx4 v[76:79], v192, s[68:71], s56 offen sc1
    s_add_u32 s56, s56, 32768
    s_waitcnt lgkmcnt(1)
    buffer_store_dwordx4 v[80:83], v192, s[68:71], s56 offen sc1
    s_add_u32 s56, s56, 32768
    s_waitcnt lgkmcnt(0)
    buffer_store_dwordx4 v[84:87], v192, s[68:71], s56 offen sc1
    s_add_u32 s56, s56, 32768
    s_endpgm
L_mneg_9:
    v_cndmask_b32 v24, v244, v8, s[4:5]
    v_cndmask_b32 v25, v244, v9, s[6:7]
    v_cndmask_b32 v26, v244, v10, s[8:9]
    v_cndmask_b32 v27, v244, v11, s[10:11]
    v_cndmask_b32 v28, v244, v12, s[16:17]
    v_cndmask_b32 v29, v244, v13, s[18:19]
    v_cndmask_b32 v30, v244, v14, s[20:21]
    v_cndmask_b32 v31, v244, v15, s[22:23]
    v_cndmask_b32 v32, v244, v16, s[24:25]
    v_cndmask_b32 v33, v244, v17, s[26:27]
    v_cndmask_b32 v34, v244, v18, s[48:49]
    v_cndmask_b32 v35, v244, v19, s[50:51]
    v_cndmask_b32 v36, v244, v20, s[52:53]
    v_cndmask_b32 v37, v244, v21, s[54:55]
    v_cndmask_b32 v38, v244, v22, s[56:57]
    v_cndmask_b32 v39, v244, v23, s[58:59]
    s_branch L_mback_10
L_aexit_11:
    v_mfma_f32_32x32x16_bf16 v[96:111], v[80:83], v[32:35], 0
    v_mfma_f32_16x16x32_bf16 v[128:131], v[240:243], v[24:27], 0
    v_mfma_f32_32x32x16_bf16 v[96:111], v[84:87], v[36:39], v[96:111]
    v_mfma_f32_16x16x32_bf16 v[128:131], v[240:243], v[28:31], v[128:131]
    v_mfma_f32_32x32x16_bf16 v[96:111], v[88:91], v[144:147], v[96:111]
    v_mfma_f32_32x32x16_bf16 v[96:111], v[92:95], v[148:151], v[96:111]
    s_waitcnt vmcnt(0)
    s_add_u32 s80, s89, 0x1810000
    v_mov_b32 v194, s78
    v_mov_b32 v195, s79
    s_mov_b64 exec, 1
    buffer_store_dwordx2 v[194:195], v252, s[12:15], s80 offen sc1
    s_mov_b64 exec, -1
    s_add_u32 m0, s84, 106496
    s_add_u32 s81, s43, 0
    s_and_b32 s81, s81, 7
    s_lshl_b32 s81, s81, 18
    s_add_u32 s81, s81, s88
    buffer_load_dwordx4 v250, s[60:63], s81 offen lds
    s_add_u32 s81, s81, 15360
    buffer_load_dwordx4 v250, s[60:63], s81 offen offset:1024 lds
    s_add_u32 m0, s84, 122880
    s_add_u32 s81, s43, 1
    s_and_b32 s81, s81, 7
    s_lshl_b32 s81, s81, 18
    s_add_u32 s81, s81, s88
    buffer_load_dwordx4 v250, s[60:63], s81 offen lds
    s_add_u32 s81, s81, 15360
    buffer_load_dwordx4 v250, s[60:63], s81 offen offset:1024 lds
    s_add_u32 m0, s84, 139264
    s_add_u32 s81, s43, 2
    s_and_b32 s81, s81, 7
    s_lshl_b32 s81, s81, 18
    s_add_u32 s81, s81, s88
    buffer_load_dwordx4 v250, s[60:63], s81 offen lds
    s_add_u32 s81, s81, 15360
    buffer_load_dwordx4 v250, s[60:63], s81 offen offset:1024 lds
    s_lshl_b32 s80, s32, 2
    v_add_u32 v158, s80, v251
    v_mov_b32 v159, 1
    ds_write_b32 v158, v159 offset:64
    s_mov_b32 s80, 0
    buffer_load_dwordx2 v[112:113], v217, s[64:67], s80 offen offset:0
    buffer_load_dwordx2 v[114:115], v217, s[64:67], s80 offen offset:2048
    s_mov_b32 s80, 4096
    buffer_load_dwordx2 v[116:117], v217, s[64:67], s80 offen offset:0
    buffer_load_dwordx2 v[118:119], v217, s[64:67], s80 offen offset:2048
    s_mov_b32 s80, 8192
    buffer_load_dwordx2 v[120:121], v217, s[64:67], s80 offen offset:0
    buffer_load_dwordx2 v[122:123], v217, s[64:67], s80 offen offset:2048
    s_mov_b32 s80, 12288
    buffer_load_dwordx2 v[124:125], v217, s[64:67], s80 offen offset:0
    buffer_load_dwordx2 v[126:127], v217, s[64:67], s80 offen offset:2048
    buffer_load_dwordx2 v[196:197], v219, s[12:15], 0 offen sc1
    s_branch L_afin_8
L_aexit_12:
    v_mfma_f32_32x32x16_bf16 v[96:111], v[160:163], v[40:43], v[96:111]
    v_mfma_f32_16x16x32_bf16 v[128:131], v[240:243], v[40:43], v[128:131]
    v_mfma_f32_32x32x16_bf16 v[96:111], v[164:167], v[44:47], v[96:111]
    v_mfma_f32_16x16x32_bf16 v[128:131], v[240:243], v[44:47], v[128:131]
    s_waitcnt vmcnt(0)
    s_add_u32 s80, s89, 0x1810000
    v_mov_b32 v194, s78
    v_mov_b32 v195, s79
    s_mov_b64 exec, 1
    buffer_store_dwordx2 v[194:195], v252, s[12:15], s80 offen sc1
    s_mov_b64 exec, -1
    s_add_u32 m0, s84, 106496
    s_add_u32 s81, s43, 0
    s_and_b32 s81, s81, 7
    s_lshl_b32 s81, s81, 18
    s_add_u32 s81, s81, s88
    buffer_load_dwordx4 v250, s[60:63], s81 offen lds
    s_add_u32 s81, s81, 15360
    buffer_load_dwordx4 v250, s[60:63], s81 offen offset:1024 lds
    s_add_u32 m0, s84, 122880
    s_add_u32 s81, s43, 1
    s_and_b32 s81, s81, 7
    s_lshl_b32 s81, s81, 18
    s_add_u32 s81, s81, s88
    buffer_load_dwordx4 v250, s[60:63], s81 offen lds
    s_add_u32 s81, s81, 15360
    buffer_load_dwordx4 v250, s[60:63], s81 offen offset:1024 lds
    s_add_u32 m0, s84, 139264
    s_add_u32 s81, s43, 2
    s_and_b32 s81, s81, 7
    s_lshl_b32 s81, s81, 18
    s_add_u32 s81, s81, s88
    buffer_load_dwordx4 v250, s[60:63], s81 offen lds
    s_add_u32 s81, s81, 15360
    buffer_load_dwordx4 v250, s[60:63], s81 offen offset:1024 lds
    s_lshl_b32 s80, s32, 2
    v_add_u32 v158, s80, v251
    v_mov_b32 v159, 1
    ds_write_b32 v158, v159 offset:64
    s_mov_b32 s80, 0
    buffer_load_dwordx2 v[112:113], v217, s[64:67], s80 offen offset:0
    buffer_load_dwordx2 v[114:115], v217, s[64:67], s80 offen offset:2048
    s_mov_b32 s80, 4096
    buffer_load_dwordx2 v[116:117], v217, s[64:67], s80 offen offset:0
    buffer_load_dwordx2 v[118:119], v217, s[64:67], s80 offen offset:2048
    s_mov_b32 s80, 8192
    buffer_load_dwordx2 v[120:121], v217, s[64:67], s80 offen offset:0
    buffer_load_dwordx2 v[122:123], v217, s[64:67], s80 offen offset:2048
    s_mov_b32 s80, 12288
    buffer_load_dwordx2 v[124:125], v217, s[64:67], s80 offen offset:0
    buffer_load_dwordx2 v[126:127], v217, s[64:67], s80 offen offset:2048
    buffer_load_dwordx2 v[196:197], v219, s[12:15], 0 offen sc1
    s_branch L_afin_8
L_aexit_13:
    v_mfma_f32_32x32x16_bf16 v[96:111], v[80:83], v[8:11], v[96:111]
    v_mfma_f32_16x16x32_bf16 v[128:131], v[240:243], v[8:11], v[128:131]
    v_mfma_f32_32x32x16_bf16 v[96:111], v[84:87], v[12:15], v[96:111]
    v_mfma_f32_16x16x32_bf16 v[128:131], v[240:243], v[12:15], v[128:131]
    s_add_u32 m0, s84, 122880
    s_add_u32 s81, s43, 1
    s_and_b32 s81, s81, 7
    s_lshl_b32 s81, s81, 18
    s_add_u32 s81, s81, s88
    buffer_load_dwordx4 v250, s[60:63], s81 offen lds
    s_add_u32 s81, s81, 15360
    buffer_load_dwordx4 v250, s[60:63], s81 offen offset:1024 lds
    s_add_u32 m0, s84, 139264
    s_add_u32 s81, s43, 2
    s_and_b32 s81, s81, 7
    s_lshl_b32 s81, s81, 18
    s_add_u32 s81, s81, s88
    buffer_load_dwordx4 v250, s[60:63], s81 offen lds
    s_add_u32 s81, s81, 15360
    buffer_load_dwordx4 v250, s[60:63], s81 offen offset:1024 lds
    s_lshl_b32 s80, s32, 2
    v_add_u32 v158, s80, v251
    v_mov_b32 v159, 1
    ds_write_b32 v158, v159 offset:64
    s_mov_b32 s80, 0
    buffer_load_dwordx2 v[112:113], v217, s[64:67], s80 offen offset:0
    buffer_load_dwordx2 v[114:115], v217, s[64:67], s80 offen offset:2048
    s_mov_b32 s80, 4096
    buffer_load_dwordx2 v[116:117], v217, s[64:67], s80 offen offset:0
    buffer_load_dwordx2 v[118:119], v217, s[64:67], s80 offen offset:2048
    s_mov_b32 s80, 8192
    buffer_load_dwordx2 v[120:121], v217, s[64:67], s80 offen offset:0
    buffer_load_dwordx2 v[122:123], v217, s[64:67], s80 offen offset:2048
    s_mov_b32 s80, 12288
    buffer_load_dwordx2 v[124:125], v217, s[64:67], s80 offen offset:0
    buffer_load_dwordx2 v[126:127], v217, s[64:67], s80 offen offset:2048
    buffer_load_dwordx2 v[196:197], v219, s[12:15], 0 offen sc1
    s_branch L_afin_8
L_aexit_14:
    v_mfma_f32_32x32x16_bf16 v[96:111], v[88:91], v[24:27], v[96:111]
    v_mfma_f32_16x16x32_bf16 v[128:131], v[240:243], v[24:27], v[128:131]
    v_mfma_f32_32x32x16_bf16 v[96:111], v[92:95], v[28:31], v[96:111]
    v_mfma_f32_16x16x32_bf16 v[128:131], v[240:243], v[28:31], v[128:131]
    s_add_u32 m0, s84, 139264
    s_add_u32 s81, s43, 2
    s_and_b32 s81, s81, 7
    s_lshl_b32 s81, s81, 18
    s_add_u32 s81, s81, s88
    buffer_load_dwordx4 v250, s[60:63], s81 offen lds
    s_add_u32 s81, s81, 15360
    buffer_load_dwordx4 v250, s[60:63], s81 offen offset:1024 lds
    s_lshl_b32 s80, s32, 2
    v_add_u32 v158, s80, v251
    v_mov_b32 v159, 1
    ds_write_b32 v158, v159 offset:64
    s_mov_b32 s80, 0
    buffer_load_dwordx2 v[112:113], v217, s[64:67], s80 offen offset:0
    buffer_load_dwordx2 v[114:115], v217, s[64:67], s80 offen offset:2048
    s_mov_b32 s80, 4096
    buffer_load_dwordx2 v[116:117], v217, s[64:67], s80 offen offset:0
    buffer_load_dwordx2 v[118:119], v217, s[64:67], s80 offen offset:2048
    s_mov_b32 s80, 8192
    buffer_load_dwordx2 v[120:121], v217, s[64:67], s80 offen offset:0
    buffer_load_dwordx2 v[122:123], v217, s[64:67], s80 offen offset:2048
    s_mov_b32 s80, 12288
    buffer_load_dwordx2 v[124:125], v217, s[64:67], s80 offen offset:0
    buffer_load_dwordx2 v[126:127], v217, s[64:67], s80 offen offset:2048
    buffer_load_dwordx2 v[196:197], v219, s[12:15], 0 offen sc1
    s_branch L_afin_8
L_aexit_15:
    v_mfma_f32_32x32x16_bf16 v[96:111], v[160:163], v[40:43], v[96:111]
    v_mfma_f32_16x16x32_bf16 v[128:131], v[240:243], v[40:43], v[128:131]
    v_mfma_f32_32x32x16_bf16 v[96:111], v[164:167], v[44:47], v[96:111]
    v_mfma_f32_16x16x32_bf16 v[128:131], v[240:243], v[44:47], v[128:131]
    s_lshl_b32 s80, s32, 2
    v_add_u32 v158, s80, v251
    v_mov_b32 v159, 1
    ds_write_b32 v158, v159 offset:64
    s_mov_b32 s80, 0
    buffer_load_dwordx2 v[112:113], v217, s[64:67], s80 offen offset:0
    buffer_load_dwordx2 v[114:115], v217, s[64:67], s80 offen offset:2048
    s_mov_b32 s80, 4096
    buffer_load_dwordx2 v[116:117], v217, s[64:67], s80 offen offset:0
    buffer_load_dwordx2 v[118:119], v217, s[64:67], s80 offen offset:2048
    s_mov_b32 s80, 8192
    buffer_load_dwordx2 v[120:121], v217, s[64:67], s80 offen offset:0
    buffer_load_dwordx2 v[122:123], v217, s[64:67], s80 offen offset:2048
    s_mov_b32 s80, 12288
    buffer_load_dwordx2 v[124:125], v217, s[64:67], s80 offen offset:0
    buffer_load_dwordx2 v[126:127], v217, s[64:67], s80 offen offset:2048
    buffer_load_dwordx2 v[196:197], v219, s[12:15], 0 offen sc1
    s_branch L_afin_8
L_aexit_16:
    v_mfma_f32_32x32x16_bf16 v[96:111], v[80:83], v[8:11], v[96:111]
    v_mfma_f32_16x16x32_bf16 v[128:131], v[240:243], v[8:11], v[128:131]
    v_mfma_f32_32x32x16_bf16 v[96:111], v[84:87], v[12:15], v[96:111]
    v_mfma_f32_16x16x32_bf16 v[128:131], v[240:243], v[12:15], v[128:131]
    s_lshl_b32 s80, s32, 2
    v_add_u32 v158, s80, v251
    v_mov_b32 v159, 1
    ds_write_b32 v158, v159 offset:64
    s_mov_b32 s80, 0
    buffer_load_dwordx2 v[112:113], v217, s[64:67], s80 offen offset:0
    buffer_load_dwordx2 v[114:115], v217, s[64:67], s80 offen offset:2048
    s_mov_b32 s80, 4096
    buffer_load_dwordx2 v[116:117], v217, s[64:67], s80 offen offset:0
    buffer_load_dwordx2 v[118:119], v217, s[64:67], s80 offen offset:2048
    s_mov_b32 s80, 8192
    buffer_load_dwordx2 v[120:121], v217, s[64:67], s80 offen offset:0
    buffer_load_dwordx2 v[122:123], v217, s[64:67], s80 offen offset:2048
    s_mov_b32 s80, 12288
    buffer_load_dwordx2 v[124:125], v217, s[64:67], s80 offen offset:0
    buffer_load_dwordx2 v[126:127], v217, s[64:67], s80 offen offset:2048
    buffer_load_dwordx2 v[196:197], v219, s[12:15], 0 offen sc1
    s_branch L_afin_8
L_aexit_17:
    v_mfma_f32_32x32x16_bf16 v[96:111], v[88:91], v[24:27], v[96:111]
    v_mfma_f32_16x16x32_bf16 v[128:131], v[240:243], v[24:27], v[128:131]
    v_mfma_f32_32x32x16_bf16 v[96:111], v[92:95], v[28:31], v[96:111]
    v_mfma_f32_16x16x32_bf16 v[128:131], v[240:243], v[28:31], v[128:131]
    s_branch L_afin_8
L_ylate_18:
    s_waitcnt vmcnt(0)
    s_lshl_b32 s80, s32, 2
    v_add_u32 v4, s80, v251
    v_mov_b32 v5, 1
    ds_write_b32 v4, v5 offset:0
    buffer_load_dwordx2 v[196:197], v219, s[12:15], 0 offen sc1
    s_mov_b32 s80, 0xffffffff
    s_mov_b32 s81, 0xffffffff
    s_mov_b32 s85, 0
L_pollc_1025:
    s_waitcnt vmcnt(0)
    v_cmp_eq_u64 vcc, s[78:79], v[196:197]
    s_add_u32 s85, s85, 1
    s_and_b64 s[82:83], vcc, s[80:81]
    s_cmp_eq_u64 s[82:83], s[80:81]
    s_cbranch_scc1 L_polld_1026
    buffer_load_dwordx2 v[196:197], v219, s[12:15], 0 offen sc1
    s_cmp_lt_u32 s85, 0x40000
    s_cbranch_scc1 L_pollc_1025
    s_waitcnt vmcnt(0)
L_polld_1026:
    s_mov_b32 s80, 0xc00000
    buffer_load_dwordx4 v[168:171], v216, s[12:15], s80 offen
    s_add_u32 s80, s80, 4096
    buffer_load_dwordx4 v[172:175], v216, s[12:15], s80 offen
    s_add_u32 s80, s80, 4096
    buffer_load_dwordx4 v[176:179], v216, s[12:15], s80 offen
    s_add_u32 s80, s80, 4096
    buffer_load_dwordx4 v[180:183], v216, s[12:15], s80 offen
    s_waitcnt vmcnt(0)
    s_branch L_yback_19
L_mneg_1040:
    v_cndmask_b32 v24, v244, v8, s[4:5]
    v_cndmask_b32 v25, v244, v9, s[6:7]
    v_cndmask_b32 v26, v244, v10, s[16:17]
    v_cndmask_b32 v27, v244, v11, s[18:19]
    v_cndmask_b32 v28, v244, v12, s[20:21]
    v_cndmask_b32 v29, v244, v13, s[22:23]
    v_cndmask_b32 v30, v244, v14, s[24:25]
    v_cndmask_b32 v31, v244, v15, s[26:27]
    v_cndmask_b32 v32, v244, v16, s[28:29]
    v_cndmask_b32 v33, v244, v17, s[30:31]
    v_cndmask_b32 v34, v244, v18, s[58:59]
    v_cndmask_b32 v35, v244, v19, s[76:77]
    v_cndmask_b32 v36, v244, v20, s[92:93]
    v_cndmask_b32 v37, v244, v21, s[94:95]
    v_cndmask_b32 v38, v244, v22, s[96:97]
    v_cndmask_b32 v39, v244, v23, s[98:99]
    s_branch L_mback_1041
L_aexit_1042:
    v_mfma_f32_32x32x16_bf16 v[96:111], v[80:83], v[32:35], 0
    v_mfma_f32_16x16x32_bf16 v[128:131], v[240:243], v[24:27], 0
    v_mfma_f32_32x32x16_bf16 v[96:111], v[84:87], v[36:39], v[96:111]
    v_mfma_f32_16x16x32_bf16 v[128:131], v[240:243], v[28:31], v[128:131]
    v_mfma_f32_32x32x16_bf16 v[96:111], v[88:91], v[144:147], v[96:111]
    v_mfma_f32_32x32x16_bf16 v[96:111], v[92:95], v[148:151], v[96:111]
    buffer_load_dword v157, v199, s[64:67], 0 offen
    s_add_u32 m0, s84, 106496
    s_add_u32 s81, s43, 0
    s_and_b32 s81, s81, 7
    s_lshl_b32 s81, s81, 18
    s_add_u32 s81, s81, s88
    buffer_load_dwordx4 v250, s[60:63], s81 offen lds
    s_add_u32 s81, s81, 15360
    buffer_load_dwordx4 v250, s[60:63], s81 offen offset:1024 lds
    s_add_u32 m0, s84, 122880
    s_add_u32 s81, s43, 1
    s_and_b32 s81, s81, 7
    s_lshl_b32 s81, s81, 18
    s_add_u32 s81, s81, s88
    buffer_load_dwordx4 v250, s[60:63], s81 offen lds
    s_add_u32 s81, s81, 15360
    buffer_load_dwordx4 v250, s[60:63], s81 offen offset:1024 lds
    s_add_u32 m0, s84, 139264
    s_add_u32 s81, s43, 2
    s_and_b32 s81, s81, 7
    s_lshl_b32 s81, s81, 18
    s_add_u32 s81, s81, s88
    buffer_load_dwordx4 v250, s[60:63], s81 offen lds
    s_add_u32 s81, s81, 15360
    buffer_load_dwordx4 v250, s[60:63], s81 offen offset:1024 lds
    s_lshl_b32 s80, s32, 2
    v_add_u32 v158, s80, v251
    v_mov_b32 v159, 1
    ds_write_b32 v158, v159 offset:64
    s_branch L_afin_1039
L_aexit_1043:
    v_mfma_f32_32x32x16_bf16 v[96:111], v[160:163], v[40:43], v[96:111]
    v_mfma_f32_16x16x32_bf16 v[128:131], v[240:243], v[40:43], v[128:131]
    v_mfma_f32_32x32x16_bf16 v[96:111], v[164:167], v[44:47], v[96:111]
    v_mfma_f32_16x16x32_bf16 v[128:131], v[240:243], v[44:47], v[128:131]
    s_add_u32 m0, s84, 106496
    s_add_u32 s81, s43, 0
    s_and_b32 s81, s81, 7
    s_lshl_b32 s81, s81, 18
    s_add_u32 s81, s81, s88
    buffer_load_dwordx4 v250, s[60:63], s81 offen lds
    s_add_u32 s81, s81, 15360
    buffer_load_dwordx4 v250, s[60:63], s81 offen offset:1024 lds
    s_add_u32 m0, s84, 122880
    s_add_u32 s81, s43, 1
    s_and_b32 s81, s81, 7
    s_lshl_b32 s81, s81, 18
    s_add_u32 s81, s81, s88
    buffer_load_dwordx4 v250, s[60:63], s81 offen lds
    s_add_u32 s81, s81, 15360
    buffer_load_dwordx4 v250, s[60:63], s81 offen offset:1024 lds
    s_add_u32 m0, s84, 139264
    s_add_u32 s81, s43, 2
    s_and_b32 s81, s81, 7
    s_lshl_b32 s81, s81, 18
    s_add_u32 s81, s81, s88
    buffer_load_dwordx4 v250, s[60:63], s81 offen lds
    s_add_u32 s81, s81, 15360
    buffer_load_dwordx4 v250, s[60:63], s81 offen offset:1024 lds
    s_lshl_b32 s80, s32, 2
    v_add_u32 v158, s80, v251
    v_mov_b32 v159, 1
    ds_write_b32 v158, v159 offset:64
    s_branch L_afin_1039
L_aexit_1044:
    v_mfma_f32_32x32x16_bf16 v[96:111], v[80:83], v[8:11], v[96:111]
    v_mfma_f32_16x16x32_bf16 v[128:131], v[240:243], v[8:11], v[128:131]
    v_mfma_f32_32x32x16_bf16 v[96:111], v[84:87], v[12:15], v[96:111]
    v_mfma_f32_16x16x32_bf16 v[128:131], v[240:243], v[12:15], v[128:131]
    s_add_u32 m0, s84, 122880
    s_add_u32 s81, s43, 1
    s_and_b32 s81, s81, 7
    s_lshl_b32 s81, s81, 18
    s_add_u32 s81, s81, s88
    buffer_load_dwordx4 v250, s[60:63], s81 offen lds
    s_add_u32 s81, s81, 15360
    buffer_load_dwordx4 v250, s[60:63], s81 offen offset:1024 lds
    s_add_u32 m0, s84, 139264
    s_add_u32 s81, s43, 2
    s_and_b32 s81, s81, 7
    s_lshl_b32 s81, s81, 18
    s_add_u32 s81, s81, s88
    buffer_load_dwordx4 v250, s[60:63], s81 offen lds
    s_add_u32 s81, s81, 15360
    buffer_load_dwordx4 v250, s[60:63], s81 offen offset:1024 lds
    s_lshl_b32 s80, s32, 2
    v_add_u32 v158, s80, v251
    v_mov_b32 v159, 1
    ds_write_b32 v158, v159 offset:64
    s_branch L_afin_1039
L_aexit_1045:
    v_mfma_f32_32x32x16_bf16 v[96:111], v[88:91], v[24:27], v[96:111]
    v_mfma_f32_16x16x32_bf16 v[128:131], v[240:243], v[24:27], v[128:131]
    v_mfma_f32_32x32x16_bf16 v[96:111], v[92:95], v[28:31], v[96:111]
    v_mfma_f32_16x16x32_bf16 v[128:131], v[240:243], v[28:31], v[128:131]
    s_add_u32 m0, s84, 139264
    s_add_u32 s81, s43, 2
    s_and_b32 s81, s81, 7
    s_lshl_b32 s81, s81, 18
    s_add_u32 s81, s81, s88
    buffer_load_dwordx4 v250, s[60:63], s81 offen lds
    s_add_u32 s81, s81, 15360
    buffer_load_dwordx4 v250, s[60:63], s81 offen offset:1024 lds
    s_lshl_b32 s80, s32, 2
    v_add_u32 v158, s80, v251
    v_mov_b32 v159, 1
    ds_write_b32 v158, v159 offset:64
    s_branch L_afin_1039
L_aexit_1046:
    v_mfma_f32_32x32x16_bf16 v[96:111], v[160:163], v[40:43], v[96:111]
    v_mfma_f32_16x16x32_bf16 v[128:131], v[240:243], v[40:43], v[128:131]
    v_mfma_f32_32x32x16_bf16 v[96:111], v[164:167], v[44:47], v[96:111]
    v_mfma_f32_16x16x32_bf16 v[128:131], v[240:243], v[44:47], v[128:131]
    s_lshl_b32 s80, s32, 2
    v_add_u32 v158, s80, v251
    v_mov_b32 v159, 1
    ds_write_b32 v158, v159 offset:64
    s_branch L_afin_1039
L_aexit_1047:
    v_mfma_f32_32x32x16_bf16 v[96:111], v[80:83], v[8:11], v[96:111]
    v_mfma_f32_16x16x32_bf16 v[128:131], v[240:243], v[8:11], v[128:131]
    v_mfma_f32_32x32x16_bf16 v[96:111], v[84:87], v[12:15], v[96:111]
    v_mfma_f32_16x16x32_bf16 v[128:131], v[240:243], v[12:15], v[128:131]
    s_lshl_b32 s80, s32, 2
    v_add_u32 v158, s80, v251
    v_mov_b32 v159, 1
    ds_write_b32 v158, v159 offset:64
    s_branch L_afin_1039
L_aexit_1048:
    v_mfma_f32_32x32x16_bf16 v[96:111], v[88:91], v[24:27], v[96:111]
    v_mfma_f32_16x16x32_bf16 v[128:131], v[240:243], v[24:27], v[128:131]
    v_mfma_f32_32x32x16_bf16 v[96:111], v[92:95], v[28:31], v[96:111]
    v_mfma_f32_16x16x32_bf16 v[128:131], v[240:243], v[28:31], v[128:131]
    s_branch L_afin_1039
L_end:
    s_endpgm
L_exact:
    s_waitcnt vmcnt(0) lgkmcnt(0)
    v_and_b32 v24, 31, v0
    v_lshrrev_b32 v25, 5, v0
    v_lshlrev_b32 v25, 2, v25
    v_sub_u32 v24, v24, v25
    v_mov_b32 v25, 0xf149f2ca
    v_mov_b32 v152, v25
    s_lshl_b32 s4, s34, 1
    s_add_u32 s4, s4, s41
    s_lshl_b32 s4, s4, 6
    s_add_u32 s4, s4, s45
    s_lshl_b32 s4, s4, 11
    s_add_u32 s4, s4, 0x3fc000
    s_sub_u32 s5, 8, s45
    s_cmp_lt_u32 s45, 8
    s_cselect_b32 s5, s5, 0
    v_mov_b32 v200, 0
    v_mov_b32 v96, 0
    v_mov_b32 v201, 0
    v_mov_b32 v97, 0
    v_mov_b32 v202, 0
    v_mov_b32 v98, 0
    v_mov_b32 v203, 0
    v_mov_b32 v99, 0
    v_mov_b32 v204, 0
    v_mov_b32 v100, 0
    v_mov_b32 v205, 0
    v_mov_b32 v101, 0
    v_mov_b32 v206, 0
    v_mov_b32 v102, 0
    v_mov_b32 v207, 0
    v_mov_b32 v103, 0
    v_mov_b32 v208, 0
    v_mov_b32 v104, 0
    v_mov_b32 v209, 0
    v_mov_b32 v105, 0
    v_mov_b32 v210, 0
    v_mov_b32 v106, 0
    v_mov_b32 v211, 0
    v_mov_b32 v107, 0
    v_mov_b32 v212, 0
    v_mov_b32 v108, 0
    v_mov_b32 v213, 0
    v_mov_b32 v109, 0
    v_mov_b32 v214, 0
    v_mov_b32 v110, 0
    v_mov_b32 v215, 0
    v_mov_b32 v111, 0
    v_mov_b32 v128, 0
    v_mov_b32 v129, 0
    v_mov_b32 v130, 0
    v_mov_b32 v131, 0
    s_mov_b32 s9, 0
L_expass:
    s_mov_b32 s6, s5
L_extile:
    s_lshl_b32 s7, s6, 11
    s_add_u32 s7, s7, s4
    s_add_u32 s8, s7, 0x400000
    buffer_load_dwordx4 v[56:59], v1, s[12:15], s7 offen offset:0
    buffer_load_dwordx4 v[80:83], v1, s[12:15], s8 offen offset:0
    buffer_load_dwordx4 v[60:63], v1, s[12:15], s7 offen offset:1024
    buffer_load_dwordx4 v[84:87], v1, s[12:15], s8 offen offset:1024
    s_waitcnt vmcnt(0)
    v_mfma_f32_32x32x16_bf16 v[8:23], v[56:59], v[224:227], v[200:215]
    v_mfma_f32_32x32x16_bf16 v[8:23], v[60:63], v[228:231], v[8:23]
    s_nop 7
    s_nop 7
    s_cmp_lg_u32 s6, 8
    s_cbranch_scc1 L_exm8
    v_cmp_le_i32 vcc, 0, v24
    v_cndmask_b32 v8, v25, v8, vcc
    v_cmp_le_i32 vcc, 1, v24
    v_cndmask_b32 v9, v25, v9, vcc
    v_cmp_le_i32 vcc, 2, v24
    v_cndmask_b32 v10, v25, v10, vcc
    v_cmp_le_i32 vcc, 3, v24
    v_cndmask_b32 v11, v25, v11, vcc
    v_cmp_le_i32 vcc, 8, v24
    v_cndmask_b32 v12, v25, v12, vcc
    v_cmp_le_i32 vcc, 9, v24
    v_cndmask_b32 v13, v25, v13, vcc
    v_cmp_le_i32 vcc, 10, v24
    v_cndmask_b32 v14, v25, v14, vcc
    v_cmp_le_i32 vcc, 11, v24
    v_cndmask_b32 v15, v25, v15, vcc
    v_cmp_le_i32 vcc, 16, v24
    v_cndmask_b32 v16, v25, v16, vcc
    v_cmp_le_i32 vcc, 17, v24
    v_cndmask_b32 v17, v25, v17, vcc
    v_cmp_le_i32 vcc, 18, v24
    v_cndmask_b32 v18, v25, v18, vcc
    v_cmp_le_i32 vcc, 19, v24
    v_cndmask_b32 v19, v25, v19, vcc
    v_cmp_le_i32 vcc, 24, v24
    v_cndmask_b32 v20, v25, v20, vcc
    v_cmp_le_i32 vcc, 25, v24
    v_cndmask_b32 v21, v25, v21, vcc
    v_cmp_le_i32 vcc, 26, v24
    v_cndmask_b32 v22, v25, v22, vcc
    v_cmp_le_i32 vcc, 27, v24
    v_cndmask_b32 v23, v25, v23, vcc
L_exm8:
    s_cmp_lg_u32 s6, 0
    s_cbranch_scc1 L_exm0
    v_cmp_gt_i32 vcc, 0, v24
    v_cndmask_b32 v8, v25, v8, vcc
    v_cmp_gt_i32 vcc, 1, v24
    v_cndmask_b32 v9, v25, v9, vcc
    v_cmp_gt_i32 vcc, 2, v24
    v_cndmask_b32 v10, v25, v10, vcc
    v_cmp_gt_i32 vcc, 3, v24
    v_cndmask_b32 v11, v25, v11, vcc
    v_cmp_gt_i32 vcc, 8, v24
    v_cndmask_b32 v12, v25, v12, vcc
    v_cmp_gt_i32 vcc, 9, v24
    v_cndmask_b32 v13, v25, v13, vcc
    v_cmp_gt_i32 vcc, 10, v24
    v_cndmask_b32 v14, v25, v14, vcc
    v_cmp_gt_i32 vcc, 11, v24
    v_cndmask_b32 v15, v25, v15, vcc
    v_cmp_gt_i32 vcc, 16, v24
    v_cndmask_b32 v16, v25, v16, vcc
    v_cmp_gt_i32 vcc, 17, v24
    v_cndmask_b32 v17, v25, v17, vcc
    v_cmp_gt_i32 vcc, 18, v24
    v_cndmask_b32 v18, v25, v18, vcc
    v_cmp_gt_i32 vcc, 19, v24
    v_cndmask_b32 v19, v25, v19, vcc
    v_cmp_gt_i32 vcc, 24, v24
    v_cndmask_b32 v20, v25, v20, vcc
    v_cmp_gt_i32 vcc, 25, v24
    v_cndmask_b32 v21, v25, v21, vcc
    v_cmp_gt_i32 vcc, 26, v24
    v_cndmask_b32 v22, v25, v22, vcc
    v_cmp_gt_i32 vcc, 27, v24
    v_cndmask_b32 v23, v25, v23, vcc
L_exm0:
    s_cmp_lg_u32 s9, 0
    s_cbranch_scc1 L_exp2
    v_max_f32 v152, v152, v8
    v_max_f32 v152, v152, v9
    v_max_f32 v152, v152, v10
    v_max_f32 v152, v152, v11
    v_max_f32 v152, v152, v12
    v_max_f32 v152, v152, v13
    v_max_f32 v152, v152, v14
    v_max_f32 v152, v152, v15
    v_max_f32 v152, v152, v16
    v_max_f32 v152, v152, v17
    v_max_f32 v152, v152, v18
    v_max_f32 v152, v152, v19
    v_max_f32 v152, v152, v20
    v_max_f32 v152, v152, v21
    v_max_f32 v152, v152, v22
    v_max_f32 v152, v152, v23
    s_branch L_exnext
L_exp2:
    v_exp_f32 v8, v8
    v_exp_f32 v9, v9
    v_exp_f32 v10, v10
    v_exp_f32 v11, v11
    v_exp_f32 v12, v12
    v_exp_f32 v13, v13
    v_exp_f32 v14, v14
    v_exp_f32 v15, v15
    v_exp_f32 v16, v16
    v_exp_f32 v17, v17
    v_exp_f32 v18, v18
    v_exp_f32 v19, v19
    v_exp_f32 v20, v20
    v_exp_f32 v21, v21
    v_exp_f32 v22, v22
    v_exp_f32 v23, v23
    s_nop 0
    v_cvt_pk_bf16_f32 v8, v8, v9
    v_cvt_pk_bf16_f32 v9, v10, v11
    v_cvt_pk_bf16_f32 v10, v12, v13
    v_cvt_pk_bf16_f32 v11, v14, v15
    v_cvt_pk_bf16_f32 v12, v16, v17
    v_cvt_pk_bf16_f32 v13, v18, v19
    v_cvt_pk_bf16_f32 v14, v20, v21
    v_cvt_pk_bf16_f32 v15, v22, v23
    s_nop 1
    v_mfma_f32_32x32x16_bf16 v[96:111], v[80:83], v[8:11], v[96:111]
    v_mfma_f32_16x16x32_bf16 v[128:131], v[240:243], v[8:11], v[128:131]
    v_mfma_f32_32x32x16_bf16 v[96:111], v[84:87], v[12:15], v[96:111]
    v_mfma_f32_16x16x32_bf16 v[128:131], v[240:243], v[12:15], v[128:131]
    s_nop 7
    s_nop 7
L_exnext:
    s_add_u32 s6, s6, 1
    s_cmp_le_u32 s6, 8
    s_cbranch_scc1 L_extile
    s_cmp_lg_u32 s9, 0
    s_cbranch_scc1 L_exdone
    v_mov_b32 v154, v152
    s_nop 1
    v_permlane32_swap_b32 v152, v154
    s_nop 1
    v_max_f32 v152, v152, v154
    v_sub_f32 v200, 0, v152
    v_sub_f32 v201, 0, v152
    v_sub_f32 v202, 0, v152
    v_sub_f32 v203, 0, v152
    v_sub_f32 v204, 0, v152
    v_sub_f32 v205, 0, v152
    v_sub_f32 v206, 0, v152
    v_sub_f32 v207, 0, v152
    v_sub_f32 v208, 0, v152
    v_sub_f32 v209, 0, v152
    v_sub_f32 v210, 0, v152
    v_sub_f32 v211, 0, v152
    v_sub_f32 v212, 0, v152
    v_sub_f32 v213, 0, v152
    v_sub_f32 v214, 0, v152
    v_sub_f32 v215, 0, v152
    s_mov_b32 s9, 1
    s_branch L_expass
L_exdone:
    v_rcp_f32 v154, v128
    s_cmp_eq_u32 s101, 1
    s_cbranch_scc1 L_normM
    s_branch L_normH
.section .rodata,"a"
.p2align 6
.amdhsa_kernel concat_heads__ssm_conv_h3__sliding_block__prompt_kernel
  .amdhsa_next_free_vgpr 256
  .amdhsa_next_free_sgpr 102
  .amdhsa_accum_offset 256
  .amdhsa_group_segment_fixed_size 0
  .amdhsa_kernarg_size 96
  .amdhsa_user_sgpr_count 2
  .amdhsa_user_sgpr_kernarg_segment_ptr 1
  .amdhsa_system_sgpr_workgroup_id_x 1
.end_amdhsa_kernel
```
